```python
import torch

def _softmax(x, axis=-1):
    return torch.softmax(x, dim=axis)
def _gelu(x):
    return torch.nn.functional.gelu(x, approximate="tanh")
def _silu(x):
    return torch.nn.functional.silu(x)
def _sigmoid(x):
    return torch.sigmoid(x)
def _layernorm(x, axis=-1, eps=1e-5):
    m = x.mean(dim=axis, keepdim=True)
    v = x.var(dim=axis, keepdim=True, unbiased=False)
    return (x - m) / torch.sqrt(v + eps)
def _scatter_add(tgt, idx, src, axis=0):
    return tgt.clone().index_add_(axis, idx, src)
def _segment_sum(src, seg, n):
    out = torch.zeros((n,) + src.shape[1:], dtype=src.dtype)
    return out.index_add_(0, seg, src)
def _pad(x, pw):
    flat = tuple(v for pair in reversed(pw) for v in pair)
    return torch.nn.functional.pad(x, flat)

kernel_name = 'interleave_layers__linear_attn_block__geglu_ffn__prompt'

def setup_inputs():

    _w = (lambda a: (lambda t: t.to(torch.bfloat16) if t.is_floating_point() else t)(torch.as_tensor(a)))
    def _A_setup():
        B, S, D = 1, 2048, 576
        return {
            "x": _w((lambda *s: torch.randn(*s, dtype=torch.bfloat16) * 0.05)(B, S, D)),
            "wqkv": _w((lambda *s: torch.randn(*s, dtype=torch.bfloat16) * 0.05)(D, 3 * D)),
            "wo": _w((lambda *s: torch.randn(*s, dtype=torch.bfloat16) * 0.05)(D, D)),
        }
    _A_in = _A_setup()

    def _B_setup():
        B, S, D, F = 1, 2048, 576, 4608
        return {
            "x": _w((lambda *s: torch.randn(*s, dtype=torch.bfloat16) * 0.05)(B, S, D)),
            "w_gate": _w((lambda *s: torch.randn(*s, dtype=torch.bfloat16) * 0.05)(D, F)),
            "w_up": _w((lambda *s: torch.randn(*s, dtype=torch.bfloat16) * 0.05)(D, F)),
            "w_down": _w((lambda *s: torch.randn(*s, dtype=torch.bfloat16) * 0.05)(F, D)),
        }
    _B_in = _B_setup()

    return {
        "A_x": _A_in["x"],
        "A_wqkv": _A_in["wqkv"],
        "A_wo": _A_in["wo"],
        "B_x": _B_in["x"],
        "B_w_gate": _B_in["w_gate"],
        "B_w_up": _B_in["w_up"],
        "B_w_down": _B_in["w_down"],
    }

def reference(A_x, A_wqkv, A_wo, B_x, B_w_gate, B_w_up, B_w_down):
    def _A_ref(x, wqkv, wo):
        B, S, D = x.shape
        H = 32; Dh = D // H
        qkv = (lambda x, *d: x.permute(*d))((x @ wqkv).reshape(B, S, 3, H, Dh), 2, 0, 3, 1, 4)
        q, k, v = qkv[0], qkv[1], qkv[2]
        phi = lambda t: torch.where(t > 0, t + 1, torch.exp(t)) + 1e-6
        pq, pk = phi(q), phi(k)
        kv = torch.einsum("bhsd,bhse->bhde", pk, v)
        z = torch.einsum("bhsd->bhd", pk)
        num = torch.einsum("bhqd,bhde->bhqe", pq, kv)
        den = torch.einsum("bhqd,bhd->bhq", pq, z)[..., None] + 1e-6
        o = num / den
        return (lambda x, *d: x.permute(*d))(o, 0, 2, 1, 3).reshape(B, S, D) @ wo

    def _B_ref(x, w_gate, w_up, w_down):
        return (_gelu(x @ w_gate) * (x @ w_up)) @ w_down

    x = A_x
    x = x + _A_ref(_layernorm(x, axis=-1), A_wqkv, A_wo)
    x = x + _B_ref(_layernorm(x, axis=-1), B_w_gate, B_w_up, B_w_down)
    x = x + _A_ref(_layernorm(x, axis=-1), A_wqkv, A_wo)
    x = x + _B_ref(_layernorm(x, axis=-1), B_w_gate, B_w_up, B_w_down)
    return x
```

```asm
; @launch kernel=k0_kernel grid=(452,1,1) block=(576,1,1) lds=46080
; @launch kernel=mk_kernel grid=(256,1,1) block=(256,1,1) lds=163840
.amdgcn_target "amdgcn-amd-amdhsa--gfx950"
.text
.globl k0_kernel
.p2align 8
.type k0_kernel,@function
k0_kernel:
    s_load_dwordx2 s[4:5], s[0:1], 72
    s_load_dwordx2 s[6:7], s[0:1], 0
    s_load_dwordx4 s[40:43], s[0:1], 8
    s_load_dwordx4 s[44:47], s[0:1], 32
    s_load_dwordx2 s[48:49], s[0:1], 48
    v_lshrrev_b32 v1, 6, v0
    s_nop 0
    v_readfirstlane_b32 s3, v1
    v_and_b32 v1, 63, v0
    s_cmp_ge_u32 s2, 452
    s_cbranch_scc0 SK_k0_27
    s_endpgm
SK_k0_27:
    s_add_u32 s2, s2, 208
    s_cmp_ge_u32 s2, 452
    s_cselect_b32 s20, 452, 0
    s_sub_u32 s2, s2, s20
    s_and_b32 s51, s2, 1
    s_lshr_b32 s20, s2, 1
    s_sub_u32 s21, s2, 104
    s_cmp_ge_u32 s2, 320
    s_cselect_b32 s2, s21, s20
    s_cmp_ge_u32 s2, 284
    s_cbranch_scc0 SK_k0_28
    s_sub_u32 s2, s2, 284
    v_and_b32 v1, 15, v0
    v_lshrrev_b32 v2, 4, v0
    v_lshlrev_b32 v3, 4, v0
    v_mul_u32_u24 v4, 1152, v1
    v_lshl_add_u32 v4, v2, 4, v4
    s_mul_i32 s20, s2, 36864
    s_waitcnt lgkmcnt(0)
    s_mov_b32 s8, s6
    s_mov_b32 s9, s7
    s_mov_b32 s10, 2359296
    s_mov_b32 s11, 0x20000
    s_lshl_b32 s21, s3, 12
    s_add_u32 m0, s21, 4096
    s_add_u32 s21, s21, s20
    v_and_b32 v7, 63, v0
    v_lshlrev_b32 v7, 4, v7
    buffer_load_dwordx4 v7, s[8:11], s21 offen offset:0 nt lds
    buffer_load_dwordx4 v7, s[8:11], s21 offen offset:1024 nt lds
    buffer_load_dwordx4 v7, s[8:11], s21 offen offset:2048 nt lds
    buffer_load_dwordx4 v7, s[8:11], s21 offen offset:3072 nt lds
    s_add_u32 s12, s4, 18874368
    s_addc_u32 s13, s5, 0
    s_mov_b32 s14, 2359296
    s_mov_b32 s15, 0x20000
    s_add_u32 s16, s4, 21233664
    s_addc_u32 s17, s5, 0
    s_mov_b32 s18, 131072
    s_mov_b32 s19, 0x20000
    s_add_u32 s24, s4, 21364736
    s_addc_u32 s25, s5, 0
    s_mov_b32 s26, 37996544
    s_mov_b32 s27, 0x20000
    v_mov_b32 v16, 0
    v_mov_b32 v17, 0
    v_mov_b32 v18, 0
    v_mov_b32 v19, 0
    s_mul_i32 s21, s2, 3872
    v_mov_b32 v6, 1073741824
    v_cmp_gt_u32 vcc, 242, v0
    s_nop 1
    v_cndmask_b32 v5, v6, v3, vcc
    s_add_u32 s22, s21, 37748736
    buffer_store_dwordx4 v[16:19], v5, s[24:27], s22 offen
    v_add_u32 v6, s21, v3
    v_cmp_le_u32 vcc, 196608, v6
    s_nop 1
    v_cndmask_b32 v28, 0, 16, vcc
    v_cmp_le_u32 vcc, 229376, v6
    s_nop 1
    v_cndmask_b32 v28, v28, 0, vcc
    v_mov_b32 v29, 0
    v_mov_b32 v30, 0
    v_mov_b32 v31, 0
    buffer_store_dwordx4 v[28:31], v5, s[24:27], s21 offen
    s_mov_b32 s30, 0x3f803f80
    s_waitcnt vmcnt(2)
    s_barrier
    ds_read_b128 v[32:35], v4 offset:4096
    ds_read_b128 v[36:39], v4 offset:4672
    ds_read_b128 v[40:43], v4 offset:22528
    ds_read_b128 v[44:47], v4 offset:23104
    s_lshl_b32 s23, s3, 7
    v_lshl_add_u32 v24, v1, 3, s23
    s_add_u32 s21, s20, 0
    s_waitcnt lgkmcnt(3)
    buffer_store_dwordx4 v[32:35], v3, s[12:15], s21 offen
    s_add_u32 s21, s20, 9216
    s_waitcnt lgkmcnt(2)
    buffer_store_dwordx4 v[36:39], v3, s[12:15], s21 offen
    v_mov_b32 v20, 0
    v_mov_b32 v21, 0
    v_dot2c_f32_bf16 v20, s30, v32
    v_dot2c_f32_bf16 v21, v32, v32
    v_dot2c_f32_bf16 v20, s30, v33
    v_dot2c_f32_bf16 v21, v33, v33
    v_dot2c_f32_bf16 v20, s30, v34
    v_dot2c_f32_bf16 v21, v34, v34
    v_dot2c_f32_bf16 v20, s30, v35
    v_dot2c_f32_bf16 v21, v35, v35
    v_dot2c_f32_bf16 v20, s30, v36
    v_dot2c_f32_bf16 v21, v36, v36
    v_dot2c_f32_bf16 v20, s30, v37
    v_dot2c_f32_bf16 v21, v37, v37
    v_dot2c_f32_bf16 v20, s30, v38
    v_dot2c_f32_bf16 v21, v38, v38
    v_dot2c_f32_bf16 v20, s30, v39
    v_dot2c_f32_bf16 v21, v39, v39
    s_nop 1
    v_mov_b32 v22, v20
    s_nop 1
    v_permlane16_swap_b32 v20, v22
    v_add_f32 v20, v20, v22
    v_mov_b32 v22, v20
    s_nop 1
    v_permlane32_swap_b32 v20, v22
    v_add_f32 v20, v20, v22
    v_mov_b32 v22, v21
    s_nop 1
    v_permlane16_swap_b32 v21, v22
    v_add_f32 v21, v21, v22
    v_mov_b32 v22, v21
    s_nop 1
    v_permlane32_swap_b32 v21, v22
    v_add_f32 v21, v21, v22
    ds_write_b64 v24, v[20:21] offset:0
    s_add_u32 s21, s20, 18432
    s_waitcnt lgkmcnt(2)
    buffer_store_dwordx4 v[40:43], v3, s[12:15], s21 offen
    s_add_u32 s21, s20, 27648
    s_waitcnt lgkmcnt(1)
    buffer_store_dwordx4 v[44:47], v3, s[12:15], s21 offen
    v_mov_b32 v20, 0
    v_mov_b32 v21, 0
    v_dot2c_f32_bf16 v20, s30, v40
    v_dot2c_f32_bf16 v21, v40, v40
    v_dot2c_f32_bf16 v20, s30, v41
    v_dot2c_f32_bf16 v21, v41, v41
    v_dot2c_f32_bf16 v20, s30, v42
    v_dot2c_f32_bf16 v21, v42, v42
    v_dot2c_f32_bf16 v20, s30, v43
    v_dot2c_f32_bf16 v21, v43, v43
    v_dot2c_f32_bf16 v20, s30, v44
    v_dot2c_f32_bf16 v21, v44, v44
    v_dot2c_f32_bf16 v20, s30, v45
    v_dot2c_f32_bf16 v21, v45, v45
    v_dot2c_f32_bf16 v20, s30, v46
    v_dot2c_f32_bf16 v21, v46, v46
    v_dot2c_f32_bf16 v20, s30, v47
    v_dot2c_f32_bf16 v21, v47, v47
    s_nop 1
    v_mov_b32 v22, v20
    s_nop 1
    v_permlane16_swap_b32 v20, v22
    v_add_f32 v20, v20, v22
    v_mov_b32 v22, v20
    s_nop 1
    v_permlane32_swap_b32 v20, v22
    v_add_f32 v20, v20, v22
    v_mov_b32 v22, v21
    s_nop 1
    v_permlane16_swap_b32 v21, v22
    v_add_f32 v21, v21, v22
    v_mov_b32 v22, v21
    s_nop 1
    v_permlane32_swap_b32 v21, v22
    v_add_f32 v21, v21, v22
    ds_write_b64 v24, v[20:21] offset:2048
    s_waitcnt lgkmcnt(0)
    s_barrier
    s_cmp_lt_u32 s3, 2
    s_cbranch_scc0 SK_k0_29
    s_lshl_b32 s23, s3, 11
    v_lshl_add_u32 v24, v1, 3, s23
    ds_read_b64 v[26:27], v24 offset:0
    ds_read_b64 v[28:29], v24 offset:128
    ds_read_b64 v[30:31], v24 offset:256
    ds_read_b64 v[32:33], v24 offset:384
    ds_read_b64 v[34:35], v24 offset:512
    ds_read_b64 v[36:37], v24 offset:640
    ds_read_b64 v[38:39], v24 offset:768
    ds_read_b64 v[40:41], v24 offset:896
    ds_read_b64 v[42:43], v24 offset:1024
    s_waitcnt lgkmcnt(7)
    v_add_f32 v26, v26, v28
    v_add_f32 v27, v27, v29
    s_waitcnt lgkmcnt(6)
    v_add_f32 v26, v26, v30
    v_add_f32 v27, v27, v31
    s_waitcnt lgkmcnt(5)
    v_add_f32 v26, v26, v32
    v_add_f32 v27, v27, v33
    s_waitcnt lgkmcnt(4)
    v_add_f32 v26, v26, v34
    v_add_f32 v27, v27, v35
    s_waitcnt lgkmcnt(3)
    v_add_f32 v26, v26, v36
    v_add_f32 v27, v27, v37
    s_waitcnt lgkmcnt(2)
    v_add_f32 v26, v26, v38
    v_add_f32 v27, v27, v39
    s_waitcnt lgkmcnt(1)
    v_add_f32 v26, v26, v40
    v_add_f32 v27, v27, v41
    s_waitcnt lgkmcnt(0)
    v_add_f32 v26, v26, v42
    v_add_f32 v27, v27, v43
    v_cmp_gt_u32 vcc, 256, v7
    s_nop 1
    v_cndmask_b32 v16, 0, v26, vcc
    v_cndmask_b32 v17, 0, v27, vcc
    s_lshl_b32 s21, s2, 11
    buffer_store_dwordx4 v[16:19], v3, s[16:19], s21 offen
SK_k0_29:
    s_endpgm
SK_k0_28:
    s_cmp_ge_u32 s2, 216
    s_cbranch_scc0 SK_k0_30
    s_lshl_b32 s33, s3, 12
    v_lshlrev_b32 v5, 4, v1
    s_waitcnt lgkmcnt(0)
    s_mov_b32 s12, s4
    s_mov_b32 s13, s5
    s_mov_b32 s14, 94371840
    s_mov_b32 s15, 0x20000
    v_lshrrev_b32 v2, 5, v1
    v_bfe_u32 v3, v1, 3, 1
    v_lshl_add_u32 v2, v2, 1, v3
    v_bfe_u32 v3, v1, 4, 1
    v_bfe_u32 v4, v1, 1, 2
    v_and_b32 v6, 1, v1
    s_cmp_ge_u32 s2, 264
    s_cbranch_scc0 SK_k0_31
    s_mov_b32 s8, s42
    s_mov_b32 s9, s43
    s_mov_b32 s10, 663552
    s_mov_b32 s11, 0x20000
    v_lshrrev_b32 v8, 5, v1
    v_lshlrev_b32 v8, 9, v8
    v_bfe_u32 v7, v1, 2, 3
    v_lshl_add_u32 v8, v7, 5, v8
    v_and_b32 v7, 1, v1
    v_lshl_add_u32 v8, v7, 4, v8
    v_bfe_u32 v7, v1, 1, 1
    v_lshl_add_u32 v8, v7, 3, v8
    v_add_u32 v8, s33, v8
    s_sub_u32 s20, s2, 264
    s_lshl_b32 s20, s20, 2
    s_add_u32 s20, s20, 0
    s_mul_i32 s21, s20, 205
    s_lshr_b32 s21, s21, 10
    s_mul_i32 s22, s21, 5
    s_sub_u32 s22, s20, s22
    s_lshr_b32 s23, s21, 2
    s_and_b32 s24, s21, 3
    s_mul_i32 s36, s20, 9
    s_add_u32 s36, s36, s3
    s_lshl_b32 s36, s36, 10
    s_add_u32 s36, s36, 2064384
    v_mul_u32_u24 v9, 20, v3
    v_lshl_add_u32 v9, v2, 2, v9
    v_add_u32 v9, v9, v4
    s_lshl_b32 s25, s22, 1
    s_lshl_b32 s28, s24, 3
    s_add_u32 s25, s25, s28
    s_mul_i32 s25, s25, 18
    v_add_u32 v9, s25, v9
    v_lshrrev_b32 v10, 1, v4
    v_lshl_add_u32 v10, v10, 2, v2
    v_add_u32 v10, s28, v10
    v_mul_u32_u24 v10, 18, v10
    v_and_b32 v11, 1, v4
    v_add3_u32 v10, v10, v11, 16
    v_and_b32 v11, 1, v2
    v_lshlrev_b32 v11, 4, v11
    v_sub_u32 v10, v10, v11
    v_lshl_add_u32 v10, v3, 16, v10
    s_cmp_eq_u32 s22, 4
    s_cselect_b64 s[30:31], -1, 0
    v_cndmask_b32 v9, v9, v10, s[30:31]
    v_mul_u32_u24 v9, 1152, v9
    v_lshl_add_u32 v9, v6, 4, v9
    s_mul_i32 s25, s23, 288
    s_lshl_b32 s28, s3, 5
    s_add_u32 s25, s25, s28
    s_add_u32 m0, s33, 0
    s_nop 0
    buffer_load_dwordx4 v9, s[8:11], s25 offen  lds
    s_sub_u32 s20, s2, 264
    s_lshl_b32 s20, s20, 2
    s_add_u32 s20, s20, 1
    s_mul_i32 s21, s20, 205
    s_lshr_b32 s21, s21, 10
    s_mul_i32 s22, s21, 5
    s_sub_u32 s22, s20, s22
    s_lshr_b32 s23, s21, 2
    s_and_b32 s24, s21, 3
    s_mul_i32 s37, s20, 9
    s_add_u32 s37, s37, s3
    s_lshl_b32 s37, s37, 10
    s_add_u32 s37, s37, 2064384
    v_mul_u32_u24 v9, 20, v3
    v_lshl_add_u32 v9, v2, 2, v9
    v_add_u32 v9, v9, v4
    s_lshl_b32 s25, s22, 1
    s_lshl_b32 s28, s24, 3
    s_add_u32 s25, s25, s28
    s_mul_i32 s25, s25, 18
    v_add_u32 v9, s25, v9
    v_lshrrev_b32 v10, 1, v4
    v_lshl_add_u32 v10, v10, 2, v2
    v_add_u32 v10, s28, v10
    v_mul_u32_u24 v10, 18, v10
    v_and_b32 v11, 1, v4
    v_add3_u32 v10, v10, v11, 16
    v_and_b32 v11, 1, v2
    v_lshlrev_b32 v11, 4, v11
    v_sub_u32 v10, v10, v11
    v_lshl_add_u32 v10, v3, 16, v10
    s_cmp_eq_u32 s22, 4
    s_cselect_b64 s[30:31], -1, 0
    v_cndmask_b32 v9, v9, v10, s[30:31]
    v_mul_u32_u24 v9, 1152, v9
    v_lshl_add_u32 v9, v6, 4, v9
    s_mul_i32 s25, s23, 288
    s_lshl_b32 s28, s3, 5
    s_add_u32 s25, s25, s28
    s_add_u32 m0, s33, 1024
    s_nop 0
    buffer_load_dwordx4 v9, s[8:11], s25 offen  lds
    s_sub_u32 s20, s2, 264
    s_lshl_b32 s20, s20, 2
    s_add_u32 s20, s20, 2
    s_mul_i32 s21, s20, 205
    s_lshr_b32 s21, s21, 10
    s_mul_i32 s22, s21, 5
    s_sub_u32 s22, s20, s22
    s_lshr_b32 s23, s21, 2
    s_and_b32 s24, s21, 3
    s_mul_i32 s38, s20, 9
    s_add_u32 s38, s38, s3
    s_lshl_b32 s38, s38, 10
    s_add_u32 s38, s38, 2064384
    v_mul_u32_u24 v9, 20, v3
    v_lshl_add_u32 v9, v2, 2, v9
    v_add_u32 v9, v9, v4
    s_lshl_b32 s25, s22, 1
    s_lshl_b32 s28, s24, 3
    s_add_u32 s25, s25, s28
    s_mul_i32 s25, s25, 18
    v_add_u32 v9, s25, v9
    v_lshrrev_b32 v10, 1, v4
    v_lshl_add_u32 v10, v10, 2, v2
    v_add_u32 v10, s28, v10
    v_mul_u32_u24 v10, 18, v10
    v_and_b32 v11, 1, v4
    v_add3_u32 v10, v10, v11, 16
    v_and_b32 v11, 1, v2
    v_lshlrev_b32 v11, 4, v11
    v_sub_u32 v10, v10, v11
    v_lshl_add_u32 v10, v3, 16, v10
    s_cmp_eq_u32 s22, 4
    s_cselect_b64 s[30:31], -1, 0
    v_cndmask_b32 v9, v9, v10, s[30:31]
    v_mul_u32_u24 v9, 1152, v9
    v_lshl_add_u32 v9, v6, 4, v9
    s_mul_i32 s25, s23, 288
    s_lshl_b32 s28, s3, 5
    s_add_u32 s25, s25, s28
    s_add_u32 m0, s33, 2048
    s_nop 0
    buffer_load_dwordx4 v9, s[8:11], s25 offen  lds
    s_sub_u32 s20, s2, 264
    s_lshl_b32 s20, s20, 2
    s_add_u32 s20, s20, 3
    s_mul_i32 s21, s20, 205
    s_lshr_b32 s21, s21, 10
    s_mul_i32 s22, s21, 5
    s_sub_u32 s22, s20, s22
    s_lshr_b32 s23, s21, 2
    s_and_b32 s24, s21, 3
    s_mul_i32 s39, s20, 9
    s_add_u32 s39, s39, s3
    s_lshl_b32 s39, s39, 10
    s_add_u32 s39, s39, 2064384
    v_mul_u32_u24 v9, 20, v3
    v_lshl_add_u32 v9, v2, 2, v9
    v_add_u32 v9, v9, v4
    s_lshl_b32 s25, s22, 1
    s_lshl_b32 s28, s24, 3
    s_add_u32 s25, s25, s28
    s_mul_i32 s25, s25, 18
    v_add_u32 v9, s25, v9
    v_lshrrev_b32 v10, 1, v4
    v_lshl_add_u32 v10, v10, 2, v2
    v_add_u32 v10, s28, v10
    v_mul_u32_u24 v10, 18, v10
    v_and_b32 v11, 1, v4
    v_add3_u32 v10, v10, v11, 16
    v_and_b32 v11, 1, v2
    v_lshlrev_b32 v11, 4, v11
    v_sub_u32 v10, v10, v11
    v_lshl_add_u32 v10, v3, 16, v10
    s_cmp_eq_u32 s22, 4
    s_cselect_b64 s[30:31], -1, 0
    v_cndmask_b32 v9, v9, v10, s[30:31]
    v_mul_u32_u24 v9, 1152, v9
    v_lshl_add_u32 v9, v6, 4, v9
    s_mul_i32 s25, s23, 288
    s_lshl_b32 s28, s3, 5
    s_add_u32 s25, s25, s28
    s_add_u32 m0, s33, 3072
    s_nop 0
    buffer_load_dwordx4 v9, s[8:11], s25 offen  lds
    s_waitcnt vmcnt(0)
    ds_read_b64_tr_b16 v[16:17], v8 offset:0
    ds_read_b64_tr_b16 v[18:19], v8 offset:256
    ds_read_b64_tr_b16 v[20:21], v8 offset:1024
    ds_read_b64_tr_b16 v[22:23], v8 offset:1280
    ds_read_b64_tr_b16 v[24:25], v8 offset:2048
    ds_read_b64_tr_b16 v[26:27], v8 offset:2304
    ds_read_b64_tr_b16 v[28:29], v8 offset:3072
    ds_read_b64_tr_b16 v[30:31], v8 offset:3328
    s_waitcnt lgkmcnt(6)
    buffer_store_dwordx4 v[16:19], v5, s[12:15], s36 offen
    s_waitcnt lgkmcnt(4)
    buffer_store_dwordx4 v[20:23], v5, s[12:15], s37 offen
    s_waitcnt lgkmcnt(2)
    buffer_store_dwordx4 v[24:27], v5, s[12:15], s38 offen
    s_waitcnt lgkmcnt(0)
    buffer_store_dwordx4 v[28:31], v5, s[12:15], s39 offen
    s_endpgm
SK_k0_31:
    s_mov_b32 s8, s40
    s_mov_b32 s9, s41
    s_mov_b32 s10, 1990656
    s_mov_b32 s11, 0x20000
    s_mul_i32 s33, s3, 5120
    s_sub_u32 s20, s2, 216
    s_and_b32 s21, s20, 1
    s_lshr_b32 s22, s20, 4
    s_bfe_u32 s23, s20, 0x30001
    s_mul_i32 s24, s21, 9
    s_add_u32 s24, s24, s3
    s_mul_i32 s25, s24, 110592
    s_mul_i32 s26, s22, 1152
    s_add_u32 s25, s25, s26
    s_mul_i32 s26, s23, 144
    s_add_u32 s25, s25, s26
    v_mov_b32 v11, 1073741824
    v_add_u32 v9, 0, v1
    v_mul_u32_u24 v10, 7282, v9
    v_lshrrev_b32 v10, 16, v10
    v_mul_u32_u24 v12, 9, v10
    v_sub_u32 v9, v9, v12
    v_mul_u32_u24 v10, 3456, v10
    v_lshl_add_u32 v9, v9, 4, v10
    s_add_u32 m0, s33, 0
    s_nop 0
    buffer_load_dwordx4 v9, s[8:11], s25 offen  lds
    v_add_u32 v9, 64, v1
    v_mul_u32_u24 v10, 7282, v9
    v_lshrrev_b32 v10, 16, v10
    v_mul_u32_u24 v12, 9, v10
    v_sub_u32 v9, v9, v12
    v_mul_u32_u24 v10, 3456, v10
    v_lshl_add_u32 v9, v9, 4, v10
    s_add_u32 m0, s33, 1024
    s_nop 0
    buffer_load_dwordx4 v9, s[8:11], s25 offen  lds
    v_add_u32 v9, 128, v1
    v_mul_u32_u24 v10, 7282, v9
    v_lshrrev_b32 v10, 16, v10
    v_mul_u32_u24 v12, 9, v10
    v_sub_u32 v9, v9, v12
    v_mul_u32_u24 v10, 3456, v10
    v_lshl_add_u32 v9, v9, 4, v10
    s_add_u32 m0, s33, 2048
    s_nop 0
    buffer_load_dwordx4 v9, s[8:11], s25 offen  lds
    v_add_u32 v9, 192, v1
    v_mul_u32_u24 v10, 7282, v9
    v_lshrrev_b32 v10, 16, v10
    v_mul_u32_u24 v12, 9, v10
    v_sub_u32 v9, v9, v12
    v_mul_u32_u24 v10, 3456, v10
    v_lshl_add_u32 v9, v9, 4, v10
    s_add_u32 m0, s33, 3072
    s_nop 0
    buffer_load_dwordx4 v9, s[8:11], s25 offen  lds
    v_add_u32 v9, 256, v1
    v_mul_u32_u24 v10, 7282, v9
    v_lshrrev_b32 v10, 16, v10
    v_mul_u32_u24 v12, 9, v10
    v_sub_u32 v9, v9, v12
    v_mul_u32_u24 v10, 3456, v10
    v_lshl_add_u32 v9, v9, 4, v10
    v_cmp_gt_u32 vcc, 32, v1
    s_nop 1
    v_cndmask_b32 v9, v11, v9, vcc
    s_add_u32 m0, s33, 4096
    s_nop 0
    buffer_load_dwordx4 v9, s[8:11], s25 offen  lds
    v_lshrrev_b32 v8, 4, v1
    v_bfe_u32 v9, v1, 2, 2
    v_lshl_add_u32 v8, v8, 3, v9
    v_mul_u32_u24 v8, 144, v8
    v_add_u32 v8, s33, v8
    v_and_b32 v9, 1, v1
    v_mul_u32_u24 v9, 72, v9
    v_add_u32 v10, v8, v9
    v_and_b32 v9, 3, v1
    v_lshl_add_u32 v8, v9, 3, v8
    v_mov_b32 v12, 0x3f803f80
    v_mov_b32 v13, 0x3f803f80
    v_mov_b32 v14, 0x3f803f80
    v_mov_b32 v15, 0x3f803f80
    s_mul_i32 s26, s23, 258048
    s_add_u32 s26, s26, 0
    s_mul_i32 s27, s24, 3
    s_add_u32 s27, s27, 72
    s_lshl_b32 s28, s24, 2
    s_lshl_b32 s29, s22, 1
    s_add_u32 s28, s28, s29
    s_sub_u32 s28, s28, 2
    s_add_u32 s29, s27, 1
    s_cmp_eq_u32 s22, 0
    s_cselect_b32 s28, s29, s28
    s_lshl_b32 s28, s28, 10
    s_add_u32 s28, s28, s26
    s_add_u32 s29, s28, 129024
    s_lshl_b32 s27, s27, 10
    s_add_u32 s27, s27, s26
    s_lshl_b32 s30, s22, 6
    s_add_u32 s27, s27, s30
    v_and_b32 v7, 15, v1
    v_lshrrev_b32 v6, 4, v1
    v_lshlrev_b32 v6, 8, v6
    v_and_b32 v9, 3, v1
    v_lshl_add_u32 v6, v9, 4, v6
    v_bfe_u32 v9, v1, 2, 1
    v_mul_u32_u24 v9, 129024, v9
    v_add_u32 v6, v6, v9
    v_add_u32 v9, 192, v6
    s_cmp_eq_u32 s22, 0
    s_cselect_b32 s30, 0, 1073741824
    v_add_u32 v9, s30, v9
    v_cmp_gt_u32 s[34:35], 8, v7
    s_nop 1
    v_cndmask_b32 v6, v9, v6, s[34:35]
    s_waitcnt vmcnt(0)
    ds_read_b64_tr_b16 v[16:17], v8 offset:0
    ds_read_b64_tr_b16 v[18:19], v8 offset:576
    ds_read_b64_tr_b16 v[20:21], v8 offset:40
    ds_read_b64_tr_b16 v[22:23], v8 offset:616
    ds_read_b64_tr_b16 v[24:25], v8 offset:72
    ds_read_b64_tr_b16 v[26:27], v8 offset:648
    ds_read_b64_tr_b16 v[28:29], v8 offset:112
    ds_read_b64_tr_b16 v[30:31], v8 offset:688
    ds_read_b64_tr_b16 v[32:33], v10 offset:32
    ds_read_b64_tr_b16 v[34:35], v10 offset:608
    s_waitcnt lgkmcnt(8)
    buffer_store_dwordx4 v[16:19], v5, s[12:15], s28 offen offset:0
    v_mfma_f32_16x16x32_bf16 v[36:39], v[16:19], v[12:15], 0
    s_waitcnt lgkmcnt(6)
    buffer_store_dwordx4 v[20:23], v5, s[12:15], s28 offen offset:1024
    v_mfma_f32_16x16x32_bf16 v[40:43], v[20:23], v[12:15], 0
    s_waitcnt lgkmcnt(4)
    buffer_store_dwordx4 v[24:27], v5, s[12:15], s29 offen offset:0
    v_mfma_f32_16x16x32_bf16 v[44:47], v[24:27], v[12:15], 0
    s_waitcnt lgkmcnt(2)
    buffer_store_dwordx4 v[28:31], v5, s[12:15], s29 offen offset:1024
    v_mfma_f32_16x16x32_bf16 v[48:51], v[28:31], v[12:15], 0
    s_waitcnt lgkmcnt(1)
    v_cndmask_b32 v32, 0, v32, s[34:35]
    v_cndmask_b32 v33, 0, v33, s[34:35]
    s_waitcnt lgkmcnt(0)
    v_cndmask_b32 v34, 0, v34, s[34:35]
    v_cndmask_b32 v35, 0, v35, s[34:35]
    buffer_store_dwordx4 v[32:35], v6, s[12:15], s27 offen
    s_nop 0
    v_mfma_f32_16x16x32_bf16 v[52:55], v[32:35], v[12:15], 0
    v_lshrrev_b32 v6, 4, v1
    v_lshlrev_b32 v6, 4, v6
    v_add_u32 v6, s33, v6
    v_cmp_eq_u32 vcc, 0, v7
    s_nop 0
    s_and_saveexec_b64 s[36:37], vcc
    ds_write_b128 v6, v[36:39] offset:0
    ds_write_b128 v6, v[40:43] offset:64
    ds_write_b128 v6, v[44:47] offset:128
    ds_write_b128 v6, v[48:51] offset:192
    ds_write_b128 v6, v[52:55] offset:256
    s_mov_b64 exec, s[36:37]
    s_waitcnt lgkmcnt(0)
    s_barrier
    s_cmp_lt_u32 s3, 2
    s_cbranch_scc0 SK_k0_32
    v_lshlrev_b32 v6, 2, v0
    ds_read_b32 v16, v6 offset:0
    ds_read_b32 v17, v6 offset:5120
    ds_read_b32 v18, v6 offset:10240
    ds_read_b32 v19, v6 offset:15360
    ds_read_b32 v20, v6 offset:20480
    ds_read_b32 v21, v6 offset:25600
    ds_read_b32 v22, v6 offset:30720
    ds_read_b32 v23, v6 offset:35840
    ds_read_b32 v24, v6 offset:40960
    s_waitcnt lgkmcnt(7)
    v_add_f32 v16, v16, v17
    s_waitcnt lgkmcnt(6)
    v_add_f32 v16, v16, v18
    s_waitcnt lgkmcnt(5)
    v_add_f32 v16, v16, v19
    s_waitcnt lgkmcnt(4)
    v_add_f32 v16, v16, v20
    s_waitcnt lgkmcnt(3)
    v_add_f32 v16, v16, v21
    s_waitcnt lgkmcnt(2)
    v_add_f32 v16, v16, v22
    s_waitcnt lgkmcnt(1)
    v_add_f32 v16, v16, v23
    s_waitcnt lgkmcnt(0)
    v_add_f32 v16, v16, v24
    s_mul_i32 s26, s23, 896
    s_mul_i32 s27, s21, 7168
    s_add_u32 s26, s26, s27
    s_add_u32 s26, s26, 18837504
    s_lshl_b32 s27, s22, 7
    s_sub_u32 s27, s27, 128
    s_cmp_eq_u32 s22, 0
    s_cselect_b32 s27, 320, s27
    v_lshrrev_b32 v8, 5, v1
    v_mul_u32_u24 v8, 448, v8
    v_and_b32 v9, 31, v1
    v_lshl_add_u32 v8, v9, 2, v8
    v_add_u32 v8, s27, v8
    v_bfe_u32 v9, v1, 2, 1
    v_mul_u32_u24 v9, 448, v9
    v_and_b32 v10, 3, v1
    v_lshl_add_u32 v9, v10, 2, v9
    s_lshl_b32 s27, s22, 4
    s_add_u32 s27, s27, 256
    s_add_u32 s28, s30, 304
    v_add_u32 v10, s27, v9
    v_add_u32 v9, s28, v9
    v_cndmask_b32 v9, v9, v10, s[34:35]
    v_cmp_gt_u32 vcc, 16, v1
    s_nop 1
    v_cndmask_b32 v9, v11, v9, vcc
    s_cmp_eq_u32 s3, 0
    s_cselect_b64 s[36:37], -1, 0
    v_cndmask_b32 v8, v9, v8, s[36:37]
    buffer_store_dword v16, v8, s[12:15], s26 offen
SK_k0_32:
    s_endpgm
SK_k0_30:
    s_cmp_ge_u32 s2, 72
    s_cselect_b32 s30, 1, 0
    s_waitcnt lgkmcnt(0)
    s_cselect_b32 s8, s46, s44
    s_cselect_b32 s9, s47, s45
    s_mov_b32 s10, 5308416
    s_mov_b32 s11, 0x20000
    s_mul_i32 s31, s30, 72
    s_sub_u32 s31, s2, s31
    s_mov_b32 s20, 9216
    s_mul_i32 s52, s51, 9
    s_add_u32 s52, s52, s3
    s_mul_i32 s21, s52, 294912
    s_lshl_b32 s22, s31, 7
    s_add_u32 s21, s21, s22
    s_mul_i32 s22, s31, 147456
    s_lshl_b32 s23, s52, 11
    s_add_u32 s22, s22, s23
    s_lshl_b32 s23, s30, 10
    s_add_u32 s22, s22, s23
    s_add_u32 s24, s22, 2801664
    s_add_u32 s25, s22, 2838528
    s_add_u32 s26, s22, 2875392
    s_add_u32 s27, s22, 2912256
    s_mov_b32 s28, 2048
    s_mov_b32 s50, 73728
    s_lshl_b32 s29, s31, 9
    s_lshl_b32 s23, s30, 6
    s_add_u32 s29, s29, s23
    s_mul_i32 s23, s51, 36864
    s_add_u32 s29, s29, s23
    s_add_u32 s29, s29, 18763776
    s_cmp_ge_u32 s2, 144
    s_cbranch_scc0 SK_k0_33
    s_sub_u32 s31, s2, 144
    s_lshr_b32 s22, s31, 2
    s_mul_i32 s22, s22, 14
    s_add_u32 s31, s31, s22
    s_mov_b32 s8, s48
    s_mov_b32 s9, s49
    s_mov_b32 s20, 1152
    s_mul_i32 s22, s31, 3641
    s_lshr_b32 s22, s22, 16
    s_mul_i32 s23, s22, 18
    s_sub_u32 s23, s31, s23
    s_lshl_b32 s32, s22, 3
    s_and_b32 s35, s23, 1
    s_lshl_b32 s35, s35, 2
    s_add_u32 s32, s32, s35
    s_mul_i32 s32, s32, 9
    s_lshr_b32 s35, s23, 1
    s_add_u32 s32, s32, s35
    s_mul_i32 s35, s51, 18
    s_add_u32 s32, s32, s35
    s_mul_i32 s21, s32, 18432
    s_lshl_b32 s22, s3, 7
    s_add_u32 s21, s21, s22
    s_mov_b32 s50, 156672
    s_lshl_b32 s22, s3, 2
    s_add_u32 s22, s22, 0
    s_mul_i32 s23, s22, 57
    s_lshr_b32 s23, s23, 9
    s_mul_i32 s32, s23, 9
    s_sub_u32 s22, s22, s32
    s_mul_i32 s23, s23, 144
    s_lshl_b32 s32, s31, 1
    s_add_u32 s23, s23, s32
    s_add_u32 s23, s23, s51
    s_mul_i32 s23, s23, 9
    s_add_u32 s23, s23, s22
    s_lshl_b32 s23, s23, 10
    s_add_u32 s24, s23, 13418496
    s_lshl_b32 s22, s3, 2
    s_add_u32 s22, s22, 1
    s_mul_i32 s23, s22, 57
    s_lshr_b32 s23, s23, 9
    s_mul_i32 s32, s23, 9
    s_sub_u32 s22, s22, s32
    s_mul_i32 s23, s23, 144
    s_lshl_b32 s32, s31, 1
    s_add_u32 s23, s23, s32
    s_add_u32 s23, s23, s51
    s_mul_i32 s23, s23, 9
    s_add_u32 s23, s23, s22
    s_lshl_b32 s23, s23, 10
    s_add_u32 s25, s23, 13418496
    s_lshl_b32 s22, s3, 2
    s_add_u32 s22, s22, 2
    s_mul_i32 s23, s22, 57
    s_lshr_b32 s23, s23, 9
    s_mul_i32 s32, s23, 9
    s_sub_u32 s22, s22, s32
    s_mul_i32 s23, s23, 144
    s_lshl_b32 s32, s31, 1
    s_add_u32 s23, s23, s32
    s_add_u32 s23, s23, s51
    s_mul_i32 s23, s23, 9
    s_add_u32 s23, s23, s22
    s_lshl_b32 s23, s23, 10
    s_add_u32 s26, s23, 13418496
    s_lshl_b32 s22, s3, 2
    s_add_u32 s22, s22, 3
    s_mul_i32 s23, s22, 57
    s_lshr_b32 s23, s23, 9
    s_mul_i32 s32, s23, 9
    s_sub_u32 s22, s22, s32
    s_mul_i32 s23, s23, 144
    s_lshl_b32 s32, s31, 1
    s_add_u32 s23, s23, s32
    s_add_u32 s23, s23, s51
    s_mul_i32 s23, s23, 9
    s_add_u32 s23, s23, s22
    s_lshl_b32 s23, s23, 10
    s_add_u32 s27, s23, 13418496
    s_mov_b32 s28, 9216
    s_mov_b32 s29, 1073741824
SK_k0_33:
    s_mov_b32 s12, s4
    s_mov_b32 s13, s5
    s_mov_b32 s14, 94371840
    s_mov_b32 s15, 0x20000
    v_lshrrev_b32 v2, 3, v1
    v_mul_lo_u32 v2, s20, v2
    v_bfe_u32 v3, v1, 4, 1
    v_lshlrev_b32 v3, 1, v3
    v_and_b32 v4, 7, v1
    v_xor_b32 v3, v3, v4
    v_lshl_add_u32 v2, v3, 4, v2
    v_xor_b32 v3, 64, v2
    s_lshl_b32 s33, s3, 12
    s_lshl_b32 s34, s20, 3
    s_add_u32 m0, s33, 0
    s_nop 0
    buffer_load_dwordx4 v2, s[8:11], s21 offen nt lds
    s_add_u32 s21, s21, s34
    s_add_u32 m0, s33, 1024
    s_nop 0
    buffer_load_dwordx4 v3, s[8:11], s21 offen nt lds
    s_add_u32 s21, s21, s50
    s_add_u32 m0, s33, 2048
    s_nop 0
    buffer_load_dwordx4 v2, s[8:11], s21 offen nt lds
    s_add_u32 s21, s21, s34
    s_add_u32 m0, s33, 3072
    s_nop 0
    buffer_load_dwordx4 v3, s[8:11], s21 offen nt lds
    v_lshrrev_b32 v4, 4, v1
    v_bfe_u32 v5, v1, 2, 2
    v_lshl_add_u32 v6, v4, 3, v5
    v_lshlrev_b32 v6, 7, v6
    v_add_u32 v6, s33, v6
    v_and_b32 v7, 1, v1
    v_lshl_add_u32 v6, v7, 4, v6
    v_bfe_u32 v7, v1, 1, 1
    v_lshl_add_u32 v6, v7, 3, v6
    v_bfe_u32 v7, v1, 3, 1
    v_bfe_u32 v5, v1, 4, 1
    v_lshl_or_b32 v7, v5, 1, v7
    v_xor_b32 v5, 0, v7
    v_lshl_add_u32 v8, v5, 5, v6
    v_xor_b32 v5, 1, v7
    v_lshl_add_u32 v9, v5, 5, v6
    v_xor_b32 v5, 2, v7
    v_lshl_add_u32 v10, v5, 5, v6
    v_xor_b32 v5, 3, v7
    v_lshl_add_u32 v11, v5, 5, v6
    v_mov_b32 v12, 0x3f803f80
    v_mov_b32 v13, 0x3f803f80
    v_mov_b32 v14, 0x3f803f80
    v_mov_b32 v15, 0x3f803f80
    v_lshlrev_b32 v5, 4, v1
    s_waitcnt vmcnt(0)
    ds_read_b64_tr_b16 v[16:17], v8 offset:0
    ds_read_b64_tr_b16 v[18:19], v8 offset:512
    ds_read_b64_tr_b16 v[20:21], v9 offset:0
    ds_read_b64_tr_b16 v[22:23], v9 offset:512
    ds_read_b64_tr_b16 v[24:25], v10 offset:0
    ds_read_b64_tr_b16 v[26:27], v10 offset:512
    ds_read_b64_tr_b16 v[28:29], v11 offset:0
    ds_read_b64_tr_b16 v[30:31], v11 offset:512
    s_waitcnt lgkmcnt(6)
    buffer_store_dwordx4 v[16:19], v5, s[12:15], s24 offen
    v_mfma_f32_16x16x32_bf16 v[48:51], v[16:19], v[12:15], 0
    s_waitcnt lgkmcnt(4)
    buffer_store_dwordx4 v[20:23], v5, s[12:15], s25 offen
    v_mfma_f32_16x16x32_bf16 v[52:55], v[20:23], v[12:15], 0
    s_waitcnt lgkmcnt(2)
    buffer_store_dwordx4 v[24:27], v5, s[12:15], s26 offen
    v_mfma_f32_16x16x32_bf16 v[56:59], v[24:27], v[12:15], 0
    s_waitcnt lgkmcnt(0)
    buffer_store_dwordx4 v[28:31], v5, s[12:15], s27 offen
    v_mfma_f32_16x16x32_bf16 v[60:63], v[28:31], v[12:15], 0
    v_lshlrev_b32 v6, 4, v4
    v_add_u32 v6, s33, v6
    v_and_b32 v7, 15, v1
    v_cmp_eq_u32 vcc, 0, v7
    s_nop 0
    s_and_saveexec_b64 s[36:37], vcc
    ds_write_b128 v6, v[48:51] offset:0
    ds_write_b128 v6, v[52:55] offset:64
    ds_write_b128 v6, v[56:59] offset:128
    ds_write_b128 v6, v[60:63] offset:192
    s_mov_b64 exec, s[36:37]
    s_waitcnt lgkmcnt(0)
    s_barrier
    s_cmp_eq_u32 s3, 0
    s_cbranch_scc0 SK_k0_34
    v_lshlrev_b32 v6, 2, v1
    ds_read_b32 v16, v6 offset:0
    ds_read_b32 v17, v6 offset:4096
    ds_read_b32 v18, v6 offset:8192
    ds_read_b32 v19, v6 offset:12288
    ds_read_b32 v20, v6 offset:16384
    ds_read_b32 v21, v6 offset:20480
    ds_read_b32 v22, v6 offset:24576
    ds_read_b32 v23, v6 offset:28672
    ds_read_b32 v24, v6 offset:32768
    s_waitcnt lgkmcnt(7)
    v_add_f32 v16, v16, v17
    s_waitcnt lgkmcnt(6)
    v_add_f32 v16, v16, v18
    s_waitcnt lgkmcnt(5)
    v_add_f32 v16, v16, v19
    s_waitcnt lgkmcnt(4)
    v_add_f32 v16, v16, v20
    s_waitcnt lgkmcnt(3)
    v_add_f32 v16, v16, v21
    s_waitcnt lgkmcnt(2)
    v_add_f32 v16, v16, v22
    s_waitcnt lgkmcnt(1)
    v_add_f32 v16, v16, v23
    s_waitcnt lgkmcnt(0)
    v_add_f32 v16, v16, v24
    v_lshlrev_b32 v7, 7, v4
    v_and_b32 v8, 15, v1
    v_lshl_add_u32 v7, v8, 2, v7
    buffer_store_dword v16, v7, s[12:15], s29 offen
SK_k0_34:
    s_endpgm
k0_code_end:
.globl mk_kernel
.p2align 8
.type mk_kernel,@function
mk_kernel:
    s_load_dwordx2 s[62:63], s[0:1], 56
    s_load_dwordx2 s[100:101], s[0:1], 48
    s_load_dwordx2 s[4:5], s[0:1], 72
    v_lshrrev_b32 v1, 6, v0
    s_nop 0
    v_readfirstlane_b32 s3, v1
    v_and_b32 v1, 63, v0
    s_cmp_ge_u32 s2, 256
    s_cbranch_scc0 SK_mk_1
    s_endpgm
SK_mk_1:
    s_and_b32 s6, s2, 7
    s_lshr_b32 s7, s2, 3
    v_lshlrev_b32 v2, 4, v1
    s_mov_b32 s41, 4096
    s_mov_b32 s42, 8192
    s_mov_b32 s43, 12288
    s_mov_b32 s44, 16384
    s_mov_b32 s45, 20480
    s_mov_b32 s46, 24576
    s_mov_b32 s47, 28672
    s_mov_b32 s48, 32768
    s_mov_b32 s49, 36864
    s_mov_b32 s50, 40960
    s_mov_b32 s51, 45056
    s_getpc_b64 s[20:21]
PC_mk_2:
    s_add_u32 s20, s20, mk_kernel-PC_mk_2
    s_addc_u32 s21, s21, -1
    s_lshl_b32 s22, s7, 1
    s_add_u32 s22, s22, s3
    s_cmp_lt_u32 s3, 2
    s_cselect_b32 s22, s22, 0
    s_cmp_lt_u32 s22, (mk_code_end-mk_kernel)>>10
    s_cselect_b32 s22, s22, 0
    s_lshl_b32 s22, s22, 10
    s_add_u32 s20, s20, s22
    s_addc_u32 s21, s21, 0
    v_lshlrev_b32 v202, 4, v1
    v_mov_b32 v201, s21
    v_add_co_u32 v200, vcc, s20, v202
    s_nop 1
    v_addc_co_u32 v201, vcc, 0, v201, vcc
    global_load_dwordx4 v[204:207], v[200:201], off
    s_waitcnt lgkmcnt(0)
    s_add_u32 s76, s4, 18726912
    s_addc_u32 s77, s5, 0
    s_mov_b32 s78, 110592
    s_mov_b32 s79, 0x20000
    s_lshl_b32 s80, s2, 2
    s_add_u32 s80, s80, s3
    s_mul_i32 s80, s80, 36
    v_lshlrev_b32 v242, 2, v1
    v_mov_b32 v11, 1073741824
    v_cmp_gt_u32 vcc, 9, v1
    s_nop 1
    v_cndmask_b32 v242, v11, v242, vcc
    s_add_u32 s25, s80, 36864
    s_add_u32 s26, s25, 36864
    buffer_load_dword v240, v242, s[76:79], s25 offen
    buffer_load_dword v241, v242, s[76:79], s26 offen
    s_and_b32 s20, s6, 3
    s_lshl_b32 s20, s20, 2
    s_and_b32 s21, s7, 3
    s_add_u32 s20, s20, s21
    s_lshr_b32 s21, s6, 2
    s_lshl_b32 s21, s21, 3
    s_lshr_b32 s22, s7, 2
    s_add_u32 s21, s21, s22
    s_mul_i32 s22, s21, 129024
    s_add_u32 s22, s22, 0
    s_add_u32 s8, s4, s22
    s_addc_u32 s9, s5, 0
    s_mov_b32 s10, 129024
    s_mov_b32 s11, 0x20000
    s_lshl_b32 s26, s3, 12
    s_add_u32 m0, s26, 0
    s_nop 0
    buffer_load_dwordx4 v2, s[8:11], m0 offen offset:0 lds
    buffer_load_dwordx4 v2, s[8:11], m0 offen offset:1024 lds
    buffer_load_dwordx4 v2, s[8:11], m0 offen offset:2048 lds
    buffer_load_dwordx4 v2, s[8:11], m0 offen offset:3072 lds
    s_add_u32 m0, s26, 16384
    s_nop 0
    buffer_load_dwordx4 v2, s[8:11], m0 offen offset:0 lds
    buffer_load_dwordx4 v2, s[8:11], m0 offen offset:1024 lds
    buffer_load_dwordx4 v2, s[8:11], m0 offen offset:2048 lds
    buffer_load_dwordx4 v2, s[8:11], m0 offen offset:3072 lds
    s_add_u32 m0, s26, 81920
    s_nop 0
    buffer_load_dwordx4 v2, s[8:11], m0 offen offset:0 lds
    buffer_load_dwordx4 v2, s[8:11], m0 offen offset:1024 lds
    buffer_load_dwordx4 v2, s[8:11], m0 offen offset:2048 lds
    buffer_load_dwordx4 v2, s[8:11], m0 offen offset:3072 lds
    s_add_u32 m0, s26, 98304
    s_nop 0
    buffer_load_dwordx4 v2, s[8:11], m0 offen offset:0 lds
    buffer_load_dwordx4 v2, s[8:11], m0 offen offset:1024 lds
    buffer_load_dwordx4 v2, s[8:11], m0 offen offset:2048 lds
    buffer_load_dwordx4 v2, s[8:11], m0 offen offset:3072 lds
    s_add_u32 m0, s26, 114688
    s_nop 0
    buffer_load_dwordx4 v2, s[8:11], m0 offen offset:0 lds
    buffer_load_dwordx4 v2, s[8:11], m0 offen offset:1024 lds
    buffer_load_dwordx4 v2, s[8:11], m0 offen offset:2048 lds
    buffer_load_dwordx4 v2, s[8:11], m0 offen offset:3072 lds
    s_add_u32 s58, s4, 18874368
    s_addc_u32 s59, s5, 0
    s_mov_b32 s60, 2
.p2align 2
LP_mk_3:
    s_add_u32 s96, s58, 2539520
    s_addc_u32 s97, s59, 0
    s_mov_b32 s98, 37947392
    s_mov_b32 s99, 0x20000
    s_and_b32 s20, s6, 3
    s_lshl_b32 s20, s20, 2
    s_and_b32 s21, s7, 3
    s_add_u32 s20, s20, s21
    s_lshr_b32 s21, s6, 2
    s_lshl_b32 s21, s21, 3
    s_lshr_b32 s22, s7, 2
    s_add_u32 s21, s21, s22
    s_mul_i32 s22, s21, 129024
    s_add_u32 s22, s22, 0
    s_add_u32 s8, s4, s22
    s_addc_u32 s9, s5, 0
    s_mov_b32 s10, 129024
    s_mov_b32 s11, 0x20000
    s_lshl_b32 s26, s3, 12
    s_lshl_b32 s23, s20, 3
    s_lshl_b32 s24, s3, 1
    s_add_u32 s23, s23, s24
    s_mul_i32 s24, s23, 18432
    s_add_u32 s24, s24, 0
    s_add_u32 s12, s58, s24
    s_addc_u32 s13, s59, 0
    s_mov_b32 s14, 36864
    s_mov_b32 s15, 0x20000
    v_add_u32 v3, 18432, v2
    s_lshl_b32 s24, s23, 10
    s_add_u32 s24, s24, 2359296
    s_add_u32 s16, s58, s24
    s_addc_u32 s17, s59, 0
    s_mov_b32 s18, 2048
    s_mov_b32 s19, 0x20000
    s_mul_i32 s24, s21, 448
    s_add_u32 s24, s24, 18837504
    s_add_u32 s28, s4, s24
    s_addc_u32 s29, s5, 0
    s_mov_b32 s30, 7616
    s_mov_b32 s31, 0x20000
    s_mov_b32 s25, 7168
    v_lshrrev_b32 v4, 4, v1
    v_and_b32 v5, 15, v1
    v_lshlrev_b32 v6, 2, v5
    v_lshlrev_b32 v7, 4, v4
    s_mov_b64 exec, 0xfffffff
    buffer_load_dwordx4 v[224:227], v2, s[28:31], 0 offen
    buffer_load_dwordx4 v[228:231], v2, s[28:31], s25 offen
    s_mov_b64 exec, -1
    s_mul_i32 s24, s21, 3072
    s_add_u32 s24, s24, 2490368
    s_add_u32 s32, s58, s24
    s_addc_u32 s33, s59, 0
    s_mov_b32 s34, 3072
    s_mov_b32 s35, 0x20000
    v_mov_b32 v9, 1073741824
    s_lshl_b32 s24, s3, 6
    v_add_u32 v0, s24, v1
    v_add_u32 v10, 0, v0
    v_cmp_le_u32 vcc, 384, v10
    s_nop 1
    v_cndmask_b32 v11, 0, 1, vcc
    v_mul_u32_u24 v12, 384, v11
    s_add_u32 m0, s26, 32768
    v_sub_u32 v12, v10, v12
    v_mul_u32_u24 v13, 3277, v12
    v_lshrrev_b32 v13, 16, v13
    v_mul_u32_u24 v14, 20, v13
    v_sub_u32 v14, v12, v14
    buffer_load_dwordx4 v2, s[8:11], m0 offen offset:0 lds
    v_cmp_le_u32 s[36:37], 16, v14
    v_cmp_le_u32 s[38:39], 16, v13
    v_lshl_add_u32 v15, v11, 1, v14
    v_subrev_u32 v15, 12, v15
    v_cndmask_b32 v15, v14, v15, s[36:37]
    v_lshl_add_u32 v16, v11, 1, v13
    v_subrev_u32 v16, 8, v16
    buffer_load_dwordx4 v2, s[8:11], m0 offen offset:1024 lds
    v_cmp_eq_u32 vcc, 18, v13
    s_nop 1
    v_cndmask_b32 v16, v16, 12, vcc
    v_cndmask_b32 v16, v13, v16, s[38:39]
    v_cndmask_b32 v17, 0, 2, s[38:39]
    v_cndmask_b32 v18, 0, 4, s[36:37]
    v_add3_u32 v17, v17, v18, v11
    v_min_u32 v17, 6, v17
    buffer_load_dwordx4 v2, s[8:11], m0 offen offset:2048 lds
    v_lshrrev_b32 v18, 2, v15
    v_lshl_add_u32 v18, v18, 4, v16
    v_lshlrev_b32 v18, 4, v18
    v_lshl_add_u32 v18, v17, 10, v18
    v_and_b32 v15, 3, v15
    v_lshl_add_u32 v18, v15, 2, v18
    v_and_b32 v18, 0x1fff, v18
    v_add_u32 v164, 131072, v18
    buffer_load_dwordx4 v2, s[8:11], m0 offen offset:3072 lds
    v_cmp_gt_u32 s[36:37], 18, v14
    v_cmp_gt_u32 s[38:39], 19, v13
    s_nop 0
    s_and_b64 s[36:37], s[36:37], s[38:39]
    v_lshlrev_b32 v10, 2, v10
    v_cndmask_b32 v167, v9, v10, s[36:37]
    v_add_u32 v10, 256, v0
    v_cmp_le_u32 vcc, 384, v10
    s_nop 1
    v_cndmask_b32 v11, 0, 1, vcc
    v_mul_u32_u24 v12, 384, v11
    s_add_u32 m0, s26, 49152
    v_sub_u32 v12, v10, v12
    v_mul_u32_u24 v13, 3277, v12
    v_lshrrev_b32 v13, 16, v13
    v_mul_u32_u24 v14, 20, v13
    v_sub_u32 v14, v12, v14
    buffer_load_dwordx4 v2, s[8:11], m0 offen offset:0 lds
    v_cmp_le_u32 s[36:37], 16, v14
    v_cmp_le_u32 s[38:39], 16, v13
    v_lshl_add_u32 v15, v11, 1, v14
    v_subrev_u32 v15, 12, v15
    v_cndmask_b32 v15, v14, v15, s[36:37]
    v_lshl_add_u32 v16, v11, 1, v13
    v_subrev_u32 v16, 8, v16
    buffer_load_dwordx4 v2, s[8:11], m0 offen offset:1024 lds
    v_cmp_eq_u32 vcc, 18, v13
    s_nop 1
    v_cndmask_b32 v16, v16, 12, vcc
    v_cndmask_b32 v16, v13, v16, s[38:39]
    v_cndmask_b32 v17, 0, 2, s[38:39]
    v_cndmask_b32 v18, 0, 4, s[36:37]
    v_add3_u32 v17, v17, v18, v11
    v_min_u32 v17, 6, v17
    buffer_load_dwordx4 v2, s[8:11], m0 offen offset:2048 lds
    v_lshrrev_b32 v18, 2, v15
    v_lshl_add_u32 v18, v18, 4, v16
    v_lshlrev_b32 v18, 4, v18
    v_lshl_add_u32 v18, v17, 10, v18
    v_and_b32 v15, 3, v15
    v_lshl_add_u32 v18, v15, 2, v18
    v_and_b32 v18, 0x1fff, v18
    v_add_u32 v165, 131072, v18
    buffer_load_dwordx4 v2, s[8:11], m0 offen offset:3072 lds
    v_cmp_gt_u32 s[36:37], 18, v14
    v_cmp_gt_u32 s[38:39], 19, v13
    s_nop 0
    s_and_b64 s[36:37], s[36:37], s[38:39]
    v_lshlrev_b32 v10, 2, v10
    v_cndmask_b32 v168, v9, v10, s[36:37]
    v_add_u32 v10, 512, v0
    v_cmp_le_u32 vcc, 384, v10
    s_nop 1
    v_cndmask_b32 v11, 0, 1, vcc
    v_mul_u32_u24 v12, 384, v11
    s_add_u32 m0, s26, 65536
    v_sub_u32 v12, v10, v12
    v_mul_u32_u24 v13, 3277, v12
    v_lshrrev_b32 v13, 16, v13
    v_mul_u32_u24 v14, 20, v13
    v_sub_u32 v14, v12, v14
    buffer_load_dwordx4 v2, s[8:11], m0 offen offset:0 lds
    v_cmp_le_u32 s[36:37], 16, v14
    v_cmp_le_u32 s[38:39], 16, v13
    v_lshl_add_u32 v15, v11, 1, v14
    v_subrev_u32 v15, 12, v15
    v_cndmask_b32 v15, v14, v15, s[36:37]
    v_lshl_add_u32 v16, v11, 1, v13
    v_subrev_u32 v16, 8, v16
    buffer_load_dwordx4 v2, s[8:11], m0 offen offset:1024 lds
    v_cmp_eq_u32 vcc, 18, v13
    s_nop 1
    v_cndmask_b32 v16, v16, 12, vcc
    v_cndmask_b32 v16, v13, v16, s[38:39]
    v_cndmask_b32 v17, 0, 2, s[38:39]
    v_cndmask_b32 v18, 0, 4, s[36:37]
    v_add3_u32 v17, v17, v18, v11
    v_min_u32 v17, 6, v17
    buffer_load_dwordx4 v2, s[8:11], m0 offen offset:2048 lds
    v_lshrrev_b32 v18, 2, v15
    v_lshl_add_u32 v18, v18, 4, v16
    v_lshlrev_b32 v18, 4, v18
    v_lshl_add_u32 v18, v17, 10, v18
    v_and_b32 v15, 3, v15
    v_lshl_add_u32 v18, v15, 2, v18
    v_and_b32 v18, 0x1fff, v18
    v_add_u32 v166, 131072, v18
    buffer_load_dwordx4 v2, s[8:11], m0 offen offset:3072 lds
    v_cmp_gt_u32 s[36:37], 18, v14
    v_cmp_gt_u32 s[38:39], 19, v13
    s_nop 0
    s_and_b64 s[36:37], s[36:37], s[38:39]
    v_lshlrev_b32 v10, 2, v10
    v_cndmask_b32 v169, v9, v10, s[36:37]
    v_add_u32 v8, 0x10000, v2
    s_lshl_b32 s24, s3, 9
    s_add_u32 s24, s24, 159744
    v_add_u32 v10, s24, v6
    v_add_u32 v11, s24, v7
    v_add_u32 v12, s24, v2
    s_waitcnt vmcnt(12)
    v_pk_add_f32 v[224:225], v[224:225], v[228:229]
    v_pk_add_f32 v[226:227], v[226:227], v[230:231]
    s_mov_b64 exec, 0xfffffff
    ds_write_b128 v12, v[224:227]
    s_mov_b64 exec, -1
    ds_read_b32 v144, v10 offset:0
    ds_read_b32 v145, v10 offset:64
    ds_read_b32 v146, v10 offset:128
    ds_read_b32 v147, v10 offset:192
    ds_read_b32 v148, v10 offset:256
    ds_read_b128 v[152:155], v11 offset:256
    ds_read_b128 v[156:159], v11 offset:320
    ds_read_b128 v[160:163], v11 offset:384
    s_lshl_b32 s24, s23, 1
    s_and_b32 s25, s21, 3
    s_add_u32 s24, s24, s25
    s_add_u32 s24, s24, 1152
    s_lshl_b32 s24, s24, 7
    s_waitcnt vmcnt(0) lgkmcnt(0)
    s_barrier
    s_cmp_eq_u32 s60, 2
    s_cbranch_scc1 SK_mk_4
    v_mov_b32 v10, 0
    s_mov_b64 exec, 1
    s_mov_b32 s61, 200000
POLL_mk_5:
    v_mov_b32 v11, 0
    buffer_atomic_add v11, v10, s[96:99], s24 offen sc0
    s_waitcnt vmcnt(0)
    v_cmp_gt_u32 vcc, 16, v11
    s_nop 0
    s_cbranch_vccz PDONE_mk_6
    s_sub_u32 s61, s61, 1
    s_cmp_lg_u32 s61, 0
    s_cbranch_scc1 POLL_mk_5
PDONE_mk_6:
    s_mov_b64 exec, -1
SK_mk_4:
    buffer_load_dwordx4 a[0:3], v2, s[12:15], 0 offen offset:0 sc1
    buffer_load_dwordx4 a[4:7], v3, s[12:15], 0 offen offset:0 sc1
    buffer_load_dwordx4 a[8:11], v2, s[12:15], 0 offen offset:1024 sc1
    buffer_load_dwordx4 a[12:15], v3, s[12:15], 0 offen offset:1024 sc1
    buffer_load_dwordx4 v[136:139], v2, s[16:19], 0 offen offset:0 sc1
    buffer_load_dwordx4 v[140:143], v2, s[16:19], 0 offen offset:1024 sc1
    buffer_load_dwordx4 a[16:19], v2, s[12:15], 0 offen offset:2048 sc1
    buffer_load_dwordx4 a[20:23], v3, s[12:15], 0 offen offset:2048 sc1
    buffer_load_dwordx4 a[24:27], v2, s[12:15], 0 offen offset:3072 sc1
    buffer_load_dwordx4 a[28:31], v3, s[12:15], 0 offen offset:3072 sc1
    buffer_load_dwordx4 a[32:35], v2, s[12:15], s41 offen offset:0 sc1
    buffer_load_dwordx4 a[36:39], v3, s[12:15], s41 offen offset:0 sc1
    buffer_load_dwordx4 a[40:43], v2, s[12:15], s41 offen offset:1024 sc1
    buffer_load_dwordx4 a[44:47], v3, s[12:15], s41 offen offset:1024 sc1
    ds_read_b128 v[80:83], v2 offset:0
    ds_read_b128 v[84:87], v2 offset:1024
    ds_read_b128 v[88:91], v2 offset:2048
    ds_read_b128 v[92:95], v2 offset:3072
    ds_read_b128 v[96:99], v8 offset:8192
    ds_read_b128 v[100:103], v2 offset:4096
    s_lshr_b32 s24, s7, 3
    s_lshl_b32 s24, s24, 2
    s_add_u32 s24, s24, s3
    s_mul_i32 s24, s24, 46080
    s_add_u32 s24, s24, 2064384
    s_add_u32 s92, s4, s24
    s_addc_u32 s93, s5, 0
    s_mov_b32 s94, 46080
    s_mov_b32 s95, 0x20000
    s_lshl_b32 s24, s3, 9
    s_add_u32 s24, s24, 159744
    v_add_u32 v10, s24, v6
    v_add_u32 v11, s24, v7
    s_waitcnt vmcnt(13) lgkmcnt(5)
    v_mfma_f32_16x16x32_bf16 v[16:19], a[0:3], v[80:83], 0
    ds_read_b128 v[104:107], v2 offset:5120
    s_waitcnt vmcnt(12)
    v_mfma_f32_16x16x32_bf16 v[20:23], a[4:7], v[80:83], 0
    s_waitcnt lgkmcnt(5)
    buffer_load_dwordx4 a[48:51], v2, s[12:15], s41 offen offset:2048 sc1
    v_mfma_f32_16x16x32_bf16 v[28:31], a[4:7], v[84:87], 0
    ds_read_b128 v[108:111], v2 offset:6144
    v_mfma_f32_16x16x32_bf16 v[24:27], a[0:3], v[84:87], 0
    s_waitcnt lgkmcnt(5)
    v_mfma_f32_16x16x32_bf16 v[32:35], a[0:3], v[88:91], 0
    ds_read_b128 v[112:115], v2 offset:7168
    v_mfma_f32_16x16x32_bf16 v[36:39], a[4:7], v[88:91], 0
    s_waitcnt lgkmcnt(5)
    buffer_load_dwordx4 a[52:55], v3, s[12:15], s41 offen offset:2048 sc1
    v_mfma_f32_16x16x32_bf16 v[44:47], a[4:7], v[92:95], 0
    ds_read_b128 v[116:119], v8 offset:11264
    v_mfma_f32_16x16x32_bf16 v[40:43], a[0:3], v[92:95], 0
    s_waitcnt lgkmcnt(5)
    v_mfma_f32_16x16x32_bf16 v[48:51], a[0:3], v[96:99], 0
    ds_read_b128 v[80:83], v2 offset:8192
    v_mfma_f32_16x16x32_bf16 v[52:55], a[4:7], v[96:99], 0
    s_waitcnt vmcnt(12) lgkmcnt(5)
    buffer_load_dwordx4 a[56:59], v2, s[12:15], s41 offen offset:3072 sc1
    v_mfma_f32_16x16x32_bf16 v[20:23], a[12:15], v[100:103], v[20:23]
    ds_read_b128 v[84:87], v2 offset:9216
    v_mfma_f32_16x16x32_bf16 v[16:19], a[8:11], v[100:103], v[16:19]
    s_waitcnt lgkmcnt(5)
    v_mfma_f32_16x16x32_bf16 v[24:27], a[8:11], v[104:107], v[24:27]
    ds_read_b128 v[88:91], v2 offset:10240
    v_mfma_f32_16x16x32_bf16 v[28:31], a[12:15], v[104:107], v[28:31]
    s_waitcnt lgkmcnt(5)
    buffer_load_dwordx4 a[60:63], v3, s[12:15], s41 offen offset:3072 sc1
    v_mfma_f32_16x16x32_bf16 v[36:39], a[12:15], v[108:111], v[36:39]
    ds_read_b128 v[92:95], v2 offset:11264
    v_mfma_f32_16x16x32_bf16 v[32:35], a[8:11], v[108:111], v[32:35]
    s_waitcnt lgkmcnt(5)
    v_mfma_f32_16x16x32_bf16 v[40:43], a[8:11], v[112:115], v[40:43]
    ds_read_b128 v[96:99], v8 offset:14336
    v_mfma_f32_16x16x32_bf16 v[44:47], a[12:15], v[112:115], v[44:47]
    s_waitcnt lgkmcnt(5)
    buffer_load_dwordx4 a[64:67], v2, s[12:15], s42 offen offset:0 sc1
    v_mfma_f32_16x16x32_bf16 v[52:55], a[12:15], v[116:119], v[52:55]
    ds_read_b128 v[100:103], v2 offset:12288
    v_mfma_f32_16x16x32_bf16 v[48:51], a[8:11], v[116:119], v[48:51]
    s_waitcnt vmcnt(11) lgkmcnt(5)
    v_mfma_f32_16x16x32_bf16 v[16:19], a[16:19], v[80:83], v[16:19]
    ds_read_b128 v[104:107], v2 offset:13312
    v_mfma_f32_16x16x32_bf16 v[20:23], a[20:23], v[80:83], v[20:23]
    s_waitcnt lgkmcnt(5)
    buffer_load_dwordx4 a[68:71], v3, s[12:15], s42 offen offset:0 sc1
    v_mfma_f32_16x16x32_bf16 v[28:31], a[20:23], v[84:87], v[28:31]
    ds_read_b128 v[108:111], v2 offset:14336
    v_mfma_f32_16x16x32_bf16 v[24:27], a[16:19], v[84:87], v[24:27]
    s_waitcnt lgkmcnt(5)
    v_mfma_f32_16x16x32_bf16 v[32:35], a[16:19], v[88:91], v[32:35]
    ds_read_b128 v[112:115], v2 offset:15360
    v_mfma_f32_16x16x32_bf16 v[36:39], a[20:23], v[88:91], v[36:39]
    s_waitcnt lgkmcnt(5)
    buffer_load_dwordx4 a[72:75], v2, s[12:15], s42 offen offset:1024 sc1
    v_mfma_f32_16x16x32_bf16 v[44:47], a[20:23], v[92:95], v[44:47]
    ds_read_b128 v[116:119], v8 offset:17408
    v_mfma_f32_16x16x32_bf16 v[40:43], a[16:19], v[92:95], v[40:43]
    s_waitcnt lgkmcnt(5)
    v_mfma_f32_16x16x32_bf16 v[48:51], a[16:19], v[96:99], v[48:51]
    ds_read_b128 v[80:83], v2 offset:16384
    v_mfma_f32_16x16x32_bf16 v[52:55], a[20:23], v[96:99], v[52:55]
    s_waitcnt vmcnt(11) lgkmcnt(5)
    buffer_load_dwordx4 a[76:79], v3, s[12:15], s42 offen offset:1024 sc1
    v_mfma_f32_16x16x32_bf16 v[20:23], a[28:31], v[100:103], v[20:23]
    ds_read_b128 v[84:87], v2 offset:17408
    v_mfma_f32_16x16x32_bf16 v[16:19], a[24:27], v[100:103], v[16:19]
    s_waitcnt lgkmcnt(5)
    v_mfma_f32_16x16x32_bf16 v[24:27], a[24:27], v[104:107], v[24:27]
    ds_read_b128 v[88:91], v2 offset:18432
    v_mfma_f32_16x16x32_bf16 v[28:31], a[28:31], v[104:107], v[28:31]
    s_waitcnt lgkmcnt(5)
    buffer_load_dwordx4 a[80:83], v2, s[12:15], s42 offen offset:2048 sc1
    v_mfma_f32_16x16x32_bf16 v[36:39], a[28:31], v[108:111], v[36:39]
    ds_read_b128 v[92:95], v2 offset:19456
    v_mfma_f32_16x16x32_bf16 v[32:35], a[24:27], v[108:111], v[32:35]
    s_waitcnt lgkmcnt(5)
    v_mfma_f32_16x16x32_bf16 v[40:43], a[24:27], v[112:115], v[40:43]
    ds_read_b128 v[96:99], v8 offset:20480
    v_mfma_f32_16x16x32_bf16 v[44:47], a[28:31], v[112:115], v[44:47]
    s_waitcnt lgkmcnt(5)
    buffer_load_dwordx4 a[84:87], v3, s[12:15], s42 offen offset:2048 sc1
    v_mfma_f32_16x16x32_bf16 v[52:55], a[28:31], v[116:119], v[52:55]
    ds_read_b128 v[100:103], v2 offset:20480
    v_mfma_f32_16x16x32_bf16 v[48:51], a[24:27], v[116:119], v[48:51]
    s_waitcnt vmcnt(12) lgkmcnt(5)
    v_mfma_f32_16x16x32_bf16 v[16:19], a[32:35], v[80:83], v[16:19]
    ds_read_b128 v[104:107], v2 offset:21504
    v_add_f32 v136, v136, v138
    v_mfma_f32_16x16x32_bf16 v[20:23], a[36:39], v[80:83], v[20:23]
    s_waitcnt lgkmcnt(5)
    buffer_load_dwordx4 a[88:91], v2, s[12:15], s42 offen offset:3072 sc1
    v_mfma_f32_16x16x32_bf16 v[28:31], a[36:39], v[84:87], v[28:31]
    ds_read_b128 v[108:111], v2 offset:22528
    v_add_f32 v140, v140, v142
    v_mfma_f32_16x16x32_bf16 v[24:27], a[32:35], v[84:87], v[24:27]
    s_waitcnt lgkmcnt(5)
    v_mfma_f32_16x16x32_bf16 v[32:35], a[32:35], v[88:91], v[32:35]
    ds_read_b128 v[112:115], v2 offset:23552
    v_add_f32 v137, v137, v139
    v_mfma_f32_16x16x32_bf16 v[36:39], a[36:39], v[88:91], v[36:39]
    s_waitcnt lgkmcnt(5)
    buffer_load_dwordx4 a[92:95], v3, s[12:15], s42 offen offset:3072 sc1
    v_mfma_f32_16x16x32_bf16 v[44:47], a[36:39], v[92:95], v[44:47]
    ds_read_b128 v[116:119], v8 offset:23552
    v_add_f32 v141, v141, v143
    v_mfma_f32_16x16x32_bf16 v[40:43], a[32:35], v[92:95], v[40:43]
    s_waitcnt lgkmcnt(5)
    v_mfma_f32_16x16x32_bf16 v[48:51], a[32:35], v[96:99], v[48:51]
    ds_read_b128 v[80:83], v2 offset:24576
    v_mov_b32 v138, v136
    v_mfma_f32_16x16x32_bf16 v[52:55], a[36:39], v[96:99], v[52:55]
    s_waitcnt vmcnt(12) lgkmcnt(5)
    buffer_load_dwordx4 a[96:99], v2, s[12:15], s43 offen offset:0 sc1
    v_mfma_f32_16x16x32_bf16 v[20:23], a[44:47], v[100:103], v[20:23]
    ds_read_b128 v[84:87], v2 offset:25600
    v_mov_b32 v142, v140
    v_mfma_f32_16x16x32_bf16 v[16:19], a[40:43], v[100:103], v[16:19]
    s_waitcnt lgkmcnt(5)
    v_mfma_f32_16x16x32_bf16 v[24:27], a[40:43], v[104:107], v[24:27]
    ds_read_b128 v[88:91], v2 offset:26624
    v_permlane16_swap_b32 v136, v138
    v_mfma_f32_16x16x32_bf16 v[28:31], a[44:47], v[104:107], v[28:31]
    s_waitcnt lgkmcnt(5)
    buffer_load_dwordx4 a[100:103], v3, s[12:15], s43 offen offset:0 sc1
    v_mfma_f32_16x16x32_bf16 v[36:39], a[44:47], v[108:111], v[36:39]
    ds_read_b128 v[92:95], v2 offset:27648
    v_mfma_f32_16x16x32_bf16 v[32:35], a[40:43], v[108:111], v[32:35]
    s_waitcnt lgkmcnt(5)
    v_permlane16_swap_b32 v140, v142
    v_mfma_f32_16x16x32_bf16 v[40:43], a[40:43], v[112:115], v[40:43]
    ds_read_b128 v[96:99], v8 offset:26624
    v_mfma_f32_16x16x32_bf16 v[44:47], a[44:47], v[112:115], v[44:47]
    s_waitcnt lgkmcnt(5)
    buffer_load_dwordx4 a[104:107], v2, s[12:15], s43 offen offset:1024 sc1
    v_add_f32 v136, v136, v138
    v_mfma_f32_16x16x32_bf16 v[52:55], a[44:47], v[116:119], v[52:55]
    ds_read_b128 v[100:103], v2 offset:28672
    v_mfma_f32_16x16x32_bf16 v[48:51], a[40:43], v[116:119], v[48:51]
    s_waitcnt vmcnt(13) lgkmcnt(5)
    v_add_f32 v140, v140, v142
    v_mfma_f32_16x16x32_bf16 v[16:19], a[48:51], v[80:83], v[16:19]
    ds_read_b128 v[104:107], v2 offset:29696
    v_mfma_f32_16x16x32_bf16 v[20:23], a[52:55], v[80:83], v[20:23]
    s_waitcnt lgkmcnt(5)
    buffer_load_dwordx4 a[108:111], v3, s[12:15], s43 offen offset:1024 sc1
    v_mov_b32 v138, v136
    v_mfma_f32_16x16x32_bf16 v[28:31], a[52:55], v[84:87], v[28:31]
    ds_read_b128 v[108:111], v2 offset:30720
    v_mfma_f32_16x16x32_bf16 v[24:27], a[48:51], v[84:87], v[24:27]
    s_waitcnt lgkmcnt(5)
    v_mov_b32 v142, v140
    v_mfma_f32_16x16x32_bf16 v[32:35], a[48:51], v[88:91], v[32:35]
    ds_read_b128 v[112:115], v2 offset:31744
    v_mfma_f32_16x16x32_bf16 v[36:39], a[52:55], v[88:91], v[36:39]
    s_waitcnt lgkmcnt(5)
    buffer_load_dwordx4 a[112:115], v2, s[12:15], s43 offen offset:2048 sc1
    v_permlane32_swap_b32 v136, v138
    v_mfma_f32_16x16x32_bf16 v[44:47], a[52:55], v[92:95], v[44:47]
    ds_read_b128 v[116:119], v8 offset:29696
    v_mfma_f32_16x16x32_bf16 v[40:43], a[48:51], v[92:95], v[40:43]
    s_waitcnt lgkmcnt(5)
    v_mfma_f32_16x16x32_bf16 v[48:51], a[48:51], v[96:99], v[48:51]
    ds_read_b128 v[80:83], v2 offset:32768
    v_permlane32_swap_b32 v140, v142
    v_mfma_f32_16x16x32_bf16 v[52:55], a[52:55], v[96:99], v[52:55]
    s_waitcnt vmcnt(13) lgkmcnt(5)
    buffer_load_dwordx4 a[116:119], v3, s[12:15], s43 offen offset:2048 sc1
    v_mfma_f32_16x16x32_bf16 v[20:23], a[60:63], v[100:103], v[20:23]
    ds_read_b128 v[84:87], v2 offset:33792
    v_add_f32 v136, v136, v138
    v_mfma_f32_16x16x32_bf16 v[16:19], a[56:59], v[100:103], v[16:19]
    s_waitcnt lgkmcnt(5)
    v_mfma_f32_16x16x32_bf16 v[24:27], a[56:59], v[104:107], v[24:27]
    ds_read_b128 v[88:91], v2 offset:34816
    v_add_f32 v140, v140, v142
    v_mfma_f32_16x16x32_bf16 v[28:31], a[60:63], v[104:107], v[28:31]
    s_waitcnt lgkmcnt(5)
    buffer_load_dwordx4 a[120:123], v2, s[12:15], s43 offen offset:3072 sc1
    v_mfma_f32_16x16x32_bf16 v[36:39], a[60:63], v[108:111], v[36:39]
    ds_read_b128 v[92:95], v2 offset:35840
    v_mov_b32 v139, v137
    v_mfma_f32_16x16x32_bf16 v[32:35], a[56:59], v[108:111], v[32:35]
    s_waitcnt lgkmcnt(5)
    v_mfma_f32_16x16x32_bf16 v[40:43], a[56:59], v[112:115], v[40:43]
    ds_read_b128 v[96:99], v8 offset:32768
    v_mov_b32 v143, v141
    v_mfma_f32_16x16x32_bf16 v[44:47], a[60:63], v[112:115], v[44:47]
    s_waitcnt lgkmcnt(5)
    buffer_load_dwordx4 a[124:127], v3, s[12:15], s43 offen offset:3072 sc1
    v_mfma_f32_16x16x32_bf16 v[52:55], a[60:63], v[116:119], v[52:55]
    ds_read_b128 v[100:103], v2 offset:36864
    v_permlane16_swap_b32 v137, v139
    v_mfma_f32_16x16x32_bf16 v[48:51], a[56:59], v[116:119], v[48:51]
    s_waitcnt vmcnt(14) lgkmcnt(5)
    v_mfma_f32_16x16x32_bf16 v[16:19], a[64:67], v[80:83], v[16:19]
    ds_read_b128 v[104:107], v2 offset:37888
    v_mfma_f32_16x16x32_bf16 v[20:23], a[68:71], v[80:83], v[20:23]
    s_waitcnt lgkmcnt(5)
    buffer_load_dwordx4 a[128:131], v2, s[12:15], s44 offen offset:0 sc1
    v_permlane16_swap_b32 v141, v143
    v_mfma_f32_16x16x32_bf16 v[28:31], a[68:71], v[84:87], v[28:31]
    ds_read_b128 v[108:111], v2 offset:38912
    v_mfma_f32_16x16x32_bf16 v[24:27], a[64:67], v[84:87], v[24:27]
    s_waitcnt lgkmcnt(5)
    v_add_f32 v137, v137, v139
    v_mfma_f32_16x16x32_bf16 v[32:35], a[64:67], v[88:91], v[32:35]
    ds_read_b128 v[112:115], v2 offset:39936
    v_mfma_f32_16x16x32_bf16 v[36:39], a[68:71], v[88:91], v[36:39]
    s_waitcnt lgkmcnt(5)
    buffer_load_dwordx4 a[132:135], v3, s[12:15], s44 offen offset:0 sc1
    v_add_f32 v141, v141, v143
    v_mfma_f32_16x16x32_bf16 v[44:47], a[68:71], v[92:95], v[44:47]
    ds_read_b128 v[116:119], v8 offset:35840
    v_mfma_f32_16x16x32_bf16 v[40:43], a[64:67], v[92:95], v[40:43]
    s_waitcnt lgkmcnt(5)
    v_mov_b32 v139, v137
    v_mfma_f32_16x16x32_bf16 v[48:51], a[64:67], v[96:99], v[48:51]
    ds_read_b128 v[80:83], v2 offset:40960
    v_mfma_f32_16x16x32_bf16 v[52:55], a[68:71], v[96:99], v[52:55]
    s_waitcnt vmcnt(14) lgkmcnt(5)
    buffer_load_dwordx4 a[136:139], v2, s[12:15], s44 offen offset:1024 sc1
    v_mov_b32 v143, v141
    v_mfma_f32_16x16x32_bf16 v[20:23], a[76:79], v[100:103], v[20:23]
    ds_read_b128 v[84:87], v2 offset:41984
    v_mfma_f32_16x16x32_bf16 v[16:19], a[72:75], v[100:103], v[16:19]
    s_waitcnt lgkmcnt(5)
    v_permlane32_swap_b32 v137, v139
    v_mfma_f32_16x16x32_bf16 v[24:27], a[72:75], v[104:107], v[24:27]
    ds_read_b128 v[88:91], v2 offset:43008
    v_mfma_f32_16x16x32_bf16 v[28:31], a[76:79], v[104:107], v[28:31]
    s_waitcnt lgkmcnt(5)
    buffer_load_dwordx4 a[140:143], v3, s[12:15], s44 offen offset:1024 sc1
    v_mfma_f32_16x16x32_bf16 v[36:39], a[76:79], v[108:111], v[36:39]
    ds_read_b128 v[92:95], v2 offset:44032
    v_permlane32_swap_b32 v141, v143
    v_mfma_f32_16x16x32_bf16 v[32:35], a[72:75], v[108:111], v[32:35]
    s_waitcnt lgkmcnt(5)
    v_mfma_f32_16x16x32_bf16 v[40:43], a[72:75], v[112:115], v[40:43]
    ds_read_b128 v[96:99], v8 offset:38912
    v_add_f32 v137, v137, v139
    v_mfma_f32_16x16x32_bf16 v[44:47], a[76:79], v[112:115], v[44:47]
    s_waitcnt lgkmcnt(5)
    buffer_load_dwordx4 a[144:147], v2, s[92:95], 0 offen offset:0
    v_mfma_f32_16x16x32_bf16 v[52:55], a[76:79], v[116:119], v[52:55]
    ds_read_b128 v[100:103], v2 offset:45056
    v_add_f32 v141, v141, v143
    v_mfma_f32_16x16x32_bf16 v[48:51], a[72:75], v[116:119], v[48:51]
    s_waitcnt vmcnt(15) lgkmcnt(5)
    v_mfma_f32_16x16x32_bf16 v[16:19], a[80:83], v[80:83], v[16:19]
    ds_read_b128 v[104:107], v2 offset:46080
    buffer_load_dwordx4 a[148:151], v2, s[92:95], 0 offen offset:1024
    v_mfma_f32_16x16x32_bf16 v[20:23], a[84:87], v[80:83], v[20:23]
    s_waitcnt lgkmcnt(5)
    v_mul_f32 v170, 0x3ae38e39, v136
    v_mfma_f32_16x16x32_bf16 v[28:31], a[84:87], v[84:87], v[28:31]
    ds_read_b128 v[108:111], v2 offset:47104
    v_mul_f32 v171, 0x3ae38e39, v140
    v_mfma_f32_16x16x32_bf16 v[24:27], a[80:83], v[84:87], v[24:27]
    s_waitcnt lgkmcnt(5)
    v_mfma_f32_16x16x32_bf16 v[32:35], a[80:83], v[88:91], v[32:35]
    ds_read_b128 v[112:115], v2 offset:48128
    buffer_load_dwordx4 a[152:155], v2, s[92:95], 0 offen offset:2048
    v_mfma_f32_16x16x32_bf16 v[36:39], a[84:87], v[88:91], v[36:39]
    s_waitcnt lgkmcnt(5)
    v_mul_f32 v137, 0x3ae38e39, v137
    v_mfma_f32_16x16x32_bf16 v[44:47], a[84:87], v[92:95], v[44:47]
    ds_read_b128 v[116:119], v8 offset:41984
    v_mul_f32 v141, 0x3ae38e39, v141
    v_mfma_f32_16x16x32_bf16 v[40:43], a[80:83], v[92:95], v[40:43]
    s_waitcnt lgkmcnt(5)
    v_mfma_f32_16x16x32_bf16 v[48:51], a[80:83], v[96:99], v[48:51]
    ds_read_b128 v[80:83], v2 offset:49152
    buffer_load_dwordx4 a[156:159], v2, s[92:95], 0 offen offset:3072
    v_mfma_f32_16x16x32_bf16 v[52:55], a[84:87], v[96:99], v[52:55]
    s_waitcnt vmcnt(16) lgkmcnt(5)
    v_fma_f32 v137, -v170, v170, v137
    v_mfma_f32_16x16x32_bf16 v[20:23], a[92:95], v[100:103], v[20:23]
    ds_read_b128 v[84:87], v2 offset:50176
    v_mfma_f32_16x16x32_bf16 v[16:19], a[88:91], v[100:103], v[16:19]
    s_waitcnt lgkmcnt(5)
    buffer_load_dwordx4 a[160:163], v2, s[92:95], s41 offen offset:0
    v_fma_f32 v141, -v171, v171, v141
    v_mfma_f32_16x16x32_bf16 v[24:27], a[88:91], v[104:107], v[24:27]
    ds_read_b128 v[88:91], v2 offset:51200
    v_mfma_f32_16x16x32_bf16 v[28:31], a[92:95], v[104:107], v[28:31]
    s_waitcnt lgkmcnt(5)
    v_max_f32 v137, 0, v137
    v_mfma_f32_16x16x32_bf16 v[36:39], a[92:95], v[108:111], v[36:39]
    ds_read_b128 v[92:95], v2 offset:52224
    v_mfma_f32_16x16x32_bf16 v[32:35], a[88:91], v[108:111], v[32:35]
    s_waitcnt lgkmcnt(5)
    buffer_load_dwordx4 a[164:167], v2, s[92:95], s41 offen offset:1024
    v_max_f32 v141, 0, v141
    v_mfma_f32_16x16x32_bf16 v[40:43], a[88:91], v[112:115], v[40:43]
    ds_read_b128 v[96:99], v8 offset:45056
    v_mfma_f32_16x16x32_bf16 v[44:47], a[92:95], v[112:115], v[44:47]
    s_waitcnt lgkmcnt(5)
    v_add_f32 v138, 0x3727c5ac, v137
    v_mfma_f32_16x16x32_bf16 v[52:55], a[92:95], v[116:119], v[52:55]
    ds_read_b128 v[100:103], v2 offset:53248
    v_mfma_f32_16x16x32_bf16 v[48:51], a[88:91], v[116:119], v[48:51]
    s_waitcnt vmcnt(16) lgkmcnt(5)
    buffer_load_dwordx4 a[168:171], v2, s[92:95], s41 offen offset:2048
    v_add_f32 v142, 0x3727c5ac, v141
    v_mfma_f32_16x16x32_bf16 v[16:19], a[96:99], v[80:83], v[16:19]
    ds_read_b128 v[104:107], v2 offset:54272
    v_mfma_f32_16x16x32_bf16 v[20:23], a[100:103], v[80:83], v[20:23]
    s_waitcnt lgkmcnt(5)
    v_mfma_f32_16x16x32_bf16 v[28:31], a[100:103], v[84:87], v[28:31]
    ds_read_b128 v[108:111], v2 offset:55296
    v_mfma_f32_16x16x32_bf16 v[24:27], a[96:99], v[84:87], v[24:27]
    s_waitcnt lgkmcnt(5)
    buffer_load_dwordx4 a[172:175], v2, s[92:95], s41 offen offset:3072
    v_mfma_f32_16x16x32_bf16 v[32:35], a[96:99], v[88:91], v[32:35]
    ds_read_b128 v[112:115], v2 offset:56320
    v_mfma_f32_16x16x32_bf16 v[36:39], a[100:103], v[88:91], v[36:39]
    s_waitcnt lgkmcnt(5)
    v_rsq_f32 v172, v138
    v_mfma_f32_16x16x32_bf16 v[44:47], a[100:103], v[92:95], v[44:47]
    ds_read_b128 v[116:119], v8 offset:48128
    buffer_load_dwordx4 a[176:179], v2, s[92:95], s42 offen offset:0
    v_mfma_f32_16x16x32_bf16 v[40:43], a[96:99], v[92:95], v[40:43]
    s_waitcnt lgkmcnt(5)
    v_rsq_f32 v173, v142
    v_mfma_f32_16x16x32_bf16 v[48:51], a[96:99], v[96:99], v[48:51]
    ds_read_b128 v[80:83], v2 offset:57344
    v_mfma_f32_16x16x32_bf16 v[52:55], a[100:103], v[96:99], v[52:55]
    s_waitcnt vmcnt(17) lgkmcnt(5)
    v_mfma_f32_16x16x32_bf16 v[20:23], a[108:111], v[100:103], v[20:23]
    ds_read_b128 v[84:87], v2 offset:58368
    buffer_load_dwordx4 a[180:183], v2, s[92:95], s42 offen offset:1024
    v_mfma_f32_16x16x32_bf16 v[16:19], a[104:107], v[100:103], v[16:19]
    s_waitcnt lgkmcnt(5)
    v_mul_f32 v174, 0x3fb8aa3b, v172
    v_mfma_f32_16x16x32_bf16 v[24:27], a[104:107], v[104:107], v[24:27]
    ds_read_b128 v[88:91], v2 offset:59392
    v_mul_f32 v175, 0x3fb8aa3b, v173
    v_mfma_f32_16x16x32_bf16 v[28:31], a[108:111], v[104:107], v[28:31]
    s_waitcnt lgkmcnt(5)
    v_mfma_f32_16x16x32_bf16 v[36:39], a[108:111], v[108:111], v[36:39]
    ds_read_b128 v[92:95], v2 offset:60416
    buffer_load_dwordx4 a[184:187], v2, s[92:95], s42 offen offset:2048
    v_mfma_f32_16x16x32_bf16 v[32:35], a[104:107], v[108:111], v[32:35]
    s_waitcnt lgkmcnt(5)
    ds_write_b32 v10, v170 offset:0
    v_mfma_f32_16x16x32_bf16 v[40:43], a[104:107], v[112:115], v[40:43]
    ds_read_b128 v[96:99], v8 offset:51200
    v_mfma_f32_16x16x32_bf16 v[44:47], a[108:111], v[112:115], v[44:47]
    s_waitcnt lgkmcnt(6)
    ds_write_b32 v10, v172 offset:128
    v_mfma_f32_16x16x32_bf16 v[52:55], a[108:111], v[116:119], v[52:55]
    ds_read_b128 v[100:103], v2 offset:61440
    buffer_load_dwordx4 a[188:191], v2, s[92:95], s42 offen offset:3072
    v_mfma_f32_16x16x32_bf16 v[48:51], a[104:107], v[116:119], v[48:51]
    s_waitcnt vmcnt(18) lgkmcnt(7)
    ds_write_b32 v10, v174 offset:256
    v_mfma_f32_16x16x32_bf16 v[16:19], a[112:115], v[80:83], v[16:19]
    ds_read_b128 v[104:107], v2 offset:62464
    v_mfma_f32_16x16x32_bf16 v[20:23], a[116:119], v[80:83], v[20:23]
    s_waitcnt lgkmcnt(8)
    buffer_load_dwordx4 a[192:195], v2, s[92:95], s43 offen offset:0
    ds_write_b32 v10, v171 offset:64
    v_mfma_f32_16x16x32_bf16 v[28:31], a[116:119], v[84:87], v[28:31]
    ds_read_b128 v[108:111], v2 offset:63488
    v_mfma_f32_16x16x32_bf16 v[24:27], a[112:115], v[84:87], v[24:27]
    s_waitcnt lgkmcnt(9)
    ds_write_b32 v10, v173 offset:192
    v_mfma_f32_16x16x32_bf16 v[32:35], a[112:115], v[88:91], v[32:35]
    ds_read_b128 v[112:115], v2 offset:64512
    v_mfma_f32_16x16x32_bf16 v[36:39], a[116:119], v[88:91], v[36:39]
    s_waitcnt lgkmcnt(10)
    buffer_load_dwordx4 a[196:199], v2, s[92:95], s43 offen offset:1024
    ds_write_b32 v10, v175 offset:320
    v_mfma_f32_16x16x32_bf16 v[44:47], a[116:119], v[92:95], v[44:47]
    ds_read_b128 v[116:119], v8 offset:54272
    v_mfma_f32_16x16x32_bf16 v[40:43], a[112:115], v[92:95], v[40:43]
    s_waitcnt lgkmcnt(10)
    v_mfma_f32_16x16x32_bf16 v[48:51], a[112:115], v[96:99], v[48:51]
    ds_read_b128 v[80:83], v8 offset:0
    ds_read_b128 v[176:179], v11 offset:0
    v_mfma_f32_16x16x32_bf16 v[52:55], a[116:119], v[96:99], v[52:55]
    s_waitcnt vmcnt(18) lgkmcnt(10)
    buffer_load_dwordx4 a[200:203], v2, s[92:95], s43 offen offset:2048
    v_mfma_f32_16x16x32_bf16 v[20:23], a[124:127], v[100:103], v[20:23]
    ds_read_b128 v[84:87], v8 offset:1024
    ds_read_b128 v[184:187], v11 offset:128
    v_mfma_f32_16x16x32_bf16 v[16:19], a[120:123], v[100:103], v[16:19]
    s_waitcnt lgkmcnt(10)
    v_mfma_f32_16x16x32_bf16 v[24:27], a[120:123], v[104:107], v[24:27]
    ds_read_b128 v[88:91], v8 offset:2048
    buffer_load_dwordx4 a[204:207], v2, s[92:95], s43 offen offset:3072
    v_mfma_f32_16x16x32_bf16 v[28:31], a[124:127], v[104:107], v[28:31]
    s_waitcnt lgkmcnt(9)
    ds_read_b128 v[192:195], v11 offset:256
    v_mfma_f32_16x16x32_bf16 v[36:39], a[124:127], v[108:111], v[36:39]
    ds_read_b128 v[92:95], v8 offset:3072
    ds_read_b128 v[180:183], v11 offset:64
    v_mfma_f32_16x16x32_bf16 v[32:35], a[120:123], v[108:111], v[32:35]
    s_waitcnt lgkmcnt(10)
    v_mfma_f32_16x16x32_bf16 v[40:43], a[120:123], v[112:115], v[40:43]
    ds_read_b128 v[96:99], v8 offset:57344
    buffer_load_dwordx4 a[208:211], v2, s[92:95], s44 offen offset:0
    v_mfma_f32_16x16x32_bf16 v[44:47], a[124:127], v[112:115], v[44:47]
    s_waitcnt lgkmcnt(9)
    ds_read_b128 v[188:191], v11 offset:192
    v_mfma_f32_16x16x32_bf16 v[52:55], a[124:127], v[116:119], v[52:55]
    ds_read_b128 v[100:103], v8 offset:4096
    ds_read_b128 v[196:199], v11 offset:320
    v_mfma_f32_16x16x32_bf16 v[48:51], a[120:123], v[116:119], v[48:51]
    s_waitcnt vmcnt(19) lgkmcnt(11)
    v_mfma_f32_16x16x32_bf16 v[16:19], a[128:131], v[80:83], v[16:19]
    ds_read_b128 v[104:107], v8 offset:5120
    buffer_load_dwordx4 a[212:215], v2, s[92:95], s44 offen offset:1024
    v_mfma_f32_16x16x32_bf16 v[20:23], a[132:135], v[80:83], v[20:23]
    s_waitcnt lgkmcnt(10)
    v_mfma_f32_16x16x32_bf16 v[28:31], a[132:135], v[84:87], v[28:31]
    ds_read_b128 v[108:111], v8 offset:6144
    v_mfma_f32_16x16x32_bf16 v[24:27], a[128:131], v[84:87], v[24:27]
    s_waitcnt lgkmcnt(9)
    v_mfma_f32_16x16x32_bf16 v[32:35], a[128:131], v[88:91], v[32:35]
    ds_read_b128 v[112:115], v8 offset:7168
    buffer_load_dwordx4 a[216:219], v2, s[92:95], s44 offen offset:2048
    v_mfma_f32_16x16x32_bf16 v[36:39], a[132:135], v[88:91], v[36:39]
    s_waitcnt lgkmcnt(8)
    v_mfma_f32_16x16x32_bf16 v[44:47], a[132:135], v[92:95], v[44:47]
    ds_read_b128 v[116:119], v8 offset:60416
    v_mfma_f32_16x16x32_bf16 v[40:43], a[128:131], v[92:95], v[40:43]
    s_waitcnt lgkmcnt(7)
    buffer_load_dwordx4 a[220:223], v2, s[92:95], s44 offen offset:3072
    v_mfma_f32_16x16x32_bf16 v[48:51], a[128:131], v[96:99], v[48:51]
    v_mfma_f32_16x16x32_bf16 v[52:55], a[132:135], v[96:99], v[52:55]
    s_waitcnt vmcnt(20) lgkmcnt(5)
    v_mfma_f32_16x16x32_bf16 v[20:23], a[140:143], v[100:103], v[20:23]
    v_mfma_f32_16x16x32_bf16 v[16:19], a[136:139], v[100:103], v[16:19]
    s_waitcnt lgkmcnt(3)
    buffer_load_dwordx4 a[224:227], v2, s[92:95], s45 offen offset:0
    v_mfma_f32_16x16x32_bf16 v[24:27], a[136:139], v[104:107], v[24:27]
    v_mfma_f32_16x16x32_bf16 v[28:31], a[140:143], v[104:107], v[28:31]
    s_waitcnt lgkmcnt(2)
    v_mfma_f32_16x16x32_bf16 v[36:39], a[140:143], v[108:111], v[36:39]
    v_mfma_f32_16x16x32_bf16 v[32:35], a[136:139], v[108:111], v[32:35]
    s_waitcnt lgkmcnt(1)
    buffer_load_dwordx4 a[228:231], v2, s[92:95], s45 offen offset:1024
    v_mfma_f32_16x16x32_bf16 v[40:43], a[136:139], v[112:115], v[40:43]
    v_mfma_f32_16x16x32_bf16 v[44:47], a[140:143], v[112:115], v[44:47]
    s_waitcnt lgkmcnt(0)
    v_mfma_f32_16x16x32_bf16 v[52:55], a[140:143], v[116:119], v[52:55]
    v_mfma_f32_16x16x32_bf16 v[48:51], a[136:139], v[116:119], v[48:51]
    s_cmp_eq_u32 s60, 2
    s_cbranch_scc0 SK_mk_7
    v_add_f32 v240, v240, v241
    buffer_store_dword v240, v242, s[76:79], s80 offen sc1
SK_mk_7:
    v_mov_b32 v134, 0x3fb8aa3b
    v_mov_b32 v135, 0x358637bd
    ds_read_b128 v[80:83], v8 offset:9216
    ds_read_b128 v[84:87], v8 offset:10240
    ds_read_b128 v[88:91], v8 offset:8192
    ds_read_b128 v[92:95], v8 offset:12288
    ds_read_b128 v[96:99], v8 offset:13312
    ds_read_b128 v[100:103], v8 offset:11264
    v_and_b32 v12, 12, v1
    v_cmp_eq_u32 s[36:37], 8, v12
    v_pk_fma_f32 v[16:17], v[176:177], v[144:145], v[16:17] op_sel:[0,0,0] op_sel_hi:[1,0,1] neg_lo:[1,0,0] neg_hi:[1,0,0]
    v_pk_fma_f32 v[18:19], v[178:179], v[144:145], v[18:19] op_sel:[0,0,0] op_sel_hi:[1,0,1] neg_lo:[1,0,0] neg_hi:[1,0,0]
    v_pk_fma_f32 v[20:21], v[180:181], v[144:145], v[20:21] op_sel:[0,0,0] op_sel_hi:[1,0,1] neg_lo:[1,0,0] neg_hi:[1,0,0]
    v_pk_fma_f32 v[22:23], v[182:183], v[144:145], v[22:23] op_sel:[0,0,0] op_sel_hi:[1,0,1] neg_lo:[1,0,0] neg_hi:[1,0,0]
    v_pk_mul_f32 v[124:125], v[16:17], v[192:193] op_sel:[0,0] op_sel_hi:[1,1]
    buffer_load_dwordx4 a[232:235], v2, s[92:95], s45 offen offset:2048
    v_pk_mul_f32 v[126:127], v[18:19], v[194:195] op_sel:[0,0] op_sel_hi:[1,1]
    v_pk_mul_f32 v[128:129], v[20:21], v[196:197] op_sel:[0,0] op_sel_hi:[1,1]
    v_pk_mul_f32 v[130:131], v[22:23], v[198:199] op_sel:[0,0] op_sel_hi:[1,1]
    v_exp_f32 v124, v124
    v_exp_f32 v126, v126
    v_exp_f32 v128, v128
    v_exp_f32 v130, v130
    v_exp_f32 v125, v125
    v_exp_f32 v127, v127
    v_exp_f32 v129, v129
    v_exp_f32 v131, v131
    v_pk_fma_f32 v[16:17], v[16:17], v[184:185], 1.0 op_sel:[0,0,0] op_sel_hi:[1,1,0]
    buffer_load_dwordx4 a[236:239], v2, s[92:95], s45 offen offset:3072
    v_pk_fma_f32 v[18:19], v[18:19], v[186:187], 1.0 op_sel:[0,0,0] op_sel_hi:[1,1,0]
    v_pk_fma_f32 v[20:21], v[20:21], v[188:189], 1.0 op_sel:[0,0,0] op_sel_hi:[1,1,0]
    v_pk_fma_f32 v[22:23], v[22:23], v[190:191], 1.0 op_sel:[0,0,0] op_sel_hi:[1,1,0]
    v_med3_f32 v16, v16, v124, 1.0
    v_med3_f32 v18, v18, v126, 1.0
    v_med3_f32 v20, v20, v128, 1.0
    v_med3_f32 v22, v22, v130, 1.0
    v_med3_f32 v17, v17, v125, 1.0
    v_med3_f32 v19, v19, v127, 1.0
    v_med3_f32 v21, v21, v129, 1.0
    v_med3_f32 v23, v23, v131, 1.0
    v_pk_add_f32 v[16:17], v[16:17], v[134:135] op_sel:[0,1] op_sel_hi:[1,1]
    buffer_load_dwordx4 a[240:243], v2, s[92:95], s46 offen offset:0
    v_pk_add_f32 v[18:19], v[18:19], v[134:135] op_sel:[0,1] op_sel_hi:[1,1]
    v_pk_add_f32 v[20:21], v[20:21], v[134:135] op_sel:[0,1] op_sel_hi:[1,1]
    v_pk_add_f32 v[22:23], v[22:23], v[134:135] op_sel:[0,1] op_sel_hi:[1,1]
    v_cvt_pk_bf16_f32 v200, v16, v17
    v_cvt_pk_bf16_f32 v201, v18, v19
    v_cvt_pk_bf16_f32 v202, v20, v21
    v_cvt_pk_bf16_f32 v203, v22, v23
    v_pk_fma_f32 v[24:25], v[176:177], v[144:145], v[24:25] op_sel:[0,1,0] op_sel_hi:[1,1,1] neg_lo:[1,0,0] neg_hi:[1,0,0]
    v_pk_fma_f32 v[26:27], v[178:179], v[144:145], v[26:27] op_sel:[0,1,0] op_sel_hi:[1,1,1] neg_lo:[1,0,0] neg_hi:[1,0,0]
    v_pk_fma_f32 v[28:29], v[180:181], v[144:145], v[28:29] op_sel:[0,1,0] op_sel_hi:[1,1,1] neg_lo:[1,0,0] neg_hi:[1,0,0]
    v_pk_fma_f32 v[30:31], v[182:183], v[144:145], v[30:31] op_sel:[0,1,0] op_sel_hi:[1,1,1] neg_lo:[1,0,0] neg_hi:[1,0,0]
    v_pk_mul_f32 v[124:125], v[24:25], v[192:193] op_sel:[0,0] op_sel_hi:[1,1]
    buffer_load_dwordx4 a[244:247], v2, s[92:95], s46 offen offset:1024
    v_pk_mul_f32 v[126:127], v[26:27], v[194:195] op_sel:[0,0] op_sel_hi:[1,1]
    v_pk_mul_f32 v[128:129], v[28:29], v[196:197] op_sel:[0,0] op_sel_hi:[1,1]
    v_pk_mul_f32 v[130:131], v[30:31], v[198:199] op_sel:[0,0] op_sel_hi:[1,1]
    v_exp_f32 v124, v124
    v_exp_f32 v126, v126
    v_exp_f32 v128, v128
    v_exp_f32 v130, v130
    v_exp_f32 v125, v125
    v_exp_f32 v127, v127
    v_exp_f32 v129, v129
    v_exp_f32 v131, v131
    v_pk_fma_f32 v[24:25], v[24:25], v[184:185], 1.0 op_sel:[0,0,0] op_sel_hi:[1,1,0]
    buffer_load_dwordx4 a[248:251], v2, s[92:95], s46 offen offset:2048
    v_pk_fma_f32 v[26:27], v[26:27], v[186:187], 1.0 op_sel:[0,0,0] op_sel_hi:[1,1,0]
    v_pk_fma_f32 v[28:29], v[28:29], v[188:189], 1.0 op_sel:[0,0,0] op_sel_hi:[1,1,0]
    v_pk_fma_f32 v[30:31], v[30:31], v[190:191], 1.0 op_sel:[0,0,0] op_sel_hi:[1,1,0]
    v_med3_f32 v24, v24, v124, 1.0
    v_med3_f32 v26, v26, v126, 1.0
    v_med3_f32 v28, v28, v128, 1.0
    v_med3_f32 v30, v30, v130, 1.0
    v_med3_f32 v25, v25, v125, 1.0
    v_med3_f32 v27, v27, v127, 1.0
    v_med3_f32 v29, v29, v129, 1.0
    v_med3_f32 v31, v31, v131, 1.0
    v_pk_add_f32 v[24:25], v[24:25], v[134:135] op_sel:[0,1] op_sel_hi:[1,1]
    buffer_load_dwordx4 a[252:255], v2, s[92:95], s46 offen offset:3072
    v_pk_add_f32 v[26:27], v[26:27], v[134:135] op_sel:[0,1] op_sel_hi:[1,1]
    v_pk_add_f32 v[28:29], v[28:29], v[134:135] op_sel:[0,1] op_sel_hi:[1,1]
    v_pk_add_f32 v[30:31], v[30:31], v[134:135] op_sel:[0,1] op_sel_hi:[1,1]
    v_cvt_pk_bf16_f32 v204, v24, v25
    v_cvt_pk_bf16_f32 v205, v26, v27
    v_cvt_pk_bf16_f32 v206, v28, v29
    v_cvt_pk_bf16_f32 v207, v30, v31
    v_pk_fma_f32 v[32:33], v[176:177], v[146:147], v[32:33] op_sel:[0,0,0] op_sel_hi:[1,0,1] neg_lo:[1,0,0] neg_hi:[1,0,0]
    v_pk_fma_f32 v[34:35], v[178:179], v[146:147], v[34:35] op_sel:[0,0,0] op_sel_hi:[1,0,1] neg_lo:[1,0,0] neg_hi:[1,0,0]
    v_pk_fma_f32 v[36:37], v[180:181], v[146:147], v[36:37] op_sel:[0,0,0] op_sel_hi:[1,0,1] neg_lo:[1,0,0] neg_hi:[1,0,0]
    v_pk_fma_f32 v[38:39], v[182:183], v[146:147], v[38:39] op_sel:[0,0,0] op_sel_hi:[1,0,1] neg_lo:[1,0,0] neg_hi:[1,0,0]
    v_pk_mul_f32 v[124:125], v[32:33], v[184:185]
    v_pk_mul_f32 v[126:127], v[34:35], v[186:187]
    v_cvt_pk_bf16_f32 v208, v124, v125
    v_cvt_pk_bf16_f32 v209, v126, v127
    v_pk_mul_f32 v[128:129], v[36:37], v[188:189]
    v_pk_mul_f32 v[130:131], v[38:39], v[190:191]
    v_cvt_pk_bf16_f32 v210, v128, v129
    v_cvt_pk_bf16_f32 v211, v130, v131
    v_pk_fma_f32 v[40:41], v[176:177], v[146:147], v[40:41] op_sel:[0,1,0] op_sel_hi:[1,1,1] neg_lo:[1,0,0] neg_hi:[1,0,0]
    v_pk_fma_f32 v[42:43], v[178:179], v[146:147], v[42:43] op_sel:[0,1,0] op_sel_hi:[1,1,1] neg_lo:[1,0,0] neg_hi:[1,0,0]
    v_pk_fma_f32 v[44:45], v[180:181], v[146:147], v[44:45] op_sel:[0,1,0] op_sel_hi:[1,1,1] neg_lo:[1,0,0] neg_hi:[1,0,0]
    v_pk_fma_f32 v[46:47], v[182:183], v[146:147], v[46:47] op_sel:[0,1,0] op_sel_hi:[1,1,1] neg_lo:[1,0,0] neg_hi:[1,0,0]
    v_pk_mul_f32 v[124:125], v[40:41], v[184:185]
    v_pk_mul_f32 v[126:127], v[42:43], v[186:187]
    v_cvt_pk_bf16_f32 v212, v124, v125
    v_cvt_pk_bf16_f32 v213, v126, v127
    v_pk_mul_f32 v[128:129], v[44:45], v[188:189]
    v_pk_mul_f32 v[130:131], v[46:47], v[190:191]
    v_cvt_pk_bf16_f32 v214, v128, v129
    v_cvt_pk_bf16_f32 v215, v130, v131
    v_pk_fma_f32 v[48:49], v[176:177], v[148:149], v[48:49] op_sel:[0,0,0] op_sel_hi:[1,0,1] neg_lo:[1,0,0] neg_hi:[1,0,0]
    v_pk_fma_f32 v[50:51], v[178:179], v[148:149], v[50:51] op_sel:[0,0,0] op_sel_hi:[1,0,1] neg_lo:[1,0,0] neg_hi:[1,0,0]
    v_pk_fma_f32 v[52:53], v[180:181], v[148:149], v[52:53] op_sel:[0,0,0] op_sel_hi:[1,0,1] neg_lo:[1,0,0] neg_hi:[1,0,0]
    v_pk_fma_f32 v[54:55], v[182:183], v[148:149], v[54:55] op_sel:[0,0,0] op_sel_hi:[1,0,1] neg_lo:[1,0,0] neg_hi:[1,0,0]
    v_pk_mul_f32 v[124:125], v[48:49], v[184:185]
    v_pk_mul_f32 v[126:127], v[50:51], v[186:187]
    v_cvt_pk_bf16_f32 v136, v124, v125
    v_cvt_pk_bf16_f32 v137, v126, v127
    v_pk_mul_f32 v[128:129], v[52:53], v[188:189]
    v_pk_mul_f32 v[130:131], v[54:55], v[190:191]
    v_cvt_pk_bf16_f32 v138, v128, v129
    v_cvt_pk_bf16_f32 v139, v130, v131
    v_pk_mul_f32 v[124:125], v[48:49], v[192:193] op_sel:[0,0] op_sel_hi:[1,1]
    v_pk_mul_f32 v[126:127], v[50:51], v[194:195] op_sel:[0,0] op_sel_hi:[1,1]
    v_pk_mul_f32 v[128:129], v[52:53], v[196:197] op_sel:[0,0] op_sel_hi:[1,1]
    v_pk_mul_f32 v[130:131], v[54:55], v[198:199] op_sel:[0,0] op_sel_hi:[1,1]
    v_exp_f32 v124, v124
    v_exp_f32 v126, v126
    v_exp_f32 v128, v128
    v_exp_f32 v130, v130
    v_exp_f32 v125, v125
    v_exp_f32 v127, v127
    v_exp_f32 v129, v129
    v_exp_f32 v131, v131
    v_pk_fma_f32 v[48:49], v[48:49], v[184:185], 1.0 op_sel:[0,0,0] op_sel_hi:[1,1,0]
    v_pk_fma_f32 v[50:51], v[50:51], v[186:187], 1.0 op_sel:[0,0,0] op_sel_hi:[1,1,0]
    v_pk_fma_f32 v[52:53], v[52:53], v[188:189], 1.0 op_sel:[0,0,0] op_sel_hi:[1,1,0]
    v_pk_fma_f32 v[54:55], v[54:55], v[190:191], 1.0 op_sel:[0,0,0] op_sel_hi:[1,1,0]
    v_med3_f32 v48, v48, v124, 1.0
    v_med3_f32 v50, v50, v126, 1.0
    v_med3_f32 v52, v52, v128, 1.0
    v_med3_f32 v54, v54, v130, 1.0
    v_med3_f32 v49, v49, v125, 1.0
    v_med3_f32 v51, v51, v127, 1.0
    v_med3_f32 v53, v53, v129, 1.0
    v_med3_f32 v55, v55, v131, 1.0
    v_pk_add_f32 v[48:49], v[48:49], v[134:135] op_sel:[0,1] op_sel_hi:[1,1]
    v_pk_add_f32 v[50:51], v[50:51], v[134:135] op_sel:[0,1] op_sel_hi:[1,1]
    v_pk_add_f32 v[52:53], v[52:53], v[134:135] op_sel:[0,1] op_sel_hi:[1,1]
    v_pk_add_f32 v[54:55], v[54:55], v[134:135] op_sel:[0,1] op_sel_hi:[1,1]
    v_cvt_pk_bf16_f32 v216, v48, v49
    v_cvt_pk_bf16_f32 v217, v50, v51
    v_cvt_pk_bf16_f32 v218, v52, v53
    v_cvt_pk_bf16_f32 v219, v54, v55
    v_cndmask_b32 v216, v216, v136, s[36:37]
    v_cndmask_b32 v217, v217, v137, s[36:37]
    v_cndmask_b32 v218, v218, v138, s[36:37]
    v_cndmask_b32 v219, v219, v139, s[36:37]
    s_mul_i32 s24, s3, 7168
    s_add_u32 s24, s24, 131072
    v_add_u32 v10, s24, v2
    s_lshr_b32 s24, s6, 1
    s_lshl_b32 s24, s24, 3
    s_lshr_b32 s25, s7, 2
    s_add_u32 s24, s24, s25
    s_mul_i32 s24, s24, 331776
    s_add_u32 s24, s24, 2801664
    s_add_u32 s36, s4, s24
    s_addc_u32 s37, s5, 0
    s_mov_b32 s38, 331776
    s_mov_b32 s39, 0x20000
    s_mul_i32 s22, s3, 18432
    v_mfma_f32_16x16x32_bf16 v[16:19], v[200:203], v[208:211], 0
    v_mfma_f32_16x16x32_bf16 v[20:23], v[204:207], v[212:215], 0
    v_mfma_f32_16x16x32_bf16 v[24:27], v[200:203], v[216:219], 0
    v_mfma_f32_16x16x32_bf16 v[28:31], v[204:207], v[216:219], 0
    v_mfma_f32_16x16x32_bf16 v[32:35], v[216:219], v[208:211], 0
    v_mfma_f32_16x16x32_bf16 v[36:39], v[216:219], v[212:215], 0
    v_mfma_f32_16x16x32_bf16 v[40:43], v[216:219], v[216:219], 0
    s_waitcnt lgkmcnt(5)
    v_mfma_f32_16x16x32_bf16 v[56:59], v[80:83], a[0:3], 0
    ds_read_b128 v[104:107], v8 offset:15360
    ds_write_b128 v10, v[16:19] offset:0
    v_mfma_f32_16x16x32_bf16 v[60:63], v[80:83], a[4:7], 0
    s_waitcnt lgkmcnt(6)
    ds_write_b128 v10, v[20:23] offset:1024
    v_mfma_f32_16x16x32_bf16 v[64:67], v[84:87], a[0:3], 0
    ds_read_b128 v[108:111], v8 offset:16384
    ds_write_b128 v10, v[24:27] offset:2048
    v_mfma_f32_16x16x32_bf16 v[68:71], v[84:87], a[4:7], 0
    s_waitcnt lgkmcnt(8)
    ds_write_b128 v10, v[28:31] offset:3072
    v_mfma_f32_16x16x32_bf16 v[72:75], v[88:91], a[0:3], 0
    ds_read_b128 v[112:115], v8 offset:14336
    ds_write_b128 v10, v[32:35] offset:4096
    v_mfma_f32_16x16x32_bf16 v[76:79], v[88:91], a[4:7], 0
    s_waitcnt lgkmcnt(10)
    ds_write_b128 v10, v[36:39] offset:5120
    v_mfma_f32_16x16x32_bf16 v[56:59], v[92:95], a[8:11], v[56:59]
    ds_read_b128 v[80:83], v8 offset:18432
    ds_write_b128 v10, v[40:43] offset:6144
    v_mfma_f32_16x16x32_bf16 v[60:63], v[92:95], a[12:15], v[60:63]
    s_waitcnt lgkmcnt(12)
    v_mfma_f32_16x16x32_bf16 v[64:67], v[96:99], a[8:11], v[64:67]
    ds_read_b128 v[84:87], v8 offset:19456
    v_mfma_f32_16x16x32_bf16 v[68:71], v[96:99], a[12:15], v[68:71]
    s_waitcnt lgkmcnt(12)
    v_mfma_f32_16x16x32_bf16 v[72:75], v[100:103], a[8:11], v[72:75]
    ds_read_b128 v[88:91], v8 offset:17408
    v_mfma_f32_16x16x32_bf16 v[76:79], v[100:103], a[12:15], v[76:79]
    s_waitcnt lgkmcnt(12)
    v_mfma_f32_16x16x32_bf16 v[56:59], v[104:107], a[16:19], v[56:59]
    ds_read_b128 v[92:95], v8 offset:21504
    v_mfma_f32_16x16x32_bf16 v[60:63], v[104:107], a[20:23], v[60:63]
    s_waitcnt lgkmcnt(10)
    v_mfma_f32_16x16x32_bf16 v[64:67], v[108:111], a[16:19], v[64:67]
    ds_read_b128 v[96:99], v8 offset:22528
    v_mfma_f32_16x16x32_bf16 v[68:71], v[108:111], a[20:23], v[68:71]
    s_waitcnt lgkmcnt(8)
    v_mfma_f32_16x16x32_bf16 v[72:75], v[112:115], a[16:19], v[72:75]
    ds_read_b128 v[100:103], v8 offset:20480
    v_mfma_f32_16x16x32_bf16 v[76:79], v[112:115], a[20:23], v[76:79]
    s_waitcnt lgkmcnt(6)
    v_mfma_f32_16x16x32_bf16 v[56:59], v[80:83], a[24:27], v[56:59]
    ds_read_b128 v[104:107], v8 offset:24576
    v_mfma_f32_16x16x32_bf16 v[60:63], v[80:83], a[28:31], v[60:63]
    s_waitcnt lgkmcnt(5)
    v_mfma_f32_16x16x32_bf16 v[64:67], v[84:87], a[24:27], v[64:67]
    ds_read_b128 v[108:111], v8 offset:25600
    v_mfma_f32_16x16x32_bf16 v[68:71], v[84:87], a[28:31], v[68:71]
    s_waitcnt lgkmcnt(5)
    v_mfma_f32_16x16x32_bf16 v[72:75], v[88:91], a[24:27], v[72:75]
    ds_read_b128 v[112:115], v8 offset:23552
    v_mfma_f32_16x16x32_bf16 v[76:79], v[88:91], a[28:31], v[76:79]
    s_waitcnt lgkmcnt(5)
    v_mfma_f32_16x16x32_bf16 v[56:59], v[92:95], a[32:35], v[56:59]
    s_barrier
    ds_read_b128 v[80:83], v8 offset:27648
    v_mfma_f32_16x16x32_bf16 v[60:63], v[92:95], a[36:39], v[60:63]
    s_waitcnt lgkmcnt(5)
    ds_read_b32 v44, v164 offset:0
    v_mfma_f32_16x16x32_bf16 v[64:67], v[96:99], a[32:35], v[64:67]
    ds_read_b128 v[84:87], v8 offset:28672
    ds_read_b32 v45, v164 offset:7168
    v_mfma_f32_16x16x32_bf16 v[68:71], v[96:99], a[36:39], v[68:71]
    s_waitcnt lgkmcnt(7)
    ds_read_b32 v46, v164 offset:14336
    buffer_load_dwordx4 a[0:3], v2, s[92:95], s47 offen offset:0
    v_mfma_f32_16x16x32_bf16 v[72:75], v[100:103], a[32:35], v[72:75]
    ds_read_b128 v[88:91], v8 offset:26624
    ds_read_b32 v47, v164 offset:21504
    v_mfma_f32_16x16x32_bf16 v[76:79], v[100:103], a[36:39], v[76:79]
    s_waitcnt lgkmcnt(9)
    ds_read_b32 v48, v165 offset:0
    v_mfma_f32_16x16x32_bf16 v[56:59], v[104:107], a[40:43], v[56:59]
    ds_read_b128 v[92:95], v8 offset:30720
    ds_read_b32 v49, v165 offset:7168
    v_mfma_f32_16x16x32_bf16 v[60:63], v[104:107], a[44:47], v[60:63]
    s_waitcnt lgkmcnt(11)
    ds_read_b32 v50, v165 offset:14336
    buffer_load_dwordx4 a[4:7], v2, s[92:95], s47 offen offset:1024
    v_mfma_f32_16x16x32_bf16 v[64:67], v[108:111], a[40:43], v[64:67]
    ds_read_b128 v[96:99], v8 offset:31744
    ds_read_b32 v51, v165 offset:21504
    v_mfma_f32_16x16x32_bf16 v[68:71], v[108:111], a[44:47], v[68:71]
    s_waitcnt lgkmcnt(13)
    ds_read_b32 v52, v166 offset:0
    v_mfma_f32_16x16x32_bf16 v[72:75], v[112:115], a[40:43], v[72:75]
    ds_read_b128 v[100:103], v8 offset:29696
    ds_read_b32 v53, v166 offset:7168
    v_mfma_f32_16x16x32_bf16 v[76:79], v[112:115], a[44:47], v[76:79]
    ds_read_b32 v54, v166 offset:14336
    buffer_load_dwordx4 a[8:11], v2, s[92:95], s47 offen offset:2048
    v_mfma_f32_16x16x32_bf16 v[56:59], v[80:83], a[48:51], v[56:59]
    ds_read_b128 v[104:107], v8 offset:33792
    ds_read_b32 v55, v166 offset:21504
    v_mfma_f32_16x16x32_bf16 v[60:63], v[80:83], a[52:55], v[60:63]
    v_mfma_f32_16x16x32_bf16 v[64:67], v[84:87], a[48:51], v[64:67]
    ds_read_b128 v[108:111], v8 offset:34816
    v_mfma_f32_16x16x32_bf16 v[68:71], v[84:87], a[52:55], v[68:71]
    s_waitcnt lgkmcnt(14)
    v_mfma_f32_16x16x32_bf16 v[72:75], v[88:91], a[48:51], v[72:75]
    ds_read_b128 v[112:115], v8 offset:32768
    buffer_load_dwordx4 a[12:15], v2, s[92:95], s47 offen offset:3072
    v_mfma_f32_16x16x32_bf16 v[76:79], v[88:91], a[52:55], v[76:79]
    s_waitcnt lgkmcnt(12)
    v_mfma_f32_16x16x32_bf16 v[56:59], v[92:95], a[56:59], v[56:59]
    ds_read_b128 v[80:83], v8 offset:36864
    v_add_f32 v44, v44, v45
    v_mfma_f32_16x16x32_bf16 v[60:63], v[92:95], a[60:63], v[60:63]
    s_waitcnt lgkmcnt(10)
    v_add_f32 v46, v46, v47
    v_mfma_f32_16x16x32_bf16 v[64:67], v[96:99], a[56:59], v[64:67]
    ds_read_b128 v[84:87], v8 offset:37888
    v_add_f32 v44, v44, v46
    v_mfma_f32_16x16x32_bf16 v[68:71], v[96:99], a[60:63], v[68:71]
    s_waitcnt lgkmcnt(8)
    buffer_atomic_add_f32 v44, v167, s[32:35], 0 offen
    buffer_load_dwordx4 a[16:19], v2, s[92:95], s48 offen offset:0
    v_mfma_f32_16x16x32_bf16 v[72:75], v[100:103], a[56:59], v[72:75]
    ds_read_b128 v[88:91], v8 offset:35840
    v_add_f32 v48, v48, v49
    v_mfma_f32_16x16x32_bf16 v[76:79], v[100:103], a[60:63], v[76:79]
    s_waitcnt lgkmcnt(6)
    v_add_f32 v50, v50, v51
    v_mfma_f32_16x16x32_bf16 v[56:59], v[104:107], a[64:67], v[56:59]
    ds_read_b128 v[92:95], v8 offset:39936
    v_add_f32 v48, v48, v50
    v_mfma_f32_16x16x32_bf16 v[60:63], v[104:107], a[68:71], v[60:63]
    s_waitcnt lgkmcnt(5)
    buffer_atomic_add_f32 v48, v168, s[32:35], 0 offen
    buffer_load_dwordx4 a[20:23], v2, s[92:95], s48 offen offset:1024
    v_mfma_f32_16x16x32_bf16 v[64:67], v[108:111], a[64:67], v[64:67]
    ds_read_b128 v[96:99], v8 offset:40960
    v_add_f32 v52, v52, v53
    v_mfma_f32_16x16x32_bf16 v[68:71], v[108:111], a[68:71], v[68:71]
    s_waitcnt lgkmcnt(5)
    v_add_f32 v54, v54, v55
    v_mfma_f32_16x16x32_bf16 v[72:75], v[112:115], a[64:67], v[72:75]
    ds_read_b128 v[100:103], v8 offset:38912
    v_add_f32 v52, v52, v54
    v_mfma_f32_16x16x32_bf16 v[76:79], v[112:115], a[68:71], v[76:79]
    s_waitcnt lgkmcnt(5)
    buffer_atomic_add_f32 v52, v169, s[32:35], 0 offen
    v_mfma_f32_16x16x32_bf16 v[56:59], v[80:83], a[72:75], v[56:59]
    ds_read_b128 v[104:107], v8 offset:43008
    buffer_load_dwordx4 a[24:27], v2, s[92:95], s48 offen offset:2048
    v_mfma_f32_16x16x32_bf16 v[60:63], v[80:83], a[76:79], v[60:63]
    s_waitcnt lgkmcnt(5)
    v_mfma_f32_16x16x32_bf16 v[64:67], v[84:87], a[72:75], v[64:67]
    ds_read_b128 v[108:111], v8 offset:44032
    v_mfma_f32_16x16x32_bf16 v[68:71], v[84:87], a[76:79], v[68:71]
    s_waitcnt lgkmcnt(5)
    v_mfma_f32_16x16x32_bf16 v[72:75], v[88:91], a[72:75], v[72:75]
    ds_read_b128 v[112:115], v8 offset:41984
    buffer_load_dwordx4 a[28:31], v2, s[92:95], s48 offen offset:3072
    v_mfma_f32_16x16x32_bf16 v[76:79], v[88:91], a[76:79], v[76:79]
    s_waitcnt lgkmcnt(5)
    v_mfma_f32_16x16x32_bf16 v[56:59], v[92:95], a[80:83], v[56:59]
    ds_read_b128 v[80:83], v8 offset:46080
    v_mfma_f32_16x16x32_bf16 v[60:63], v[92:95], a[84:87], v[60:63]
    s_waitcnt lgkmcnt(5)
    v_mfma_f32_16x16x32_bf16 v[64:67], v[96:99], a[80:83], v[64:67]
    ds_read_b128 v[84:87], v8 offset:47104
    v_mfma_f32_16x16x32_bf16 v[68:71], v[96:99], a[84:87], v[68:71]
    s_waitcnt lgkmcnt(5)
    buffer_load_dwordx4 a[32:35], v2, s[92:95], s49 offen offset:0
    v_mfma_f32_16x16x32_bf16 v[72:75], v[100:103], a[80:83], v[72:75]
    ds_read_b128 v[88:91], v8 offset:45056
    v_mfma_f32_16x16x32_bf16 v[76:79], v[100:103], a[84:87], v[76:79]
    s_waitcnt lgkmcnt(5)
    v_mfma_f32_16x16x32_bf16 v[56:59], v[104:107], a[88:91], v[56:59]
    ds_read_b128 v[92:95], v8 offset:49152
    v_mfma_f32_16x16x32_bf16 v[60:63], v[104:107], a[92:95], v[60:63]
    s_waitcnt lgkmcnt(5)
    v_mfma_f32_16x16x32_bf16 v[64:67], v[108:111], a[88:91], v[64:67]
    ds_read_b128 v[96:99], v8 offset:50176
    buffer_load_dwordx4 a[36:39], v2, s[92:95], s49 offen offset:1024
    v_mfma_f32_16x16x32_bf16 v[68:71], v[108:111], a[92:95], v[68:71]
    s_waitcnt lgkmcnt(5)
    v_mfma_f32_16x16x32_bf16 v[72:75], v[112:115], a[88:91], v[72:75]
    ds_read_b128 v[100:103], v8 offset:48128
    v_mfma_f32_16x16x32_bf16 v[76:79], v[112:115], a[92:95], v[76:79]
    s_waitcnt lgkmcnt(5)
    v_mfma_f32_16x16x32_bf16 v[56:59], v[80:83], a[96:99], v[56:59]
    ds_read_b128 v[104:107], v8 offset:52224
    v_mfma_f32_16x16x32_bf16 v[60:63], v[80:83], a[100:103], v[60:63]
    s_waitcnt lgkmcnt(5)
    buffer_load_dwordx4 a[40:43], v2, s[92:95], s49 offen offset:2048
    v_mfma_f32_16x16x32_bf16 v[64:67], v[84:87], a[96:99], v[64:67]
    ds_read_b128 v[108:111], v8 offset:53248
    v_mfma_f32_16x16x32_bf16 v[68:71], v[84:87], a[100:103], v[68:71]
    s_waitcnt lgkmcnt(5)
    v_mfma_f32_16x16x32_bf16 v[72:75], v[88:91], a[96:99], v[72:75]
    ds_read_b128 v[112:115], v8 offset:51200
    v_mfma_f32_16x16x32_bf16 v[76:79], v[88:91], a[100:103], v[76:79]
    s_waitcnt lgkmcnt(5)
    buffer_load_dwordx4 a[44:47], v2, s[92:95], s49 offen offset:3072
    v_mfma_f32_16x16x32_bf16 v[56:59], v[92:95], a[104:107], v[56:59]
    ds_read_b128 v[80:83], v8 offset:55296
    v_mfma_f32_16x16x32_bf16 v[60:63], v[92:95], a[108:111], v[60:63]
    s_waitcnt lgkmcnt(5)
    v_mfma_f32_16x16x32_bf16 v[64:67], v[96:99], a[104:107], v[64:67]
    ds_read_b128 v[84:87], v8 offset:56320
    v_mfma_f32_16x16x32_bf16 v[68:71], v[96:99], a[108:111], v[68:71]
    s_waitcnt lgkmcnt(5)
    v_mfma_f32_16x16x32_bf16 v[72:75], v[100:103], a[104:107], v[72:75]
    ds_read_b128 v[88:91], v8 offset:54272
    buffer_load_dwordx4 a[48:51], v2, s[92:95], s50 offen offset:0
    v_mfma_f32_16x16x32_bf16 v[76:79], v[100:103], a[108:111], v[76:79]
    s_waitcnt lgkmcnt(5)
    v_mfma_f32_16x16x32_bf16 v[56:59], v[104:107], a[112:115], v[56:59]
    ds_read_b128 v[92:95], v8 offset:58368
    v_mfma_f32_16x16x32_bf16 v[60:63], v[104:107], a[116:119], v[60:63]
    s_waitcnt lgkmcnt(5)
    v_mfma_f32_16x16x32_bf16 v[64:67], v[108:111], a[112:115], v[64:67]
    ds_read_b128 v[96:99], v8 offset:59392
    v_mfma_f32_16x16x32_bf16 v[68:71], v[108:111], a[116:119], v[68:71]
    s_waitcnt lgkmcnt(5)
    buffer_load_dwordx4 a[52:55], v2, s[92:95], s50 offen offset:1024
    v_mfma_f32_16x16x32_bf16 v[72:75], v[112:115], a[112:115], v[72:75]
    ds_read_b128 v[100:103], v8 offset:57344
    v_mfma_f32_16x16x32_bf16 v[76:79], v[112:115], a[116:119], v[76:79]
    s_waitcnt lgkmcnt(5)
    v_mfma_f32_16x16x32_bf16 v[56:59], v[80:83], a[120:123], v[56:59]
    ds_read_b128 v[104:107], v8 offset:61440
    v_mfma_f32_16x16x32_bf16 v[60:63], v[80:83], a[124:127], v[60:63]
    s_waitcnt lgkmcnt(5)
    buffer_load_dwordx4 a[56:59], v2, s[92:95], s50 offen offset:2048
    v_mfma_f32_16x16x32_bf16 v[64:67], v[84:87], a[120:123], v[64:67]
    ds_read_b128 v[108:111], v8 offset:62464
    v_mfma_f32_16x16x32_bf16 v[68:71], v[84:87], a[124:127], v[68:71]
    s_waitcnt lgkmcnt(5)
    v_mfma_f32_16x16x32_bf16 v[72:75], v[88:91], a[120:123], v[72:75]
    ds_read_b128 v[112:115], v8 offset:60416
    v_mfma_f32_16x16x32_bf16 v[76:79], v[88:91], a[124:127], v[76:79]
    s_waitcnt lgkmcnt(5)
    v_mfma_f32_16x16x32_bf16 v[56:59], v[92:95], a[128:131], v[56:59]
    buffer_load_dwordx4 a[60:63], v2, s[92:95], s50 offen offset:3072
    v_mfma_f32_16x16x32_bf16 v[60:63], v[92:95], a[132:135], v[60:63]
    s_waitcnt lgkmcnt(4)
    v_mfma_f32_16x16x32_bf16 v[64:67], v[96:99], a[128:131], v[64:67]
    v_mfma_f32_16x16x32_bf16 v[68:71], v[96:99], a[132:135], v[68:71]
    s_waitcnt lgkmcnt(3)
    v_mfma_f32_16x16x32_bf16 v[72:75], v[100:103], a[128:131], v[72:75]
    v_mfma_f32_16x16x32_bf16 v[76:79], v[100:103], a[132:135], v[76:79]
    s_waitcnt lgkmcnt(2)
    buffer_load_dwordx4 a[64:67], v2, s[92:95], s51 offen offset:0
    v_mfma_f32_16x16x32_bf16 v[56:59], v[104:107], a[136:139], v[56:59]
    v_mfma_f32_16x16x32_bf16 v[60:63], v[104:107], a[140:143], v[60:63]
    s_waitcnt lgkmcnt(1)
    v_mfma_f32_16x16x32_bf16 v[64:67], v[108:111], a[136:139], v[64:67]
    v_mfma_f32_16x16x32_bf16 v[68:71], v[108:111], a[140:143], v[68:71]
    s_waitcnt lgkmcnt(0)
    v_mfma_f32_16x16x32_bf16 v[72:75], v[112:115], a[136:139], v[72:75]
    v_mfma_f32_16x16x32_bf16 v[76:79], v[112:115], a[140:143], v[76:79]
    s_lshl_b32 s24, s23, 15
    s_lshl_b32 s25, s21, 11
    s_add_u32 s24, s24, s25
    s_add_u32 s24, s24, 5230592
    s_add_u32 s12, s58, s24
    s_addc_u32 s13, s59, 0
    s_mov_b32 s14, 34816
    s_mov_b32 s15, 0x20000
    s_lshl_b32 s24, s21, 11
    s_cmp_eq_u32 s3, 0
    s_cselect_b32 s24, s24, 1073741824
    v_pk_fma_f32 v[72:73], v[170:171], v[152:153], v[72:73] op_sel:[0,0,0] op_sel_hi:[0,1,1] neg_lo:[1,0,0] neg_hi:[1,0,0]
    v_pk_fma_f32 v[74:75], v[170:171], v[154:155], v[74:75] op_sel:[0,0,0] op_sel_hi:[0,1,1] neg_lo:[1,0,0] neg_hi:[1,0,0]
    v_pk_fma_f32 v[76:77], v[170:171], v[152:153], v[76:77] op_sel:[1,0,0] op_sel_hi:[1,1,1] neg_lo:[1,0,0] neg_hi:[1,0,0]
    v_pk_fma_f32 v[78:79], v[170:171], v[154:155], v[78:79] op_sel:[1,0,0] op_sel_hi:[1,1,1] neg_lo:[1,0,0] neg_hi:[1,0,0]
    v_pk_mul_f32 v[124:125], v[72:73], v[174:175] op_sel:[0,0] op_sel_hi:[1,0]
    v_pk_mul_f32 v[126:127], v[74:75], v[174:175] op_sel:[0,0] op_sel_hi:[1,0]
    v_pk_mul_f32 v[128:129], v[76:77], v[174:175] op_sel:[0,1] op_sel_hi:[1,1]
    v_pk_mul_f32 v[130:131], v[78:79], v[174:175] op_sel:[0,1] op_sel_hi:[1,1]
    v_exp_f32 v124, v124
    v_exp_f32 v126, v126
    v_exp_f32 v128, v128
    v_exp_f32 v130, v130
    v_exp_f32 v125, v125
    v_exp_f32 v127, v127
    v_exp_f32 v129, v129
    v_exp_f32 v131, v131
    v_pk_fma_f32 v[72:73], v[72:73], v[172:173], 1.0 op_sel:[0,0,0] op_sel_hi:[1,0,0]
    v_pk_fma_f32 v[74:75], v[74:75], v[172:173], 1.0 op_sel:[0,0,0] op_sel_hi:[1,0,0]
    v_pk_fma_f32 v[76:77], v[76:77], v[172:173], 1.0 op_sel:[0,1,0] op_sel_hi:[1,1,0]
    v_pk_fma_f32 v[78:79], v[78:79], v[172:173], 1.0 op_sel:[0,1,0] op_sel_hi:[1,1,0]
    v_med3_f32 v72, v72, v124, 1.0
    v_med3_f32 v74, v74, v126, 1.0
    v_med3_f32 v76, v76, v128, 1.0
    v_med3_f32 v78, v78, v130, 1.0
    v_med3_f32 v73, v73, v125, 1.0
    v_med3_f32 v75, v75, v127, 1.0
    v_med3_f32 v77, v77, v129, 1.0
    v_med3_f32 v79, v79, v131, 1.0
    v_pk_add_f32 v[72:73], v[72:73], v[134:135] op_sel:[0,1] op_sel_hi:[1,1]
    v_pk_add_f32 v[74:75], v[74:75], v[134:135] op_sel:[0,1] op_sel_hi:[1,1]
    v_pk_add_f32 v[76:77], v[76:77], v[134:135] op_sel:[0,1] op_sel_hi:[1,1]
    v_pk_add_f32 v[78:79], v[78:79], v[134:135] op_sel:[0,1] op_sel_hi:[1,1]
    v_cvt_pk_bf16_f32 v82, v72, v73
    v_cvt_pk_bf16_f32 v83, v74, v75
    v_cvt_pk_bf16_f32 v86, v76, v77
    v_cvt_pk_bf16_f32 v87, v78, v79
    v_cvt_pk_bf16_f32 v90, v72, v73
    v_cvt_pk_bf16_f32 v91, v74, v75
    v_cvt_pk_bf16_f32 v94, v76, v77
    v_cvt_pk_bf16_f32 v95, v78, v79
    v_pk_fma_f32 v[56:57], v[170:171], v[156:157], v[56:57] op_sel:[0,0,0] op_sel_hi:[0,1,1] neg_lo:[1,0,0] neg_hi:[1,0,0]
    v_pk_fma_f32 v[58:59], v[170:171], v[158:159], v[58:59] op_sel:[0,0,0] op_sel_hi:[0,1,1] neg_lo:[1,0,0] neg_hi:[1,0,0]
    v_pk_fma_f32 v[60:61], v[170:171], v[156:157], v[60:61] op_sel:[1,0,0] op_sel_hi:[1,1,1] neg_lo:[1,0,0] neg_hi:[1,0,0]
    v_pk_fma_f32 v[62:63], v[170:171], v[158:159], v[62:63] op_sel:[1,0,0] op_sel_hi:[1,1,1] neg_lo:[1,0,0] neg_hi:[1,0,0]
    v_pk_mul_f32 v[124:125], v[56:57], v[174:175] op_sel:[0,0] op_sel_hi:[1,0]
    v_pk_mul_f32 v[126:127], v[58:59], v[174:175] op_sel:[0,0] op_sel_hi:[1,0]
    v_pk_mul_f32 v[128:129], v[60:61], v[174:175] op_sel:[0,1] op_sel_hi:[1,1]
    v_pk_mul_f32 v[130:131], v[62:63], v[174:175] op_sel:[0,1] op_sel_hi:[1,1]
    v_exp_f32 v124, v124
    v_exp_f32 v126, v126
    v_exp_f32 v128, v128
    v_exp_f32 v130, v130
    v_exp_f32 v125, v125
    v_exp_f32 v127, v127
    v_exp_f32 v129, v129
    v_exp_f32 v131, v131
    v_pk_fma_f32 v[56:57], v[56:57], v[172:173], 1.0 op_sel:[0,0,0] op_sel_hi:[1,0,0]
    v_pk_fma_f32 v[58:59], v[58:59], v[172:173], 1.0 op_sel:[0,0,0] op_sel_hi:[1,0,0]
    v_pk_fma_f32 v[60:61], v[60:61], v[172:173], 1.0 op_sel:[0,1,0] op_sel_hi:[1,1,0]
    v_pk_fma_f32 v[62:63], v[62:63], v[172:173], 1.0 op_sel:[0,1,0] op_sel_hi:[1,1,0]
    v_med3_f32 v56, v56, v124, 1.0
    v_med3_f32 v58, v58, v126, 1.0
    v_med3_f32 v60, v60, v128, 1.0
    v_med3_f32 v62, v62, v130, 1.0
    v_med3_f32 v57, v57, v125, 1.0
    v_med3_f32 v59, v59, v127, 1.0
    v_med3_f32 v61, v61, v129, 1.0
    v_med3_f32 v63, v63, v131, 1.0
    v_pk_add_f32 v[56:57], v[56:57], v[134:135] op_sel:[0,1] op_sel_hi:[1,1]
    v_pk_add_f32 v[58:59], v[58:59], v[134:135] op_sel:[0,1] op_sel_hi:[1,1]
    v_pk_add_f32 v[60:61], v[60:61], v[134:135] op_sel:[0,1] op_sel_hi:[1,1]
    v_pk_add_f32 v[62:63], v[62:63], v[134:135] op_sel:[0,1] op_sel_hi:[1,1]
    v_cvt_pk_bf16_f32 v80, v56, v57
    v_cvt_pk_bf16_f32 v81, v58, v59
    v_cvt_pk_bf16_f32 v84, v60, v61
    v_cvt_pk_bf16_f32 v85, v62, v63
    buffer_store_dwordx4 v[80:83], v2, s[12:15], 0 offen offset:0 sc1
    buffer_store_dwordx4 v[84:87], v2, s[12:15], s48 offen offset:0 sc1
    s_waitcnt vmcnt(13)
    s_barrier
    v_mul_u32_u24 v10, 128, v1
    v_mov_b32 v11, 1
    s_mov_b64 exec, 65535
    buffer_atomic_add v11, v10, s[96:99], s24 offen
    s_mov_b64 exec, -1
    v_pk_fma_f32 v[64:65], v[170:171], v[160:161], v[64:65] op_sel:[0,0,0] op_sel_hi:[0,1,1] neg_lo:[1,0,0] neg_hi:[1,0,0]
    v_pk_fma_f32 v[66:67], v[170:171], v[162:163], v[66:67] op_sel:[0,0,0] op_sel_hi:[0,1,1] neg_lo:[1,0,0] neg_hi:[1,0,0]
    v_pk_fma_f32 v[68:69], v[170:171], v[160:161], v[68:69] op_sel:[1,0,0] op_sel_hi:[1,1,1] neg_lo:[1,0,0] neg_hi:[1,0,0]
    v_pk_fma_f32 v[70:71], v[170:171], v[162:163], v[70:71] op_sel:[1,0,0] op_sel_hi:[1,1,1] neg_lo:[1,0,0] neg_hi:[1,0,0]
    v_pk_mul_f32 v[124:125], v[64:65], v[174:175] op_sel:[0,0] op_sel_hi:[1,0]
    v_pk_mul_f32 v[126:127], v[66:67], v[174:175] op_sel:[0,0] op_sel_hi:[1,0]
    v_pk_mul_f32 v[128:129], v[68:69], v[174:175] op_sel:[0,1] op_sel_hi:[1,1]
    v_pk_mul_f32 v[130:131], v[70:71], v[174:175] op_sel:[0,1] op_sel_hi:[1,1]
    v_exp_f32 v124, v124
    v_exp_f32 v126, v126
    v_exp_f32 v128, v128
    v_exp_f32 v130, v130
    v_exp_f32 v125, v125
    v_exp_f32 v127, v127
    v_exp_f32 v129, v129
    v_exp_f32 v131, v131
    v_pk_fma_f32 v[64:65], v[64:65], v[172:173], 1.0 op_sel:[0,0,0] op_sel_hi:[1,0,0]
    v_pk_fma_f32 v[66:67], v[66:67], v[172:173], 1.0 op_sel:[0,0,0] op_sel_hi:[1,0,0]
    v_pk_fma_f32 v[68:69], v[68:69], v[172:173], 1.0 op_sel:[0,1,0] op_sel_hi:[1,1,0]
    v_pk_fma_f32 v[70:71], v[70:71], v[172:173], 1.0 op_sel:[0,1,0] op_sel_hi:[1,1,0]
    v_med3_f32 v64, v64, v124, 1.0
    v_med3_f32 v66, v66, v126, 1.0
    v_med3_f32 v68, v68, v128, 1.0
    v_med3_f32 v70, v70, v130, 1.0
    v_med3_f32 v65, v65, v125, 1.0
    v_med3_f32 v67, v67, v127, 1.0
    v_med3_f32 v69, v69, v129, 1.0
    v_med3_f32 v71, v71, v131, 1.0
    v_pk_add_f32 v[64:65], v[64:65], v[134:135] op_sel:[0,1] op_sel_hi:[1,1]
    v_pk_add_f32 v[66:67], v[66:67], v[134:135] op_sel:[0,1] op_sel_hi:[1,1]
    v_pk_add_f32 v[68:69], v[68:69], v[134:135] op_sel:[0,1] op_sel_hi:[1,1]
    v_pk_add_f32 v[70:71], v[70:71], v[134:135] op_sel:[0,1] op_sel_hi:[1,1]
    v_cvt_pk_bf16_f32 v88, v64, v65
    v_cvt_pk_bf16_f32 v89, v66, v67
    v_cvt_pk_bf16_f32 v92, v68, v69
    v_cvt_pk_bf16_f32 v93, v70, v71
    buffer_store_dwordx4 v[88:91], v2, s[12:15], 0 offen offset:1024 sc1
    buffer_store_dwordx4 v[92:95], v2, s[12:15], s48 offen offset:1024 sc1
    s_lshl_b32 s24, s23, 1
    s_lshr_b32 s25, s21, 2
    s_add_u32 s24, s24, s25
    s_add_u32 s24, s24, 256
    s_lshl_b32 s24, s24, 7
    v_mul_u32_u24 v10, 128, v1
    v_mov_b32 v11, 1
    s_waitcnt vmcnt(0)
    s_mov_b64 exec, 1
    buffer_atomic_add v11, v10, s[96:99], s24 offen
    s_mov_b64 exec, -1
    s_lshl_b32 s20, s6, 3
    s_and_b32 s21, s7, 7
    s_add_u32 s20, s20, s21
    s_lshr_b32 s21, s7, 3
    s_mul_i32 s22, s3, 12288
    s_add_u32 s23, s22, 114688
    s_add_u32 s22, s22, 2490368
    s_add_u32 s8, s58, s22
    s_addc_u32 s9, s59, 0
    s_mov_b32 s10, 12288
    s_mov_b32 s11, 0x20000
    s_lshl_b32 s22, s20, 16
    s_lshl_b32 s24, s3, 13
    s_add_u32 s22, s22, s24
    s_add_u32 s22, s22, 5230592
    s_add_u32 s12, s58, s22
    s_addc_u32 s13, s59, 0
    s_mov_b32 s14, 40960
    s_mov_b32 s15, 0x20000
    v_lshrrev_b32 v3, 4, v1
    v_and_b32 v4, 15, v1
    v_lshlrev_b32 v5, 4, v3
    v_add_u32 v5, s23, v5
    v_mov_b32 v6, 72
    v_cmp_gt_u32 s[30:31], 16, v1
    s_nop 1
    v_cndmask_b32 v6, v6, 64, s[30:31]
    v_add_u32 v6, s23, v6
    v_mul_u32_u24 v7, 80, v4
    v_add_u32 v8, v5, v7
    v_add_u32 v9, v6, v7
    v_and_b32 v7, 3, v4
    v_cmp_eq_u32 s[32:33], 2, v7
    v_lshrrev_b32 v18, 1, v4
    v_and_b32 v19, 1, v4
    v_mul_u32_u24 v19, 80, v19
    v_add_u32 v19, 1280, v19
    s_add_u32 s24, s23, 1520
    v_mov_b32 v20, s24
    v_mov_b32 v22, 1440
    v_cmp_eq_u32 s[34:35], 0, v18
    s_nop 1
    v_cndmask_b32 v21, v22, v19, s[34:35]
    s_or_b64 s[34:35], s[34:35], s[32:33]
    v_add_u32 v23, v21, v5
    v_cndmask_b32 v10, v20, v23, s[34:35]
    v_add_u32 v23, v21, v6
    v_cndmask_b32 v14, v20, v23, s[34:35]
    v_cmp_eq_u32 s[34:35], 2, v18
    s_nop 1
    v_cndmask_b32 v21, v22, v19, s[34:35]
    s_or_b64 s[34:35], s[34:35], s[32:33]
    v_add_u32 v23, v21, v5
    v_cndmask_b32 v11, v20, v23, s[34:35]
    v_add_u32 v23, v21, v6
    v_cndmask_b32 v15, v20, v23, s[34:35]
    v_cmp_eq_u32 s[34:35], 4, v18
    s_nop 1
    v_cndmask_b32 v21, v22, v19, s[34:35]
    s_or_b64 s[34:35], s[34:35], s[32:33]
    v_add_u32 v23, v21, v5
    v_cndmask_b32 v12, v20, v23, s[34:35]
    v_add_u32 v23, v21, v6
    v_cndmask_b32 v16, v20, v23, s[34:35]
    v_cmp_eq_u32 s[34:35], 6, v18
    s_nop 1
    v_cndmask_b32 v21, v22, v19, s[34:35]
    s_or_b64 s[34:35], s[34:35], s[32:33]
    v_add_u32 v23, v21, v5
    v_cndmask_b32 v13, v20, v23, s[34:35]
    v_add_u32 v23, v21, v6
    v_cndmask_b32 v17, v20, v23, s[34:35]
    s_lshr_b32 s24, s3, 1
    s_lshl_b32 s25, s20, 1
    s_add_u32 s24, s24, s25
    s_mul_i32 s25, s24, 18432
    s_mul_i32 s26, s21, 4608
    s_add_u32 s25, s25, s26
    s_add_u32 s26, s25, 0
    s_add_u32 s52, s58, s26
    s_addc_u32 s53, s59, 0
    s_mov_b32 s54, 4608
    s_mov_b32 s55, 0x20000
    s_and_b32 s27, s3, 1
    s_lshl_b32 s28, s27, 10
    v_add_u32 v24, s28, v2
    s_mov_b32 s56, 0x00003f80
    s_mov_b32 s57, 0x3f800000
    s_mov_b32 s40, 0x3f803f80
    s_lshl_b32 s29, s24, 10
    s_lshl_b32 s26, s21, 8
    s_add_u32 s29, s29, s26
    s_lshl_b32 s26, s27, 3
    s_add_u32 s29, s29, s26
    v_mov_b32 v250, 0
    v_mov_b32 v251, 0
    v_mov_b32 v254, 0
    v_mov_b32 v255, 0
    s_lshl_b32 s26, s3, 6
    s_and_b32 s22, s2, 15
    s_add_u32 s26, s26, s22
    v_lshl_add_u32 v25, v1, 4, s26
    s_lshl_b32 s26, s20, 2
    s_add_u32 s26, s26, s3
    s_add_u32 s26, s26, 256
    v_mov_b32 v26, s26
    v_cmp_gt_u32 vcc, 4, v1
    s_nop 1
    v_cndmask_b32 v25, v26, v25, vcc
    v_lshlrev_b32 v25, 7, v25
    v_cndmask_b32 v26, 4, 16, vcc
    s_mul_i32 s22, s3, 9216
    s_lshl_b32 s34, s22, 1
    s_add_u32 s22, s22, 73728
    s_add_u32 m0, s34, 0
    s_nop 0
    buffer_load_dwordx4 v2, s[36:39], m0 offen offset:0 lds
    buffer_load_dwordx4 v2, s[36:39], m0 offen offset:1024 lds
    buffer_load_dwordx4 v2, s[36:39], m0 offen offset:2048 lds
    buffer_load_dwordx4 v2, s[36:39], m0 offen offset:3072 lds
    s_add_u32 m0, s34, 4096
    s_nop 0
    buffer_load_dwordx4 v2, s[36:39], m0 offen offset:0 lds
    buffer_load_dwordx4 v2, s[36:39], m0 offen offset:1024 lds
    buffer_load_dwordx4 v2, s[36:39], m0 offen offset:2048 lds
    buffer_load_dwordx4 v2, s[36:39], m0 offen offset:3072 lds
    s_mov_b64 exec, 31
    s_mov_b32 s61, 200000
POLL_mk_8:
    v_mov_b32 v27, 0
    buffer_atomic_add v27, v25, s[96:99], 0 offen sc0
    s_waitcnt vmcnt(0)
    v_cmp_gt_u32 vcc, v26, v27
    s_nop 0
    s_cbranch_vccz PDONE_mk_9
    s_sub_u32 s61, s61, 1
    s_cmp_lg_u32 s61, 0
    s_cbranch_scc1 POLL_mk_8
PDONE_mk_9:
    s_mov_b64 exec, -1
    s_add_u32 m0, s23, 0
    s_nop 0
    buffer_load_dwordx4 v2, s[8:11], 0 offen offset:0 sc1 lds
    buffer_load_dwordx4 v2, s[8:11], 0 offen offset:1024 sc1 lds
    buffer_load_dwordx4 v2, s[8:11], 0 offen offset:2048 sc1 lds
    buffer_load_dwordx4 v2, s[8:11], 0 offen offset:3072 sc1 lds
    s_add_u32 m0, s23, 4096
    s_nop 0
    buffer_load_dwordx4 v2, s[8:11], s41 offen offset:0 sc1 lds
    buffer_load_dwordx4 v2, s[8:11], s41 offen offset:1024 sc1 lds
    buffer_load_dwordx4 v2, s[8:11], s41 offen offset:2048 sc1 lds
    buffer_load_dwordx4 v2, s[8:11], s41 offen offset:3072 sc1 lds
    s_add_u32 m0, s23, 8192
    s_nop 0
    buffer_load_dwordx4 v2, s[8:11], s42 offen offset:0 sc1 lds
    buffer_load_dwordx4 v2, s[8:11], s42 offen offset:1024 sc1 lds
    buffer_load_dwordx4 v2, s[8:11], s42 offen offset:2048 sc1 lds
    buffer_load_dwordx4 v2, s[8:11], s42 offen offset:3072 sc1 lds
    buffer_load_dwordx4 a[80:83], v2, s[12:15], 0 offen offset:0 sc1
    buffer_load_dwordx4 a[84:87], v2, s[12:15], s48 offen offset:0 sc1
    buffer_load_dwordx4 a[88:91], v2, s[12:15], 0 offen offset:1024 sc1
    buffer_load_dwordx4 a[92:95], v2, s[12:15], s48 offen offset:1024 sc1
    buffer_load_dwordx4 a[96:99], v2, s[12:15], 0 offen offset:2048 sc1
    buffer_load_dwordx4 a[100:103], v2, s[12:15], s48 offen offset:2048 sc1
    buffer_load_dwordx4 a[104:107], v2, s[12:15], 0 offen offset:3072 sc1
    buffer_load_dwordx4 a[108:111], v2, s[12:15], s48 offen offset:3072 sc1
    buffer_load_dwordx4 a[112:115], v2, s[12:15], s41 offen offset:0 sc1
    buffer_load_dwordx4 a[116:119], v2, s[12:15], s49 offen offset:0 sc1
    buffer_load_dwordx4 a[120:123], v2, s[12:15], s41 offen offset:1024 sc1
    buffer_load_dwordx4 a[124:127], v2, s[12:15], s49 offen offset:1024 sc1
    buffer_load_dwordx4 a[128:131], v2, s[12:15], s41 offen offset:2048 sc1
    buffer_load_dwordx4 a[132:135], v2, s[12:15], s49 offen offset:2048 sc1
    buffer_load_dwordx4 a[136:139], v2, s[12:15], s41 offen offset:3072 sc1
    buffer_load_dwordx4 a[140:143], v2, s[12:15], s49 offen offset:3072 sc1
    s_waitcnt vmcnt(25)
    ds_read_b128 v[104:107], v8 offset:0
    ds_read_b128 v[108:111], v10 offset:0
    ds_read_b64 v[168:169], v9 offset:0
    ds_read_b64 v[170:171], v14 offset:0
    ds_read_b128 v[112:115], v8 offset:1536
    ds_read_b128 v[116:119], v11 offset:1536
    ds_read_b64 v[172:173], v9 offset:1536
    ds_read_b64 v[174:175], v15 offset:1536
    s_waitcnt vmcnt(22)
    ds_read_b128 v[120:123], v8 offset:3072
    ds_read_b128 v[124:127], v12 offset:3072
    ds_read_b64 v[176:177], v9 offset:3072
    ds_read_b64 v[178:179], v16 offset:3072
    ds_read_b128 v[128:131], v8 offset:4608
    ds_read_b128 v[132:135], v13 offset:4608
    ds_read_b64 v[180:181], v9 offset:4608
    ds_read_b64 v[182:183], v17 offset:4608
    s_waitcnt vmcnt(19)
    ds_read_b128 v[136:139], v8 offset:6144
    ds_read_b128 v[140:143], v10 offset:6144
    ds_read_b64 v[184:185], v9 offset:6144
    ds_read_b64 v[186:187], v14 offset:6144
    ds_read_b128 v[144:147], v8 offset:7680
    ds_read_b128 v[148:151], v11 offset:7680
    ds_read_b64 v[188:189], v9 offset:7680
    ds_read_b64 v[190:191], v15 offset:7680
    s_waitcnt vmcnt(16)
    ds_read_b128 v[152:155], v8 offset:9216
    ds_read_b128 v[156:159], v12 offset:9216
    ds_read_b64 v[192:193], v9 offset:9216
    ds_read_b64 v[194:195], v16 offset:9216
    ds_read_b128 v[160:163], v8 offset:10752
    ds_read_b128 v[164:167], v13 offset:10752
    ds_read_b64 v[196:197], v9 offset:10752
    ds_read_b64 v[198:199], v17 offset:10752
    v_cvt_pk_bf16_f32 v104, v104, v105
    v_cvt_pk_bf16_f32 v105, v106, v107
    v_cvt_pk_bf16_f32 v106, v168, v169
    v_mov_b32 v107, 0
    v_cvt_pk_bf16_f32 v108, v108, v109
    v_cvt_pk_bf16_f32 v109, v110, v111
    v_cvt_pk_bf16_f32 v110, v170, v171
    v_mov_b32 v111, 0
    v_cvt_pk_bf16_f32 v112, v112, v113
    v_cvt_pk_bf16_f32 v113, v114, v115
    v_cvt_pk_bf16_f32 v115, v172, v173
    v_mov_b32 v114, 0
    v_cvt_pk_bf16_f32 v116, v116, v117
    v_cvt_pk_bf16_f32 v117, v118, v119
    v_cvt_pk_bf16_f32 v119, v174, v175
    v_mov_b32 v118, 0
    v_cvt_pk_bf16_f32 v120, v120, v121
    v_cvt_pk_bf16_f32 v121, v122, v123
    v_cvt_pk_bf16_f32 v122, v176, v177
    v_mov_b32 v123, 0
    v_cvt_pk_bf16_f32 v124, v124, v125
    v_cvt_pk_bf16_f32 v125, v126, v127
    v_cvt_pk_bf16_f32 v126, v178, v179
    v_mov_b32 v127, 0
    v_cvt_pk_bf16_f32 v128, v128, v129
    v_cvt_pk_bf16_f32 v129, v130, v131
    v_cvt_pk_bf16_f32 v131, v180, v181
    v_mov_b32 v130, 0
    v_cvt_pk_bf16_f32 v132, v132, v133
    v_cvt_pk_bf16_f32 v133, v134, v135
    v_cvt_pk_bf16_f32 v135, v182, v183
    v_mov_b32 v134, 0
    v_cvt_pk_bf16_f32 v136, v136, v137
    v_cvt_pk_bf16_f32 v137, v138, v139
    s_waitcnt lgkmcnt(13)
    v_cvt_pk_bf16_f32 v138, v184, v185
    v_mov_b32 v139, 0
    v_cvt_pk_bf16_f32 v140, v140, v141
    v_cvt_pk_bf16_f32 v141, v142, v143
    s_waitcnt lgkmcnt(12)
    v_cvt_pk_bf16_f32 v142, v186, v187
    v_mov_b32 v143, 0
    s_waitcnt lgkmcnt(11)
    v_cvt_pk_bf16_f32 v144, v144, v145
    v_cvt_pk_bf16_f32 v145, v146, v147
    s_waitcnt lgkmcnt(9)
    v_cvt_pk_bf16_f32 v147, v188, v189
    v_mov_b32 v146, 0
    v_cvt_pk_bf16_f32 v148, v148, v149
    v_cvt_pk_bf16_f32 v149, v150, v151
    s_waitcnt lgkmcnt(8)
    v_cvt_pk_bf16_f32 v151, v190, v191
    v_mov_b32 v150, 0
    s_waitcnt lgkmcnt(7)
    v_cvt_pk_bf16_f32 v152, v152, v153
    v_cvt_pk_bf16_f32 v153, v154, v155
    s_waitcnt lgkmcnt(5)
    v_cvt_pk_bf16_f32 v154, v192, v193
    v_mov_b32 v155, 0
    v_cvt_pk_bf16_f32 v156, v156, v157
    v_cvt_pk_bf16_f32 v157, v158, v159
    s_waitcnt lgkmcnt(4)
    v_cvt_pk_bf16_f32 v158, v194, v195
    v_mov_b32 v159, 0
    s_waitcnt lgkmcnt(3)
    v_cvt_pk_bf16_f32 v160, v160, v161
    v_cvt_pk_bf16_f32 v161, v162, v163
    s_waitcnt lgkmcnt(1)
    v_cvt_pk_bf16_f32 v163, v196, v197
    v_mov_b32 v162, 0
    v_cvt_pk_bf16_f32 v164, v164, v165
    v_cvt_pk_bf16_f32 v165, v166, v167
    s_waitcnt lgkmcnt(0)
    v_cvt_pk_bf16_f32 v167, v198, v199
    v_mov_b32 v166, 0
    s_waitcnt vmcnt(15)
    v_mfma_f32_16x16x32_bf16 v[172:175], v[108:111], a[80:83], 0
    v_mfma_f32_16x16x32_bf16 v[168:171], v[104:107], a[80:83], 0
    s_waitcnt vmcnt(14)
    v_mfma_f32_16x16x32_bf16 v[180:183], v[108:111], a[84:87], 0
    v_mfma_f32_16x16x32_bf16 v[176:179], v[104:107], a[84:87], 0
    s_waitcnt vmcnt(13)
    v_mfma_f32_16x16x32_bf16 v[188:191], v[116:119], a[88:91], 0
    v_mfma_f32_16x16x32_bf16 v[184:187], v[112:115], a[88:91], 0
    s_waitcnt vmcnt(12)
    v_mfma_f32_16x16x32_bf16 v[196:199], v[116:119], a[92:95], 0
    v_mfma_f32_16x16x32_bf16 v[192:195], v[112:115], a[92:95], 0
    s_waitcnt vmcnt(11)
    v_mfma_f32_16x16x32_bf16 v[204:207], v[124:127], a[96:99], 0
    v_mfma_f32_16x16x32_bf16 v[200:203], v[120:123], a[96:99], 0
    s_waitcnt vmcnt(10)
    v_mfma_f32_16x16x32_bf16 v[212:215], v[124:127], a[100:103], 0
    v_mfma_f32_16x16x32_bf16 v[208:211], v[120:123], a[100:103], 0
    s_waitcnt vmcnt(9)
    v_mfma_f32_16x16x32_bf16 v[220:223], v[132:135], a[104:107], 0
    v_mfma_f32_16x16x32_bf16 v[216:219], v[128:131], a[104:107], 0
    s_waitcnt vmcnt(8)
    v_mfma_f32_16x16x32_bf16 v[228:231], v[132:135], a[108:111], 0
    v_mfma_f32_16x16x32_bf16 v[224:227], v[128:131], a[108:111], 0
    v_add_f32 v174, 0x358637bd, v174
    v_add_f32 v182, 0x358637bd, v182
    v_add_f32 v190, 0x358637bd, v190
    v_add_f32 v198, 0x358637bd, v198
    v_rcp_f32 v174, v174
    v_rcp_f32 v182, v182
    v_rcp_f32 v190, v190
    v_rcp_f32 v198, v198
    v_mul_f32 v168, v168, v174
    v_mul_f32 v176, v176, v182
    v_mul_f32 v184, v184, v190
    v_mul_f32 v192, v192, v198
    v_mul_f32 v169, v169, v174
    v_mul_f32 v177, v177, v182
    v_mul_f32 v185, v185, v190
    v_mul_f32 v193, v193, v198
    v_mul_f32 v170, v170, v174
    v_mul_f32 v178, v178, v182
    v_mul_f32 v186, v186, v190
    v_mul_f32 v194, v194, v198
    v_mul_f32 v171, v171, v174
    v_mul_f32 v179, v179, v182
    v_mul_f32 v187, v187, v190
    v_mul_f32 v195, v195, v198
    v_cvt_pk_bf16_f32 v232, v168, v169
    v_cvt_pk_bf16_f32 v236, v176, v177
    v_cvt_pk_bf16_f32 v234, v184, v185
    v_cvt_pk_bf16_f32 v238, v192, v193
    v_cvt_pk_bf16_f32 v233, v170, v171
    v_cvt_pk_bf16_f32 v237, v178, v179
    v_cvt_pk_bf16_f32 v235, v186, v187
    v_cvt_pk_bf16_f32 v239, v194, v195
    v_mul_f32 v28, v172, v174
    v_mul_f32 v30, v180, v182
    v_fmac_f32 v28, v188, v190
    v_fmac_f32 v30, v196, v198
    v_mul_f32 v29, v173, v174
    v_mul_f32 v31, v181, v182
    v_fmac_f32 v29, v189, v190
    v_fmac_f32 v31, v197, v198
    v_add_u32 v6, s23, v2
    v_mfma_f32_16x16x32_bf16 v[32:35], a[144:147], v[232:235], 0
    v_add_f32 v206, 0x358637bd, v206
    v_add_f32 v214, 0x358637bd, v214
    v_mfma_f32_16x16x32_bf16 v[68:71], a[144:147], v[236:239], 0
    buffer_load_dwordx4 v[104:107], v24, s[52:55], 0 offen offset:0 sc1
    v_add_f32 v222, 0x358637bd, v222
    v_add_f32 v230, 0x358637bd, v230
    v_mfma_f32_16x16x32_bf16 v[36:39], a[148:151], v[232:235], 0
    v_rcp_f32 v206, v206
    v_mfma_f32_16x16x32_bf16 v[72:75], a[148:151], v[236:239], 0
    v_rcp_f32 v214, v214
    v_mfma_f32_16x16x32_bf16 v[40:43], a[152:155], v[232:235], 0
    buffer_load_dwordx4 v[108:111], v24, s[52:55], 0 offen offset:2048 sc1
    v_rcp_f32 v222, v222
    v_mfma_f32_16x16x32_bf16 v[76:79], a[152:155], v[236:239], 0
    v_rcp_f32 v230, v230
    v_mfma_f32_16x16x32_bf16 v[44:47], a[156:159], v[232:235], 0
    v_mul_f32 v200, v200, v206
    v_mul_f32 v208, v208, v214
    v_mfma_f32_16x16x32_bf16 v[80:83], a[156:159], v[236:239], 0
    buffer_load_dwordx4 v[112:115], v24, s[52:55], s41 offen offset:0 sc1
    v_mul_f32 v216, v216, v222
    v_mul_f32 v224, v224, v230
    v_mfma_f32_16x16x32_bf16 v[48:51], a[160:163], v[232:235], 0
    s_add_u32 m0, s34, 8192
    v_mul_f32 v201, v201, v206
    v_mul_f32 v209, v209, v214
    v_mfma_f32_16x16x32_bf16 v[84:87], a[160:163], v[236:239], 0
    v_mul_f32 v217, v217, v222
    v_mul_f32 v225, v225, v230
    v_mfma_f32_16x16x32_bf16 v[52:55], a[164:167], v[232:235], 0
    buffer_load_dwordx4 v2, s[36:39], m0 offen offset:0 lds
    v_mul_f32 v202, v202, v206
    v_mul_f32 v210, v210, v214
    v_mfma_f32_16x16x32_bf16 v[88:91], a[164:167], v[236:239], 0
    v_mul_f32 v218, v218, v222
    v_mul_f32 v226, v226, v230
    v_mfma_f32_16x16x32_bf16 v[56:59], a[168:171], v[232:235], 0
    v_mul_f32 v203, v203, v206
    v_mul_f32 v211, v211, v214
    v_mfma_f32_16x16x32_bf16 v[92:95], a[168:171], v[236:239], 0
    buffer_load_dwordx4 v2, s[36:39], m0 offen offset:1024 lds
    v_mul_f32 v219, v219, v222
    v_mul_f32 v227, v227, v230
    v_mfma_f32_16x16x32_bf16 v[60:63], a[172:175], v[232:235], 0
    v_cvt_pk_bf16_f32 v240, v200, v201
    v_cvt_pk_bf16_f32 v244, v208, v209
    v_mfma_f32_16x16x32_bf16 v[96:99], a[172:175], v[236:239], 0
    v_cvt_pk_bf16_f32 v242, v216, v217
    v_cvt_pk_bf16_f32 v246, v224, v225
    v_mfma_f32_16x16x32_bf16 v[64:67], a[176:179], v[232:235], 0
    buffer_load_dwordx4 v2, s[36:39], m0 offen offset:2048 lds
    v_cvt_pk_bf16_f32 v241, v202, v203
    v_cvt_pk_bf16_f32 v245, v210, v211
    v_mfma_f32_16x16x32_bf16 v[100:103], a[176:179], v[236:239], 0
    v_cvt_pk_bf16_f32 v243, v218, v219
    v_cvt_pk_bf16_f32 v247, v226, v227
    s_waitcnt vmcnt(13)
    v_mfma_f32_16x16x32_bf16 v[172:175], v[140:143], a[112:115], 0
    v_fmac_f32 v28, v204, v206
    v_fmac_f32 v30, v212, v214
    v_mfma_f32_16x16x32_bf16 v[168:171], v[136:139], a[112:115], 0
    buffer_load_dwordx4 v2, s[36:39], m0 offen offset:3072 lds
    v_fmac_f32 v28, v220, v222
    v_fmac_f32 v30, v228, v230
    s_waitcnt vmcnt(13)
    v_mfma_f32_16x16x32_bf16 v[180:183], v[140:143], a[116:119], 0
    s_add_u32 m0, s34, 12288
    v_fmac_f32 v29, v205, v206
    v_fmac_f32 v31, v213, v214
    v_mfma_f32_16x16x32_bf16 v[176:179], v[136:139], a[116:119], 0
    v_fmac_f32 v29, v221, v222
    v_fmac_f32 v31, v229, v230
    s_waitcnt vmcnt(12)
    v_mfma_f32_16x16x32_bf16 v[188:191], v[148:151], a[120:123], 0
    buffer_load_dwordx4 v2, s[36:39], m0 offen offset:0 lds
    v_cvt_pk_bf16_f32 v248, v28, v29
    v_cvt_pk_bf16_f32 v252, v30, v31
    v_mfma_f32_16x16x32_bf16 v[184:187], v[144:147], a[120:123], 0
    s_waitcnt vmcnt(12)
    v_mfma_f32_16x16x32_bf16 v[196:199], v[148:151], a[124:127], 0
    v_mfma_f32_16x16x32_bf16 v[192:195], v[144:147], a[124:127], 0
    buffer_load_dwordx4 v2, s[36:39], m0 offen offset:1024 lds
    s_waitcnt vmcnt(12)
    v_mfma_f32_16x16x32_bf16 v[204:207], v[156:159], a[128:131], 0
    v_mfma_f32_16x16x32_bf16 v[200:203], v[152:155], a[128:131], 0
    s_waitcnt vmcnt(11)
    v_mfma_f32_16x16x32_bf16 v[212:215], v[156:159], a[132:135], 0
    buffer_load_dwordx4 v2, s[36:39], m0 offen offset:2048 lds
    v_mfma_f32_16x16x32_bf16 v[208:211], v[152:155], a[132:135], 0
    v_add_f32 v174, 0x358637bd, v174
    v_add_f32 v182, 0x358637bd, v182
    v_add_f32 v190, 0x358637bd, v190
    s_waitcnt vmcnt(11)
    v_mfma_f32_16x16x32_bf16 v[220:223], v[164:167], a[136:139], 0
    v_add_f32 v198, 0x358637bd, v198
    v_rcp_f32 v174, v174
    v_mfma_f32_16x16x32_bf16 v[216:219], v[160:163], a[136:139], 0
    buffer_load_dwordx4 v2, s[36:39], m0 offen offset:3072 lds
    v_rcp_f32 v182, v182
    s_waitcnt vmcnt(11)
    v_mfma_f32_16x16x32_bf16 v[228:231], v[164:167], a[140:143], 0
    s_add_u32 m0, s34, 16384
    v_rcp_f32 v190, v190
    v_mfma_f32_16x16x32_bf16 v[224:227], v[160:163], a[140:143], 0
    v_rcp_f32 v198, v198
    v_mfma_f32_16x16x32_bf16 v[32:35], a[180:183], v[240:243], v[32:35]
    buffer_load_dwordx4 v2, s[36:39], m0 offen offset:0 lds
    v_mul_f32 v168, v168, v174
    v_mul_f32 v176, v176, v182
    v_mfma_f32_16x16x32_bf16 v[68:71], a[180:183], v[244:247], v[68:71]
    v_mul_f32 v184, v184, v190
    v_mul_f32 v192, v192, v198
    v_mul_f32 v169, v169, v174
    v_mfma_f32_16x16x32_bf16 v[36:39], a[184:187], v[240:243], v[36:39]
    v_mul_f32 v177, v177, v182
    v_mul_f32 v185, v185, v190
    v_mfma_f32_16x16x32_bf16 v[72:75], a[184:187], v[244:247], v[72:75]
    buffer_load_dwordx4 v2, s[36:39], m0 offen offset:1024 lds
    v_mul_f32 v193, v193, v198
    v_mul_f32 v170, v170, v174
    v_mfma_f32_16x16x32_bf16 v[40:43], a[188:191], v[240:243], v[40:43]
    s_add_u32 m0, s22, 0
    v_mul_f32 v178, v178, v182
    v_mul_f32 v186, v186, v190
    v_mul_f32 v194, v194, v198
    v_mfma_f32_16x16x32_bf16 v[76:79], a[188:191], v[244:247], v[76:79]
    v_mul_f32 v171, v171, v174
    v_mul_f32 v179, v179, v182
    v_mfma_f32_16x16x32_bf16 v[44:47], a[192:195], v[240:243], v[44:47]
    buffer_load_dwordx4 v2, s[36:39], m0 offen offset:0 lds
    v_mul_f32 v187, v187, v190
    v_mul_f32 v195, v195, v198
    v_mfma_f32_16x16x32_bf16 v[80:83], a[192:195], v[244:247], v[80:83]
    v_cvt_pk_bf16_f32 v232, v168, v169
    v_cvt_pk_bf16_f32 v236, v176, v177
    v_cvt_pk_bf16_f32 v234, v184, v185
    v_mfma_f32_16x16x32_bf16 v[48:51], a[196:199], v[240:243], v[48:51]
    v_cvt_pk_bf16_f32 v238, v192, v193
    v_cvt_pk_bf16_f32 v233, v170, v171
    v_mfma_f32_16x16x32_bf16 v[84:87], a[196:199], v[244:247], v[84:87]
    buffer_load_dwordx4 v2, s[36:39], m0 offen offset:1024 lds
    v_cvt_pk_bf16_f32 v237, v178, v179
    v_cvt_pk_bf16_f32 v235, v186, v187
    v_mfma_f32_16x16x32_bf16 v[52:55], a[200:203], v[240:243], v[52:55]
    v_cvt_pk_bf16_f32 v239, v194, v195
    v_mul_f32 v28, v172, v174
    v_mul_f32 v30, v180, v182
    v_mfma_f32_16x16x32_bf16 v[88:91], a[200:203], v[244:247], v[88:91]
    v_fmac_f32 v28, v188, v190
    v_fmac_f32 v30, v196, v198
    v_mfma_f32_16x16x32_bf16 v[56:59], a[204:207], v[240:243], v[56:59]
    buffer_load_dwordx4 v2, s[36:39], m0 offen offset:2048 lds
    v_mul_f32 v29, v173, v174
    v_mul_f32 v31, v181, v182
    v_mfma_f32_16x16x32_bf16 v[92:95], a[204:207], v[244:247], v[92:95]
    v_fmac_f32 v29, v189, v190
    v_fmac_f32 v31, v197, v198
    v_mfma_f32_16x16x32_bf16 v[60:63], a[208:211], v[240:243], v[60:63]
    v_add_f32 v206, 0x358637bd, v206
    v_add_f32 v214, 0x358637bd, v214
    v_add_f32 v222, 0x358637bd, v222
    v_mfma_f32_16x16x32_bf16 v[96:99], a[208:211], v[244:247], v[96:99]
    v_add_f32 v230, 0x358637bd, v230
    v_rcp_f32 v206, v206
    v_mfma_f32_16x16x32_bf16 v[64:67], a[212:215], v[240:243], v[64:67]
    buffer_load_dwordx4 v2, s[36:39], m0 offen offset:3072 lds
    v_rcp_f32 v214, v214
    v_mfma_f32_16x16x32_bf16 v[100:103], a[212:215], v[244:247], v[100:103]
    s_add_u32 m0, s22, 4096
    v_rcp_f32 v222, v222
    v_mfma_f32_16x16x32_bf16 v[32:35], a[216:219], v[232:235], v[32:35]
    v_rcp_f32 v230, v230
    v_mul_f32 v200, v200, v206
    v_mfma_f32_16x16x32_bf16 v[68:71], a[216:219], v[236:239], v[68:71]
    buffer_load_dwordx4 v2, s[36:39], m0 offen offset:0 lds
    v_mul_f32 v208, v208, v214
    v_mul_f32 v216, v216, v222
    v_mfma_f32_16x16x32_bf16 v[36:39], a[220:223], v[232:235], v[36:39]
    v_mul_f32 v224, v224, v230
    v_mul_f32 v201, v201, v206
    v_mfma_f32_16x16x32_bf16 v[72:75], a[220:223], v[236:239], v[72:75]
    v_mul_f32 v209, v209, v214
    v_mul_f32 v217, v217, v222
    v_mul_f32 v225, v225, v230
    v_mfma_f32_16x16x32_bf16 v[40:43], a[224:227], v[232:235], v[40:43]
    buffer_load_dwordx4 v2, s[36:39], m0 offen offset:1024 lds
    v_mul_f32 v202, v202, v206
    v_mul_f32 v210, v210, v214
    v_mfma_f32_16x16x32_bf16 v[76:79], a[224:227], v[236:239], v[76:79]
    v_mul_f32 v218, v218, v222
    v_mul_f32 v226, v226, v230
    v_mul_f32 v203, v203, v206
    v_mfma_f32_16x16x32_bf16 v[44:47], a[228:231], v[232:235], v[44:47]
    buffer_load_dwordx4 v2, s[36:39], m0 offen offset:2048 lds
    v_mul_f32 v211, v211, v214
    v_mul_f32 v219, v219, v222
    v_mfma_f32_16x16x32_bf16 v[80:83], a[228:231], v[236:239], v[80:83]
    v_mul_f32 v227, v227, v230
    v_cvt_pk_bf16_f32 v120, v200, v201
    v_cvt_pk_bf16_f32 v124, v208, v209
    v_mfma_f32_16x16x32_bf16 v[48:51], a[232:235], v[232:235], v[48:51]
    v_cvt_pk_bf16_f32 v122, v216, v217
    v_cvt_pk_bf16_f32 v126, v224, v225
    v_mfma_f32_16x16x32_bf16 v[84:87], a[232:235], v[236:239], v[84:87]
    buffer_load_dwordx4 v2, s[36:39], m0 offen offset:3072 lds
    v_cvt_pk_bf16_f32 v121, v202, v203
    v_cvt_pk_bf16_f32 v125, v210, v211
    v_mfma_f32_16x16x32_bf16 v[52:55], a[236:239], v[232:235], v[52:55]
    s_add_u32 m0, s22, 8192
    v_cvt_pk_bf16_f32 v123, v218, v219
    v_cvt_pk_bf16_f32 v127, v226, v227
    v_fmac_f32 v28, v204, v206
    v_mfma_f32_16x16x32_bf16 v[88:91], a[236:239], v[236:239], v[88:91]
    v_fmac_f32 v30, v212, v214
    v_fmac_f32 v28, v220, v222
    v_mfma_f32_16x16x32_bf16 v[56:59], a[240:243], v[232:235], v[56:59]
    v_fmac_f32 v30, v228, v230
    v_fmac_f32 v29, v205, v206
    v_fmac_f32 v31, v213, v214
    v_mfma_f32_16x16x32_bf16 v[92:95], a[240:243], v[236:239], v[92:95]
    buffer_load_dwordx4 v2, s[36:39], m0 offen offset:0 lds
    v_fmac_f32 v29, v221, v222
    v_fmac_f32 v31, v229, v230
    v_mfma_f32_16x16x32_bf16 v[60:63], a[244:247], v[232:235], v[60:63]
    v_cvt_pk_bf16_f32 v249, v28, v29
    v_cvt_pk_bf16_f32 v253, v30, v31
    v_mfma_f32_16x16x32_bf16 v[96:99], a[244:247], v[236:239], v[96:99]
    v_mfma_f32_16x16x32_bf16 v[64:67], a[248:251], v[232:235], v[64:67]
    v_mfma_f32_16x16x32_bf16 v[100:103], a[248:251], v[236:239], v[100:103]
    v_mfma_f32_16x16x32_bf16 v[32:35], a[252:255], v[120:123], v[32:35]
    v_mfma_f32_16x16x32_bf16 v[68:71], a[252:255], v[124:127], v[68:71]
    v_mfma_f32_16x16x32_bf16 v[36:39], a[0:3], v[120:123], v[36:39]
    v_mfma_f32_16x16x32_bf16 v[72:75], a[0:3], v[124:127], v[72:75]
    v_mfma_f32_16x16x32_bf16 v[40:43], a[4:7], v[120:123], v[40:43]
    v_mfma_f32_16x16x32_bf16 v[76:79], a[4:7], v[124:127], v[76:79]
    v_mfma_f32_16x16x32_bf16 v[44:47], a[8:11], v[120:123], v[44:47]
    v_mfma_f32_16x16x32_bf16 v[80:83], a[8:11], v[124:127], v[80:83]
    v_mfma_f32_16x16x32_bf16 v[48:51], a[12:15], v[120:123], v[48:51]
    v_mfma_f32_16x16x32_bf16 v[84:87], a[12:15], v[124:127], v[84:87]
    v_mfma_f32_16x16x32_bf16 v[52:55], a[16:19], v[120:123], v[52:55]
    v_mfma_f32_16x16x32_bf16 v[88:91], a[16:19], v[124:127], v[88:91]
    v_mfma_f32_16x16x32_bf16 v[56:59], a[20:23], v[120:123], v[56:59]
    v_mfma_f32_16x16x32_bf16 v[92:95], a[20:23], v[124:127], v[92:95]
    v_mfma_f32_16x16x32_bf16 v[60:63], a[24:27], v[120:123], v[60:63]
    v_mfma_f32_16x16x32_bf16 v[96:99], a[24:27], v[124:127], v[96:99]
    v_mfma_f32_16x16x32_bf16 v[64:67], a[28:31], v[120:123], v[64:67]
    v_mfma_f32_16x16x32_bf16 v[100:103], a[28:31], v[124:127], v[100:103]
    v_mfma_f32_16x16x32_bf16 v[32:35], a[32:35], v[248:251], v[32:35]
    v_mfma_f32_16x16x32_bf16 v[68:71], a[32:35], v[252:255], v[68:71]
    v_mfma_f32_16x16x32_bf16 v[36:39], a[36:39], v[248:251], v[36:39]
    v_mfma_f32_16x16x32_bf16 v[72:75], a[36:39], v[252:255], v[72:75]
    v_mfma_f32_16x16x32_bf16 v[40:43], a[40:43], v[248:251], v[40:43]
    v_mfma_f32_16x16x32_bf16 v[76:79], a[40:43], v[252:255], v[76:79]
    s_nop 2
    v_cvt_pk_bf16_f32 v168, v32, v33
    v_cvt_pk_bf16_f32 v169, v34, v35
    v_cvt_pk_bf16_f32 v170, v68, v69
    v_mfma_f32_16x16x32_bf16 v[44:47], a[44:47], v[248:251], v[44:47]
    v_cvt_pk_bf16_f32 v171, v70, v71
    v_mfma_f32_16x16x32_bf16 v[80:83], a[44:47], v[252:255], v[80:83]
    v_cvt_pk_bf16_f32 v172, v36, v37
    v_cvt_pk_bf16_f32 v173, v38, v39
    v_cvt_pk_bf16_f32 v174, v72, v73
    v_mfma_f32_16x16x32_bf16 v[48:51], a[48:51], v[248:251], v[48:51]
    v_cvt_pk_bf16_f32 v175, v74, v75
    v_permlane32_swap_b32 v168, v170
    v_permlane32_swap_b32 v169, v171
    v_mfma_f32_16x16x32_bf16 v[84:87], a[48:51], v[252:255], v[84:87]
    ds_write_b128 v6, v[168:171] offset:0
    v_cvt_pk_bf16_f32 v176, v40, v41
    v_cvt_pk_bf16_f32 v177, v42, v43
    v_mfma_f32_16x16x32_bf16 v[52:55], a[52:55], v[248:251], v[52:55]
    v_cvt_pk_bf16_f32 v178, v76, v77
    v_cvt_pk_bf16_f32 v179, v78, v79
    v_permlane32_swap_b32 v172, v174
    v_mfma_f32_16x16x32_bf16 v[88:91], a[52:55], v[252:255], v[88:91]
    v_permlane32_swap_b32 v173, v175
    v_mfma_f32_16x16x32_bf16 v[56:59], a[56:59], v[248:251], v[56:59]
    ds_write_b128 v6, v[172:175] offset:1024
    v_cvt_pk_bf16_f32 v180, v44, v45
    v_cvt_pk_bf16_f32 v181, v46, v47
    v_mfma_f32_16x16x32_bf16 v[92:95], a[56:59], v[252:255], v[92:95]
    v_cvt_pk_bf16_f32 v182, v80, v81
    v_cvt_pk_bf16_f32 v183, v82, v83
    v_permlane32_swap_b32 v176, v178
    v_mfma_f32_16x16x32_bf16 v[60:63], a[60:63], v[248:251], v[60:63]
    v_permlane32_swap_b32 v177, v179
    v_mfma_f32_16x16x32_bf16 v[96:99], a[60:63], v[252:255], v[96:99]
    ds_write_b128 v6, v[176:179] offset:2048
    v_mfma_f32_16x16x32_bf16 v[64:67], a[64:67], v[248:251], v[64:67]
    v_mfma_f32_16x16x32_bf16 v[100:103], a[64:67], v[252:255], v[100:103]
    s_add_u32 s26, s25, 2740224
    s_add_u32 s12, s58, s26
    s_addc_u32 s13, s59, 0
    s_mov_b32 s14, 4608
    s_mov_b32 s15, 0x20000
    v_cvt_pk_bf16_f32 v184, v48, v49
    v_cvt_pk_bf16_f32 v185, v50, v51
    v_cvt_pk_bf16_f32 v186, v84, v85
    v_cvt_pk_bf16_f32 v187, v86, v87
    v_permlane32_swap_b32 v180, v182
    v_permlane32_swap_b32 v181, v183
    ds_write_b128 v6, v[180:183] offset:3072
    v_cvt_pk_bf16_f32 v188, v52, v53
    v_cvt_pk_bf16_f32 v189, v54, v55
    v_cvt_pk_bf16_f32 v190, v88, v89
    v_cvt_pk_bf16_f32 v191, v90, v91
    v_permlane32_swap_b32 v184, v186
    v_permlane32_swap_b32 v185, v187
    ds_write_b128 v6, v[184:187] offset:4096
    v_cvt_pk_bf16_f32 v192, v56, v57
    v_cvt_pk_bf16_f32 v193, v58, v59
    v_cvt_pk_bf16_f32 v194, v92, v93
    v_cvt_pk_bf16_f32 v195, v94, v95
    v_permlane32_swap_b32 v188, v190
    v_permlane32_swap_b32 v189, v191
    ds_write_b128 v6, v[188:191] offset:5120
    v_cvt_pk_bf16_f32 v196, v60, v61
    v_cvt_pk_bf16_f32 v197, v62, v63
    v_cvt_pk_bf16_f32 v198, v96, v97
    v_cvt_pk_bf16_f32 v199, v98, v99
    v_permlane32_swap_b32 v192, v194
    v_permlane32_swap_b32 v193, v195
    ds_write_b128 v6, v[192:195] offset:6144
    v_cvt_pk_bf16_f32 v200, v64, v65
    v_cvt_pk_bf16_f32 v201, v66, v67
    v_cvt_pk_bf16_f32 v202, v100, v101
    v_cvt_pk_bf16_f32 v203, v102, v103
    v_permlane32_swap_b32 v196, v198
    v_permlane32_swap_b32 v197, v199
    ds_write_b128 v6, v[196:199] offset:7168
    v_permlane32_swap_b32 v200, v202
    v_permlane32_swap_b32 v201, v203
    ds_write_b128 v6, v[200:203] offset:8192
    s_add_u32 s16, s58, 5099520
    s_addc_u32 s17, s59, 0
    s_mov_b32 s18, 131072
    s_mov_b32 s19, 0x20000
    s_lshr_b32 s24, s3, 1
    s_lshl_b32 s24, s24, 9
    s_lshl_b32 s26, s27, 11
    s_add_u32 s24, s24, s26
    s_add_u32 s24, s24, 114688
    v_lshrrev_b32 v7, 5, v1
    v_lshlrev_b32 v7, 10, v7
    v_and_b32 v8, 31, v1
    v_lshl_add_u32 v7, v8, 4, v7
    v_add_u32 v7, s24, v7
    v_mov_b32 v10, 0
    v_mov_b32 v11, 0
    v_mov_b32 v12, 0
    v_mov_b32 v13, 0
    s_waitcnt lgkmcnt(0)
    s_barrier
    ds_read_b128 v[32:35], v7 offset:0
    ds_read_b128 v[36:39], v7 offset:12288
    ds_read_b128 v[40:43], v7 offset:24576
    ds_read_b128 v[44:47], v7 offset:36864
    ds_read_b128 v[48:51], v7 offset:4096
    ds_read_b128 v[52:55], v7 offset:16384
    ds_read_b128 v[56:59], v7 offset:28672
    ds_read_b128 v[60:63], v7 offset:40960
    ds_read_b128 v[64:67], v7 offset:8192
    ds_read_b128 v[68:71], v7 offset:20480
    ds_read_b128 v[72:75], v7 offset:32768
    ds_read_b128 v[76:79], v7 offset:45056
    s_waitcnt vmcnt(21)
    v_lshlrev_b32 v128, 16, v104
    v_and_b32 v129, 0xffff0000, v104
    v_lshlrev_b32 v130, 16, v105
    v_and_b32 v131, 0xffff0000, v105
    v_lshlrev_b32 v132, 16, v106
    v_and_b32 v133, 0xffff0000, v106
    v_lshlrev_b32 v134, 16, v107
    v_and_b32 v135, 0xffff0000, v107
    s_waitcnt lgkmcnt(11)
    v_dot2c_f32_bf16 v128, s56, v32
    v_dot2c_f32_bf16 v129, s57, v32
    v_dot2c_f32_bf16 v130, s56, v33
    v_dot2c_f32_bf16 v131, s57, v33
    v_dot2c_f32_bf16 v132, s56, v34
    v_dot2c_f32_bf16 v133, s57, v34
    v_dot2c_f32_bf16 v134, s56, v35
    v_dot2c_f32_bf16 v135, s57, v35
    s_waitcnt lgkmcnt(10)
    v_dot2c_f32_bf16 v128, s56, v36
    v_dot2c_f32_bf16 v129, s57, v36
    v_dot2c_f32_bf16 v130, s56, v37
    v_dot2c_f32_bf16 v131, s57, v37
    v_dot2c_f32_bf16 v132, s56, v38
    v_dot2c_f32_bf16 v133, s57, v38
    v_dot2c_f32_bf16 v134, s56, v39
    v_dot2c_f32_bf16 v135, s57, v39
    s_waitcnt lgkmcnt(9)
    v_dot2c_f32_bf16 v128, s56, v40
    v_dot2c_f32_bf16 v129, s57, v40
    v_dot2c_f32_bf16 v130, s56, v41
    v_dot2c_f32_bf16 v131, s57, v41
    v_dot2c_f32_bf16 v132, s56, v42
    v_dot2c_f32_bf16 v133, s57, v42
    v_dot2c_f32_bf16 v134, s56, v43
    v_dot2c_f32_bf16 v135, s57, v43
    s_waitcnt lgkmcnt(8)
    v_dot2c_f32_bf16 v128, s56, v44
    v_dot2c_f32_bf16 v129, s57, v44
    v_dot2c_f32_bf16 v130, s56, v45
    v_dot2c_f32_bf16 v131, s57, v45
    v_dot2c_f32_bf16 v132, s56, v46
    v_dot2c_f32_bf16 v133, s57, v46
    v_dot2c_f32_bf16 v134, s56, v47
    v_dot2c_f32_bf16 v135, s57, v47
    v_cvt_pk_bf16_f32 v136, v128, v129
    v_cvt_pk_bf16_f32 v137, v130, v131
    v_cvt_pk_bf16_f32 v138, v132, v133
    v_cvt_pk_bf16_f32 v139, v134, v135
    buffer_store_dwordx4 v[136:139], v24, s[12:15], 0 offen offset:0 sc1
    v_dot2c_f32_bf16 v10, s40, v136
    v_dot2c_f32_bf16 v12, v136, v136
    v_dot2c_f32_bf16 v11, s40, v137
    v_dot2c_f32_bf16 v13, v137, v137
    v_dot2c_f32_bf16 v10, s40, v138
    v_dot2c_f32_bf16 v12, v138, v138
    v_dot2c_f32_bf16 v11, s40, v139
    v_dot2c_f32_bf16 v13, v139, v139
    s_waitcnt vmcnt(21)
    v_lshlrev_b32 v140, 16, v108
    v_and_b32 v141, 0xffff0000, v108
    v_lshlrev_b32 v142, 16, v109
    v_and_b32 v143, 0xffff0000, v109
    v_lshlrev_b32 v144, 16, v110
    v_and_b32 v145, 0xffff0000, v110
    v_lshlrev_b32 v146, 16, v111
    v_and_b32 v147, 0xffff0000, v111
    s_waitcnt lgkmcnt(7)
    v_dot2c_f32_bf16 v140, s56, v48
    v_dot2c_f32_bf16 v141, s57, v48
    v_dot2c_f32_bf16 v142, s56, v49
    v_dot2c_f32_bf16 v143, s57, v49
    v_dot2c_f32_bf16 v144, s56, v50
    v_dot2c_f32_bf16 v145, s57, v50
    v_dot2c_f32_bf16 v146, s56, v51
    v_dot2c_f32_bf16 v147, s57, v51
    s_waitcnt lgkmcnt(6)
    v_dot2c_f32_bf16 v140, s56, v52
    v_dot2c_f32_bf16 v141, s57, v52
    v_dot2c_f32_bf16 v142, s56, v53
    v_dot2c_f32_bf16 v143, s57, v53
    v_dot2c_f32_bf16 v144, s56, v54
    v_dot2c_f32_bf16 v145, s57, v54
    v_dot2c_f32_bf16 v146, s56, v55
    v_dot2c_f32_bf16 v147, s57, v55
    s_waitcnt lgkmcnt(5)
    v_dot2c_f32_bf16 v140, s56, v56
    v_dot2c_f32_bf16 v141, s57, v56
    v_dot2c_f32_bf16 v142, s56, v57
    v_dot2c_f32_bf16 v143, s57, v57
    v_dot2c_f32_bf16 v144, s56, v58
    v_dot2c_f32_bf16 v145, s57, v58
    v_dot2c_f32_bf16 v146, s56, v59
    v_dot2c_f32_bf16 v147, s57, v59
    s_waitcnt lgkmcnt(4)
    v_dot2c_f32_bf16 v140, s56, v60
    v_dot2c_f32_bf16 v141, s57, v60
    v_dot2c_f32_bf16 v142, s56, v61
    v_dot2c_f32_bf16 v143, s57, v61
    v_dot2c_f32_bf16 v144, s56, v62
    v_dot2c_f32_bf16 v145, s57, v62
    v_dot2c_f32_bf16 v146, s56, v63
    v_dot2c_f32_bf16 v147, s57, v63
    v_cvt_pk_bf16_f32 v148, v140, v141
    v_cvt_pk_bf16_f32 v149, v142, v143
    v_cvt_pk_bf16_f32 v150, v144, v145
    v_cvt_pk_bf16_f32 v151, v146, v147
    buffer_store_dwordx4 v[148:151], v24, s[12:15], 0 offen offset:2048 sc1
    v_dot2c_f32_bf16 v10, s40, v148
    v_dot2c_f32_bf16 v12, v148, v148
    v_dot2c_f32_bf16 v11, s40, v149
    v_dot2c_f32_bf16 v13, v149, v149
    v_dot2c_f32_bf16 v10, s40, v150
    v_dot2c_f32_bf16 v12, v150, v150
    v_dot2c_f32_bf16 v11, s40, v151
    v_dot2c_f32_bf16 v13, v151, v151
    s_cmp_eq_u32 s27, 0
    s_cbranch_scc0 SK_mk_10
    s_mov_b32 exec_hi, 0
    s_waitcnt vmcnt(21)
    v_lshlrev_b32 v152, 16, v112
    v_and_b32 v153, 0xffff0000, v112
    v_lshlrev_b32 v154, 16, v113
    v_and_b32 v155, 0xffff0000, v113
    v_lshlrev_b32 v156, 16, v114
    v_and_b32 v157, 0xffff0000, v114
    v_lshlrev_b32 v158, 16, v115
    v_and_b32 v159, 0xffff0000, v115
    s_waitcnt lgkmcnt(3)
    v_dot2c_f32_bf16 v152, s56, v64
    v_dot2c_f32_bf16 v153, s57, v64
    v_dot2c_f32_bf16 v154, s56, v65
    v_dot2c_f32_bf16 v155, s57, v65
    v_dot2c_f32_bf16 v156, s56, v66
    v_dot2c_f32_bf16 v157, s57, v66
    v_dot2c_f32_bf16 v158, s56, v67
    v_dot2c_f32_bf16 v159, s57, v67
    s_waitcnt lgkmcnt(2)
    v_dot2c_f32_bf16 v152, s56, v68
    v_dot2c_f32_bf16 v153, s57, v68
    v_dot2c_f32_bf16 v154, s56, v69
    v_dot2c_f32_bf16 v155, s57, v69
    v_dot2c_f32_bf16 v156, s56, v70
    v_dot2c_f32_bf16 v157, s57, v70
    v_dot2c_f32_bf16 v158, s56, v71
    v_dot2c_f32_bf16 v159, s57, v71
    s_waitcnt lgkmcnt(1)
    v_dot2c_f32_bf16 v152, s56, v72
    v_dot2c_f32_bf16 v153, s57, v72
    v_dot2c_f32_bf16 v154, s56, v73
    v_dot2c_f32_bf16 v155, s57, v73
    v_dot2c_f32_bf16 v156, s56, v74
    v_dot2c_f32_bf16 v157, s57, v74
    v_dot2c_f32_bf16 v158, s56, v75
    v_dot2c_f32_bf16 v159, s57, v75
    s_waitcnt lgkmcnt(0)
    v_dot2c_f32_bf16 v152, s56, v76
    v_dot2c_f32_bf16 v153, s57, v76
    v_dot2c_f32_bf16 v154, s56, v77
    v_dot2c_f32_bf16 v155, s57, v77
    v_dot2c_f32_bf16 v156, s56, v78
    v_dot2c_f32_bf16 v157, s57, v78
    v_dot2c_f32_bf16 v158, s56, v79
    v_dot2c_f32_bf16 v159, s57, v79
    v_cvt_pk_bf16_f32 v160, v152, v153
    v_cvt_pk_bf16_f32 v161, v154, v155
    v_cvt_pk_bf16_f32 v162, v156, v157
    v_cvt_pk_bf16_f32 v163, v158, v159
    buffer_store_dwordx4 v[160:163], v24, s[12:15], s41 offen offset:0 sc1
    v_dot2c_f32_bf16 v10, s40, v160
    v_dot2c_f32_bf16 v12, v160, v160
    v_dot2c_f32_bf16 v11, s40, v161
    v_dot2c_f32_bf16 v13, v161, v161
    v_dot2c_f32_bf16 v10, s40, v162
    v_dot2c_f32_bf16 v12, v162, v162
    v_dot2c_f32_bf16 v11, s40, v163
    v_dot2c_f32_bf16 v13, v163, v163
    s_mov_b64 exec, -1
SK_mk_10:
    s_nop 0
    v_add_f32 v10, v10, v11
    v_add_f32 v11, v12, v13
    v_mov_b32 v14, v10
    s_nop 1
    v_permlane16_swap_b32 v10, v14
    v_add_f32 v10, v10, v14
    v_mov_b32 v14, v10
    s_nop 1
    v_permlane32_swap_b32 v10, v14
    v_add_f32 v10, v10, v14
    v_mov_b32 v14, v11
    s_nop 1
    v_permlane16_swap_b32 v11, v14
    v_add_f32 v11, v11, v14
    v_mov_b32 v14, v11
    s_nop 1
    v_permlane32_swap_b32 v11, v14
    v_add_f32 v11, v11, v14
    v_mov_b32 v14, 1073741824
    v_cmp_gt_u32 vcc, 16, v1
    s_nop 1
    v_cndmask_b32 v14, v14, v2, vcc
    buffer_store_dwordx2 v[10:11], v14, s[16:19], s29 offen sc1
    s_lshr_b32 s24, s20, 1
    s_lshl_b32 s24, s24, 2
    s_add_u32 s24, s24, 512
    s_lshl_b32 s24, s24, 7
    v_mul_u32_u24 v10, 128, v1
    v_mov_b32 v11, 1
    s_waitcnt vmcnt(0)
    s_mov_b64 exec, 15
    buffer_atomic_add v11, v10, s[96:99], s24 offen
    s_mov_b64 exec, -1
    s_and_b32 s20, s6, 1
    s_lshl_b32 s20, s20, 2
    s_and_b32 s21, s7, 3
    s_add_u32 s20, s20, s21
    s_lshr_b32 s21, s6, 1
    s_lshl_b32 s21, s21, 3
    s_lshr_b32 s22, s7, 2
    s_add_u32 s21, s21, s22
    s_mul_i32 s22, s21, 331776
    s_add_u32 s22, s22, 2801664
    s_mov_b32 s8, s4
    s_mov_b32 s9, s5
    s_mov_b32 s10, 18726912
    s_mov_b32 s11, 0x20000
    s_lshr_b32 s24, s7, 3
    s_lshl_b32 s24, s24, 2
    s_lshr_b32 s36, s6, 1
    s_add_u32 s24, s24, s36
    s_mul_i32 s24, s24, 331776
    s_add_u32 s24, s24, 13086720
    s_sub_u32 s36, s24, s22
    s_lshl_b32 s23, s20, 4
    s_lshl_b32 s24, s3, 2
    s_add_u32 s23, s23, s24
    s_mul_i32 s24, s23, 18432
    s_add_u32 s24, s24, 2740224
    s_add_u32 s12, s58, s24
    s_addc_u32 s13, s59, 0
    s_mov_b32 s14, 73728
    s_mov_b32 s15, 0x20000
    v_add_u32 v7, 18432, v2
    v_add_u32 v8, 36864, v2
    v_add_u32 v9, 55296, v2
    s_mul_i32 s26, s3, 9216
    s_add_u32 s28, s26, 110592
    s_add_u32 s27, s28, s22
    s_mov_b32 s38, 3
    s_mov_b32 s39, 3
    s_lshl_b32 s24, s23, 10
    s_add_u32 s24, s24, 5099520
    s_add_u32 s16, s58, s24
    s_addc_u32 s17, s59, 0
    s_mov_b32 s18, 4096
    s_mov_b32 s19, 0x20000
    s_mul_i32 s24, s21, 1152
    s_add_u32 s24, s24, 18726912
    s_add_u32 s52, s4, s24
    s_addc_u32 s53, s5, 0
    s_mov_b32 s54, 1152
    s_mov_b32 s55, 0x20000
    s_mul_i32 s24, s23, 147456
    s_lshr_b32 s30, s21, 3
    s_mul_i32 s30, s30, 72
    s_and_b32 s31, s21, 7
    s_add_u32 s30, s30, s31
    s_lshl_b32 s30, s30, 9
    s_add_u32 s24, s24, s30
    s_add_u32 s24, s24, 9424896
    s_add_u32 s88, s58, s24
    s_addc_u32 s89, s59, 0
    s_mov_b32 s90, 479232
    s_mov_b32 s91, 0x20000
    v_lshrrev_b32 v3, 4, v1
    v_add_u32 v10, 110592, v2
    v_add_u32 v4, 36864, v2
    v_add_u32 v5, 73728, v2
    v_lshlrev_b32 v12, 4, v3
    v_lshrrev_b32 v13, 5, v1
    v_mul_u32_u24 v13, 147456, v13
    v_and_b32 v14, 31, v1
    v_lshl_add_u32 v13, v14, 4, v13
    s_mov_b32 s33, 384
    s_mov_b32 s34, 0
    s_mov_b32 s35, 294912
    buffer_load_dwordx4 v[180:183], v12, s[52:55], 0 offen offset:0 sc1
    buffer_load_dwordx4 v[184:187], v12, s[52:55], 0 offen offset:64 sc1
    buffer_load_dwordx4 v[188:191], v12, s[52:55], 0 offen offset:128 sc1
    buffer_load_dwordx4 v[192:195], v12, s[52:55], 0 offen offset:192 sc1
    buffer_load_dwordx4 v[120:123], v12, s[52:55], 0 offen offset:256 sc1
    buffer_load_dwordx4 v[124:127], v12, s[52:55], 0 offen offset:320 sc1
    s_and_b32 s24, s21, 3
    s_add_u32 s24, s24, s23
    s_add_u32 s24, s24, 512
    s_lshl_b32 s24, s24, 7
    s_lshl_b32 s76, s2, 2
    s_add_u32 s76, s76, s3
    s_mul_i32 s77, s76, 7282
    s_lshr_b32 s77, s77, 16
    s_mul_i32 s78, s77, 9
    s_sub_u32 s78, s76, s78
    s_mul_i32 s79, s77, 2341
    s_lshr_b32 s79, s79, 16
    s_mul_i32 s80, s79, 28
    s_sub_u32 s80, s77, s80
    s_mul_i32 s81, s79, 36
    s_add_u32 s81, s81, s80
    s_add_u32 s81, s81, 8
    s_and_b32 s82, s80, 3
    s_lshl_b32 s82, s82, 1
    s_lshl_b32 s83, s79, 3
    s_add_u32 s82, s82, s83
    s_mul_i32 s82, s82, 9
    s_lshr_b32 s83, s80, 2
    s_add_u32 s82, s82, s83
    s_add_u32 s82, s82, 2
    s_mul_i32 s82, s82, 18432
    s_lshl_b32 s83, s78, 7
    s_add_u32 s82, s82, s83
    s_cmp_lt_u32 s2, 252
    s_cselect_b32 s83, s60, 0
    s_cmp_eq_u32 s83, 2
    s_cselect_b32 s82, s82, 1073741824
    s_cselect_b32 s83, 1, 0
    s_mov_b32 s92, s100
    s_mov_b32 s93, s101
    s_mov_b32 s94, 5308416
    s_mov_b32 s95, 0x20000
    v_lshrrev_b32 v3, 3, v1
    v_mul_u32_u24 v3, 1152, v3
    v_bfe_u32 v6, v1, 4, 1
    v_lshlrev_b32 v6, 1, v6
    v_and_b32 v14, 7, v1
    v_xor_b32 v6, v6, v14
    v_lshl_add_u32 v3, v6, 4, v3
    v_xor_b32 v6, 64, v3
    s_lshl_b32 s84, s3, 12
    s_add_u32 s84, s84, 147456
    s_and_b32 s85, s2, 15
    s_add_u32 s85, s85, 1408
    s_lshl_b32 s85, s85, 7
    s_lshr_b32 s40, s21, 3
    s_add_u32 s40, s40, s23
    s_add_u32 s40, s40, 640
    s_lshl_b32 s40, s40, 7
    v_min_u32 v11, 1, v1
    v_lshlrev_b32 v11, 30, v11
    v_mov_b32 v15, 1
    s_waitcnt lgkmcnt(0)
    s_barrier
    ds_read_b128 v[96:99], v2 offset:0
    ds_read_b128 v[100:103], v2 offset:2048
    ds_read_b128 v[104:107], v2 offset:4096
    v_mov_b32 v128, 0
    s_mov_b64 exec, 1
    s_mov_b32 s61, 200000
POLL_mk_11:
    v_mov_b32 v129, 0
    buffer_atomic_add v129, v128, s[96:99], s24 offen sc0
    s_waitcnt vmcnt(0)
    v_cmp_gt_u32 vcc, 32, v129
    s_nop 0
    s_cbranch_vccz PDONE_mk_12
    s_sub_u32 s61, s61, 1
    s_cmp_lg_u32 s61, 0
    s_cbranch_scc1 POLL_mk_11
PDONE_mk_12:
    s_mov_b64 exec, -1
    buffer_load_dwordx4 a[0:3], v2, s[12:15], 0 offen offset:0 sc1
    buffer_load_dwordx4 a[16:19], v2, s[12:15], 0 offen offset:1024 sc1
    buffer_load_dwordx4 a[32:35], v2, s[12:15], 0 offen offset:2048 sc1
    buffer_load_dwordx4 a[4:7], v7, s[12:15], 0 offen offset:0 sc1
    buffer_load_dwordx4 a[20:23], v7, s[12:15], 0 offen offset:1024 sc1
    buffer_load_dwordx4 a[36:39], v7, s[12:15], 0 offen offset:2048 sc1
    buffer_load_dwordx4 a[8:11], v8, s[12:15], 0 offen offset:0 sc1
    buffer_load_dwordx4 a[24:27], v8, s[12:15], 0 offen offset:1024 sc1
    buffer_load_dwordx4 a[40:43], v8, s[12:15], 0 offen offset:2048 sc1
    buffer_load_dwordx4 a[12:15], v9, s[12:15], 0 offen offset:0 sc1
    buffer_load_dwordx4 a[28:31], v9, s[12:15], 0 offen offset:1024 sc1
    buffer_load_dwordx4 a[44:47], v9, s[12:15], 0 offen offset:2048 sc1
    s_waitcnt vmcnt(11) lgkmcnt(2)
    v_mfma_f32_16x16x32_bf16 v[148:151], v[96:99], a[0:3], 0
    ds_read_b128 v[108:111], v2 offset:1024
    s_waitcnt vmcnt(10) lgkmcnt(2)
    v_mfma_f32_16x16x32_bf16 v[148:151], v[100:103], a[16:19], v[148:151]
    buffer_load_dwordx4 a[48:51], v2, s[12:15], 0 offen offset:3072 sc1
    s_waitcnt vmcnt(10) lgkmcnt(1)
    v_mfma_f32_16x16x32_bf16 v[148:151], v[104:107], a[32:35], v[148:151]
    s_waitcnt vmcnt(7)
    ds_read_b128 v[112:115], v2 offset:3072
    v_mfma_f32_16x16x32_bf16 v[152:155], v[104:107], a[36:39], 0
    v_mfma_f32_16x16x32_bf16 v[152:155], v[100:103], a[20:23], v[152:155]
    ds_read_b128 v[116:119], v2 offset:5120
    v_mfma_f32_16x16x32_bf16 v[152:155], v[96:99], a[4:7], v[152:155]
    s_waitcnt vmcnt(4)
    buffer_load_dwordx4 a[64:67], v2, s[12:15], s41 offen offset:0 sc1
    v_mfma_f32_16x16x32_bf16 v[156:159], v[96:99], a[8:11], 0
    v_mfma_f32_16x16x32_bf16 v[156:159], v[100:103], a[24:27], v[156:159]
    v_mfma_f32_16x16x32_bf16 v[156:159], v[104:107], a[40:43], v[156:159]
    s_waitcnt vmcnt(2)
    v_mfma_f32_16x16x32_bf16 v[160:163], v[104:107], a[44:47], 0
    buffer_load_dwordx4 a[80:83], v2, s[12:15], s41 offen offset:1024 sc1
    v_mfma_f32_16x16x32_bf16 v[160:163], v[100:103], a[28:31], v[160:163]
    v_mfma_f32_16x16x32_bf16 v[160:163], v[96:99], a[12:15], v[160:163]
    s_waitcnt lgkmcnt(0)
    v_mfma_f32_16x16x32_bf16 v[164:167], v[108:111], a[0:3], 0
    ds_read_b128 v[96:99], v4 offset:0
    v_mfma_f32_16x16x32_bf16 v[164:167], v[112:115], a[16:19], v[164:167]
    v_mfma_f32_16x16x32_bf16 v[164:167], v[116:119], a[32:35], v[164:167]
    ds_read_b128 v[100:103], v4 offset:2048
    buffer_load_dwordx4 a[52:55], v7, s[12:15], 0 offen offset:3072 sc1
    v_mfma_f32_16x16x32_bf16 v[168:171], v[116:119], a[36:39], 0
    v_mfma_f32_16x16x32_bf16 v[168:171], v[112:115], a[20:23], v[168:171]
    ds_read_b128 v[104:107], v4 offset:4096
    v_mfma_f32_16x16x32_bf16 v[168:171], v[108:111], a[4:7], v[168:171]
    v_mfma_f32_16x16x32_bf16 v[172:175], v[108:111], a[8:11], 0
    buffer_load_dwordx4 a[68:71], v7, s[12:15], s41 offen offset:0 sc1
    v_mfma_f32_16x16x32_bf16 v[172:175], v[112:115], a[24:27], v[172:175]
    v_mfma_f32_16x16x32_bf16 v[172:175], v[116:119], a[40:43], v[172:175]
    v_mfma_f32_16x16x32_bf16 v[176:179], v[116:119], a[44:47], 0
    v_mfma_f32_16x16x32_bf16 v[176:179], v[112:115], a[28:31], v[176:179]
    v_mfma_f32_16x16x32_bf16 v[176:179], v[108:111], a[12:15], v[176:179]
    s_waitcnt lgkmcnt(0)
    buffer_load_dwordx4 a[84:87], v7, s[12:15], s41 offen offset:1024 sc1
    v_mfma_f32_16x16x32_bf16 v[64:67], v[96:99], a[0:3], 0
    ds_read_b128 v[108:111], v4 offset:1024
    v_mfma_f32_16x16x32_bf16 v[64:67], v[100:103], a[16:19], v[64:67]
    v_mfma_f32_16x16x32_bf16 v[64:67], v[104:107], a[32:35], v[64:67]
    ds_read_b128 v[112:115], v4 offset:3072
    v_mfma_f32_16x16x32_bf16 v[68:71], v[104:107], a[36:39], 0
    buffer_load_dwordx4 a[56:59], v8, s[12:15], 0 offen offset:3072 sc1
    v_mfma_f32_16x16x32_bf16 v[68:71], v[100:103], a[20:23], v[68:71]
    ds_read_b128 v[116:119], v4 offset:5120
    v_mfma_f32_16x16x32_bf16 v[68:71], v[96:99], a[4:7], v[68:71]
    v_mfma_f32_16x16x32_bf16 v[72:75], v[96:99], a[8:11], 0
    v_mfma_f32_16x16x32_bf16 v[72:75], v[100:103], a[24:27], v[72:75]
    buffer_load_dwordx4 a[72:75], v8, s[12:15], s41 offen offset:0 sc1
    v_mfma_f32_16x16x32_bf16 v[72:75], v[104:107], a[40:43], v[72:75]
    v_mfma_f32_16x16x32_bf16 v[76:79], v[104:107], a[44:47], 0
    v_mfma_f32_16x16x32_bf16 v[76:79], v[100:103], a[28:31], v[76:79]
    v_mfma_f32_16x16x32_bf16 v[76:79], v[96:99], a[12:15], v[76:79]
    s_waitcnt lgkmcnt(0)
    v_mfma_f32_16x16x32_bf16 v[80:83], v[108:111], a[0:3], 0
    ds_read_b128 v[96:99], v5 offset:0
    buffer_load_dwordx4 a[88:91], v8, s[12:15], s41 offen offset:1024 sc1
    v_mfma_f32_16x16x32_bf16 v[80:83], v[112:115], a[16:19], v[80:83]
    v_mfma_f32_16x16x32_bf16 v[80:83], v[116:119], a[32:35], v[80:83]
    ds_read_b128 v[100:103], v5 offset:2048
    v_mfma_f32_16x16x32_bf16 v[84:87], v[116:119], a[36:39], 0
    v_mfma_f32_16x16x32_bf16 v[84:87], v[112:115], a[20:23], v[84:87]
    ds_read_b128 v[104:107], v5 offset:4096
    buffer_load_dwordx4 a[60:63], v9, s[12:15], 0 offen offset:3072 sc1
    v_mfma_f32_16x16x32_bf16 v[84:87], v[108:111], a[4:7], v[84:87]
    v_mfma_f32_16x16x32_bf16 v[88:91], v[108:111], a[8:11], 0
    v_mfma_f32_16x16x32_bf16 v[88:91], v[112:115], a[24:27], v[88:91]
    v_mfma_f32_16x16x32_bf16 v[88:91], v[116:119], a[40:43], v[88:91]
    v_mfma_f32_16x16x32_bf16 v[92:95], v[116:119], a[44:47], 0
    buffer_load_dwordx4 a[76:79], v9, s[12:15], s41 offen offset:0 sc1
    v_mfma_f32_16x16x32_bf16 v[92:95], v[112:115], a[28:31], v[92:95]
    v_mfma_f32_16x16x32_bf16 v[92:95], v[108:111], a[12:15], v[92:95]
    s_waitcnt lgkmcnt(0)
    v_mfma_f32_16x16x32_bf16 v[32:35], v[96:99], a[0:3], 0
    ds_read_b128 v[108:111], v5 offset:1024
    v_mfma_f32_16x16x32_bf16 v[32:35], v[100:103], a[16:19], v[32:35]
    buffer_load_dwordx4 a[92:95], v9, s[12:15], s41 offen offset:1024 sc1
    v_mfma_f32_16x16x32_bf16 v[32:35], v[104:107], a[32:35], v[32:35]
    ds_read_b128 v[112:115], v5 offset:3072
    v_mfma_f32_16x16x32_bf16 v[36:39], v[104:107], a[36:39], 0
    v_mfma_f32_16x16x32_bf16 v[36:39], v[100:103], a[20:23], v[36:39]
    ds_read_b128 v[116:119], v5 offset:5120
    v_mfma_f32_16x16x32_bf16 v[36:39], v[96:99], a[4:7], v[36:39]
    buffer_load_dwordx4 a[96:99], v2, s[12:15], s41 offen offset:2048 sc1
    v_mfma_f32_16x16x32_bf16 v[40:43], v[96:99], a[8:11], 0
    v_mfma_f32_16x16x32_bf16 v[40:43], v[100:103], a[24:27], v[40:43]
    v_mfma_f32_16x16x32_bf16 v[40:43], v[104:107], a[40:43], v[40:43]
    v_mfma_f32_16x16x32_bf16 v[44:47], v[104:107], a[44:47], 0
    v_mfma_f32_16x16x32_bf16 v[44:47], v[100:103], a[28:31], v[44:47]
    buffer_load_dwordx4 a[112:115], v2, s[12:15], s41 offen offset:3072 sc1
    v_mfma_f32_16x16x32_bf16 v[44:47], v[96:99], a[12:15], v[44:47]
    s_waitcnt lgkmcnt(0)
    v_mfma_f32_16x16x32_bf16 v[48:51], v[108:111], a[0:3], 0
    ds_read_b128 v[96:99], v2 offset:6144
    v_mfma_f32_16x16x32_bf16 v[48:51], v[112:115], a[16:19], v[48:51]
    v_mfma_f32_16x16x32_bf16 v[48:51], v[116:119], a[32:35], v[48:51]
    ds_read_b128 v[100:103], v2 offset:8192
    buffer_load_dwordx4 a[128:131], v2, s[12:15], s42 offen offset:0 sc1
    v_mfma_f32_16x16x32_bf16 v[52:55], v[116:119], a[36:39], 0
    v_mfma_f32_16x16x32_bf16 v[52:55], v[112:115], a[20:23], v[52:55]
    ds_read_b128 v[104:107], v2 offset:10240
    v_mfma_f32_16x16x32_bf16 v[52:55], v[108:111], a[4:7], v[52:55]
    v_mfma_f32_16x16x32_bf16 v[56:59], v[108:111], a[8:11], 0
    v_mfma_f32_16x16x32_bf16 v[56:59], v[112:115], a[24:27], v[56:59]
    buffer_load_dwordx4 a[100:103], v7, s[12:15], s41 offen offset:2048 sc1
    v_mfma_f32_16x16x32_bf16 v[56:59], v[116:119], a[40:43], v[56:59]
    v_mfma_f32_16x16x32_bf16 v[60:63], v[116:119], a[44:47], 0
    v_mfma_f32_16x16x32_bf16 v[60:63], v[112:115], a[28:31], v[60:63]
    v_mfma_f32_16x16x32_bf16 v[60:63], v[108:111], a[12:15], v[60:63]
    s_waitcnt vmcnt(13) lgkmcnt(0)
    buffer_load_dwordx4 a[116:119], v7, s[12:15], s41 offen offset:3072 sc1
    v_mfma_f32_16x16x32_bf16 v[148:151], v[96:99], a[48:51], v[148:151]
    ds_read_b128 v[108:111], v2 offset:7168
    v_mfma_f32_16x16x32_bf16 v[148:151], v[100:103], a[64:67], v[148:151]
    v_mfma_f32_16x16x32_bf16 v[148:151], v[104:107], a[80:83], v[148:151]
    s_waitcnt vmcnt(11)
    ds_read_b128 v[112:115], v2 offset:9216
    v_mfma_f32_16x16x32_bf16 v[152:155], v[104:107], a[84:87], v[152:155]
    buffer_load_dwordx4 a[132:135], v7, s[12:15], s42 offen offset:0 sc1
    v_mfma_f32_16x16x32_bf16 v[152:155], v[100:103], a[68:71], v[152:155]
    ds_read_b128 v[116:119], v2 offset:11264
    v_mfma_f32_16x16x32_bf16 v[152:155], v[96:99], a[52:55], v[152:155]
    s_waitcnt vmcnt(9)
    v_mfma_f32_16x16x32_bf16 v[156:159], v[96:99], a[56:59], v[156:159]
    v_mfma_f32_16x16x32_bf16 v[156:159], v[100:103], a[72:75], v[156:159]
    v_mfma_f32_16x16x32_bf16 v[156:159], v[104:107], a[88:91], v[156:159]
    s_waitcnt vmcnt(6)
    buffer_load_dwordx4 a[104:107], v8, s[12:15], s41 offen offset:2048 sc1
    v_mfma_f32_16x16x32_bf16 v[160:163], v[104:107], a[92:95], v[160:163]
    v_mfma_f32_16x16x32_bf16 v[160:163], v[100:103], a[76:79], v[160:163]
    v_mfma_f32_16x16x32_bf16 v[160:163], v[96:99], a[60:63], v[160:163]
    s_waitcnt lgkmcnt(0)
    v_mfma_f32_16x16x32_bf16 v[164:167], v[108:111], a[48:51], v[164:167]
    ds_read_b128 v[96:99], v4 offset:6144
    buffer_load_dwordx4 a[120:123], v8, s[12:15], s41 offen offset:3072 sc1
    v_mfma_f32_16x16x32_bf16 v[164:167], v[112:115], a[64:67], v[164:167]
    v_mfma_f32_16x16x32_bf16 v[164:167], v[116:119], a[80:83], v[164:167]
    ds_read_b128 v[100:103], v4 offset:8192
    v_mfma_f32_16x16x32_bf16 v[168:171], v[116:119], a[84:87], v[168:171]
    v_mfma_f32_16x16x32_bf16 v[168:171], v[112:115], a[68:71], v[168:171]
    ds_read_b128 v[104:107], v4 offset:10240
    v_mfma_f32_16x16x32_bf16 v[168:171], v[108:111], a[52:55], v[168:171]
    buffer_load_dwordx4 a[136:139], v8, s[12:15], s42 offen offset:0 sc1
    v_mfma_f32_16x16x32_bf16 v[172:175], v[108:111], a[56:59], v[172:175]
    v_mfma_f32_16x16x32_bf16 v[172:175], v[112:115], a[72:75], v[172:175]
    v_mfma_f32_16x16x32_bf16 v[172:175], v[116:119], a[88:91], v[172:175]
    v_mfma_f32_16x16x32_bf16 v[176:179], v[116:119], a[92:95], v[176:179]
    buffer_load_dwordx4 a[108:111], v9, s[12:15], s41 offen offset:2048 sc1
    v_mfma_f32_16x16x32_bf16 v[176:179], v[112:115], a[76:79], v[176:179]
    v_mfma_f32_16x16x32_bf16 v[176:179], v[108:111], a[60:63], v[176:179]
    s_waitcnt lgkmcnt(0)
    v_mfma_f32_16x16x32_bf16 v[64:67], v[96:99], a[48:51], v[64:67]
    ds_read_b128 v[108:111], v4 offset:7168
    v_mfma_f32_16x16x32_bf16 v[64:67], v[100:103], a[64:67], v[64:67]
    buffer_load_dwordx4 a[124:127], v9, s[12:15], s41 offen offset:3072 sc1
    v_mfma_f32_16x16x32_bf16 v[64:67], v[104:107], a[80:83], v[64:67]
    ds_read_b128 v[112:115], v4 offset:9216
    v_mfma_f32_16x16x32_bf16 v[68:71], v[104:107], a[84:87], v[68:71]
    v_mfma_f32_16x16x32_bf16 v[68:71], v[100:103], a[68:71], v[68:71]
    ds_read_b128 v[116:119], v4 offset:11264
    v_mfma_f32_16x16x32_bf16 v[68:71], v[96:99], a[52:55], v[68:71]
    v_mfma_f32_16x16x32_bf16 v[72:75], v[96:99], a[56:59], v[72:75]
    buffer_load_dwordx4 a[140:143], v9, s[12:15], s42 offen offset:0 sc1
    v_mfma_f32_16x16x32_bf16 v[72:75], v[100:103], a[72:75], v[72:75]
    v_mfma_f32_16x16x32_bf16 v[72:75], v[104:107], a[88:91], v[72:75]
    v_mfma_f32_16x16x32_bf16 v[76:79], v[104:107], a[92:95], v[76:79]
    v_mfma_f32_16x16x32_bf16 v[76:79], v[100:103], a[76:79], v[76:79]
    buffer_load_dwordx4 a[144:147], v2, s[12:15], s42 offen offset:1024 sc1
    v_mfma_f32_16x16x32_bf16 v[76:79], v[96:99], a[60:63], v[76:79]
    s_waitcnt lgkmcnt(0)
    v_mfma_f32_16x16x32_bf16 v[80:83], v[108:111], a[48:51], v[80:83]
    ds_read_b128 v[96:99], v5 offset:6144
    v_mfma_f32_16x16x32_bf16 v[80:83], v[112:115], a[64:67], v[80:83]
    v_mfma_f32_16x16x32_bf16 v[80:83], v[116:119], a[80:83], v[80:83]
    ds_read_b128 v[100:103], v5 offset:8192
    v_mfma_f32_16x16x32_bf16 v[84:87], v[116:119], a[84:87], v[84:87]
    buffer_load_dwordx4 a[160:163], v2, s[12:15], s42 offen offset:2048 sc1
    v_mfma_f32_16x16x32_bf16 v[84:87], v[112:115], a[68:71], v[84:87]
    ds_read_b128 v[104:107], v5 offset:10240
    v_mfma_f32_16x16x32_bf16 v[84:87], v[108:111], a[52:55], v[84:87]
    v_mfma_f32_16x16x32_bf16 v[88:91], v[108:111], a[56:59], v[88:91]
    v_mfma_f32_16x16x32_bf16 v[88:91], v[112:115], a[72:75], v[88:91]
    buffer_load_dwordx4 a[176:179], v2, s[12:15], s42 offen offset:3072 sc1
    v_mfma_f32_16x16x32_bf16 v[88:91], v[116:119], a[88:91], v[88:91]
    v_mfma_f32_16x16x32_bf16 v[92:95], v[116:119], a[92:95], v[92:95]
    v_mfma_f32_16x16x32_bf16 v[92:95], v[112:115], a[76:79], v[92:95]
    v_mfma_f32_16x16x32_bf16 v[92:95], v[108:111], a[60:63], v[92:95]
    s_waitcnt lgkmcnt(0)
    buffer_load_dwordx4 a[148:151], v7, s[12:15], s42 offen offset:1024 sc1
    v_mfma_f32_16x16x32_bf16 v[32:35], v[96:99], a[48:51], v[32:35]
    ds_read_b128 v[108:111], v5 offset:7168
    v_mfma_f32_16x16x32_bf16 v[32:35], v[100:103], a[64:67], v[32:35]
    v_mfma_f32_16x16x32_bf16 v[32:35], v[104:107], a[80:83], v[32:35]
    ds_read_b128 v[112:115], v5 offset:9216
    v_mfma_f32_16x16x32_bf16 v[36:39], v[104:107], a[84:87], v[36:39]
    v_mfma_f32_16x16x32_bf16 v[36:39], v[100:103], a[68:71], v[36:39]
    ds_read_b128 v[116:119], v5 offset:11264
    buffer_load_dwordx4 a[164:167], v7, s[12:15], s42 offen offset:2048 sc1
    v_mfma_f32_16x16x32_bf16 v[36:39], v[96:99], a[52:55], v[36:39]
    v_mfma_f32_16x16x32_bf16 v[40:43], v[96:99], a[56:59], v[40:43]
    v_mfma_f32_16x16x32_bf16 v[40:43], v[100:103], a[72:75], v[40:43]
    v_mfma_f32_16x16x32_bf16 v[40:43], v[104:107], a[88:91], v[40:43]
    buffer_load_dwordx4 a[180:183], v7, s[12:15], s42 offen offset:3072 sc1
    v_mfma_f32_16x16x32_bf16 v[44:47], v[104:107], a[92:95], v[44:47]
    v_mfma_f32_16x16x32_bf16 v[44:47], v[100:103], a[76:79], v[44:47]
    v_mfma_f32_16x16x32_bf16 v[44:47], v[96:99], a[60:63], v[44:47]
    s_waitcnt lgkmcnt(0)
    v_mfma_f32_16x16x32_bf16 v[48:51], v[108:111], a[48:51], v[48:51]
    ds_read_b128 v[96:99], v2 offset:12288
    v_mfma_f32_16x16x32_bf16 v[48:51], v[112:115], a[64:67], v[48:51]
    buffer_load_dwordx4 a[152:155], v8, s[12:15], s42 offen offset:1024 sc1
    v_mfma_f32_16x16x32_bf16 v[48:51], v[116:119], a[80:83], v[48:51]
    ds_read_b128 v[100:103], v2 offset:14336
    v_mfma_f32_16x16x32_bf16 v[52:55], v[116:119], a[84:87], v[52:55]
    v_mfma_f32_16x16x32_bf16 v[52:55], v[112:115], a[68:71], v[52:55]
    ds_read_b128 v[104:107], v2 offset:16384
    v_mfma_f32_16x16x32_bf16 v[52:55], v[108:111], a[52:55], v[52:55]
    buffer_load_dwordx4 a[168:171], v8, s[12:15], s42 offen offset:2048 sc1
    v_mfma_f32_16x16x32_bf16 v[56:59], v[108:111], a[56:59], v[56:59]
    v_mfma_f32_16x16x32_bf16 v[56:59], v[112:115], a[72:75], v[56:59]
    v_mfma_f32_16x16x32_bf16 v[56:59], v[116:119], a[88:91], v[56:59]
    v_mfma_f32_16x16x32_bf16 v[60:63], v[116:119], a[92:95], v[60:63]
    buffer_load_dwordx4 a[184:187], v8, s[12:15], s42 offen offset:3072 sc1
    v_mfma_f32_16x16x32_bf16 v[60:63], v[112:115], a[76:79], v[60:63]
    v_mfma_f32_16x16x32_bf16 v[60:63], v[108:111], a[60:63], v[60:63]
    s_waitcnt vmcnt(18) lgkmcnt(0)
    v_mfma_f32_16x16x32_bf16 v[148:151], v[96:99], a[96:99], v[148:151]
    ds_read_b128 v[108:111], v2 offset:13312
    v_mfma_f32_16x16x32_bf16 v[148:151], v[100:103], a[112:115], v[148:151]
    v_mfma_f32_16x16x32_bf16 v[148:151], v[104:107], a[128:131], v[148:151]
    s_waitcnt vmcnt(15)
    ds_read_b128 v[112:115], v2 offset:15360
    buffer_load_dwordx4 a[156:159], v9, s[12:15], s42 offen offset:1024 sc1
    v_mfma_f32_16x16x32_bf16 v[152:155], v[104:107], a[132:135], v[152:155]
    v_mfma_f32_16x16x32_bf16 v[152:155], v[100:103], a[116:119], v[152:155]
    ds_read_b128 v[116:119], v2 offset:17408
    v_mfma_f32_16x16x32_bf16 v[152:155], v[96:99], a[100:103], v[152:155]
    s_waitcnt vmcnt(13)
    v_mfma_f32_16x16x32_bf16 v[156:159], v[96:99], a[104:107], v[156:159]
    buffer_load_dwordx4 a[172:175], v9, s[12:15], s42 offen offset:2048 sc1
    v_mfma_f32_16x16x32_bf16 v[156:159], v[100:103], a[120:123], v[156:159]
    v_mfma_f32_16x16x32_bf16 v[156:159], v[104:107], a[136:139], v[156:159]
    s_waitcnt vmcnt(11)
    v_mfma_f32_16x16x32_bf16 v[160:163], v[104:107], a[140:143], v[160:163]
    v_mfma_f32_16x16x32_bf16 v[160:163], v[100:103], a[124:127], v[160:163]
    v_mfma_f32_16x16x32_bf16 v[160:163], v[96:99], a[108:111], v[160:163]
    s_waitcnt lgkmcnt(0)
    buffer_load_dwordx4 a[188:191], v9, s[12:15], s42 offen offset:3072 sc1
    v_mfma_f32_16x16x32_bf16 v[164:167], v[108:111], a[96:99], v[164:167]
    ds_read_b128 v[96:99], v4 offset:12288
    v_mfma_f32_16x16x32_bf16 v[164:167], v[112:115], a[112:115], v[164:167]
    v_mfma_f32_16x16x32_bf16 v[164:167], v[116:119], a[128:131], v[164:167]
    ds_read_b128 v[100:103], v4 offset:14336
    v_mfma_f32_16x16x32_bf16 v[168:171], v[116:119], a[132:135], v[168:171]
    buffer_load_dwordx4 a[192:195], v2, s[12:15], s43 offen offset:0 sc1
    v_mfma_f32_16x16x32_bf16 v[168:171], v[112:115], a[116:119], v[168:171]
    ds_read_b128 v[104:107], v4 offset:16384
    v_mfma_f32_16x16x32_bf16 v[168:171], v[108:111], a[100:103], v[168:171]
    v_mfma_f32_16x16x32_bf16 v[172:175], v[108:111], a[104:107], v[172:175]
    v_mfma_f32_16x16x32_bf16 v[172:175], v[112:115], a[120:123], v[172:175]
    buffer_load_dwordx4 a[208:211], v2, s[12:15], s43 offen offset:1024 sc1
    v_mfma_f32_16x16x32_bf16 v[172:175], v[116:119], a[136:139], v[172:175]
    v_mfma_f32_16x16x32_bf16 v[176:179], v[116:119], a[140:143], v[176:179]
    v_mfma_f32_16x16x32_bf16 v[176:179], v[112:115], a[124:127], v[176:179]
    v_mfma_f32_16x16x32_bf16 v[176:179], v[108:111], a[108:111], v[176:179]
    s_waitcnt lgkmcnt(0)
    v_mfma_f32_16x16x32_bf16 v[64:67], v[96:99], a[96:99], v[64:67]
    ds_read_b128 v[108:111], v4 offset:13312
    buffer_load_dwordx4 a[224:227], v2, s[12:15], s43 offen offset:2048 sc1
    v_mfma_f32_16x16x32_bf16 v[64:67], v[100:103], a[112:115], v[64:67]
    v_mfma_f32_16x16x32_bf16 v[64:67], v[104:107], a[128:131], v[64:67]
    ds_read_b128 v[112:115], v4 offset:15360
    v_mfma_f32_16x16x32_bf16 v[68:71], v[104:107], a[132:135], v[68:71]
    v_mfma_f32_16x16x32_bf16 v[68:71], v[100:103], a[116:119], v[68:71]
    ds_read_b128 v[116:119], v4 offset:17408
    buffer_load_dwordx4 a[196:199], v7, s[12:15], s43 offen offset:0 sc1
    v_mfma_f32_16x16x32_bf16 v[68:71], v[96:99], a[100:103], v[68:71]
    v_mfma_f32_16x16x32_bf16 v[72:75], v[96:99], a[104:107], v[72:75]
    v_mfma_f32_16x16x32_bf16 v[72:75], v[100:103], a[120:123], v[72:75]
    v_mfma_f32_16x16x32_bf16 v[72:75], v[104:107], a[136:139], v[72:75]
    v_mfma_f32_16x16x32_bf16 v[76:79], v[104:107], a[140:143], v[76:79]
    buffer_load_dwordx4 a[212:215], v7, s[12:15], s43 offen offset:1024 sc1
    v_mfma_f32_16x16x32_bf16 v[76:79], v[100:103], a[124:127], v[76:79]
    v_mfma_f32_16x16x32_bf16 v[76:79], v[96:99], a[108:111], v[76:79]
    s_waitcnt lgkmcnt(0)
    v_mfma_f32_16x16x32_bf16 v[80:83], v[108:111], a[96:99], v[80:83]
    ds_read_b128 v[96:99], v5 offset:12288
    v_mfma_f32_16x16x32_bf16 v[80:83], v[112:115], a[112:115], v[80:83]
    buffer_load_dwordx4 a[228:231], v7, s[12:15], s43 offen offset:2048 sc1
    v_mfma_f32_16x16x32_bf16 v[80:83], v[116:119], a[128:131], v[80:83]
    ds_read_b128 v[100:103], v5 offset:14336
    v_mfma_f32_16x16x32_bf16 v[84:87], v[116:119], a[132:135], v[84:87]
    v_mfma_f32_16x16x32_bf16 v[84:87], v[112:115], a[116:119], v[84:87]
    ds_read_b128 v[104:107], v5 offset:16384
    v_mfma_f32_16x16x32_bf16 v[84:87], v[108:111], a[100:103], v[84:87]
    buffer_load_dwordx4 a[200:203], v8, s[12:15], s43 offen offset:0 sc1
    v_mfma_f32_16x16x32_bf16 v[88:91], v[108:111], a[104:107], v[88:91]
    v_mfma_f32_16x16x32_bf16 v[88:91], v[112:115], a[120:123], v[88:91]
    v_mfma_f32_16x16x32_bf16 v[88:91], v[116:119], a[136:139], v[88:91]
    v_mfma_f32_16x16x32_bf16 v[92:95], v[116:119], a[140:143], v[92:95]
    v_mfma_f32_16x16x32_bf16 v[92:95], v[112:115], a[124:127], v[92:95]
    buffer_load_dwordx4 a[216:219], v8, s[12:15], s43 offen offset:1024 sc1
    v_mfma_f32_16x16x32_bf16 v[92:95], v[108:111], a[108:111], v[92:95]
    s_waitcnt lgkmcnt(0)
    v_mfma_f32_16x16x32_bf16 v[32:35], v[96:99], a[96:99], v[32:35]
    ds_read_b128 v[108:111], v5 offset:13312
    v_mfma_f32_16x16x32_bf16 v[32:35], v[100:103], a[112:115], v[32:35]
    v_mfma_f32_16x16x32_bf16 v[32:35], v[104:107], a[128:131], v[32:35]
    ds_read_b128 v[112:115], v5 offset:15360
    buffer_load_dwordx4 a[232:235], v8, s[12:15], s43 offen offset:2048 sc1
    v_mfma_f32_16x16x32_bf16 v[36:39], v[104:107], a[132:135], v[36:39]
    v_mfma_f32_16x16x32_bf16 v[36:39], v[100:103], a[116:119], v[36:39]
    ds_read_b128 v[116:119], v5 offset:17408
    v_mfma_f32_16x16x32_bf16 v[36:39], v[96:99], a[100:103], v[36:39]
    v_mfma_f32_16x16x32_bf16 v[40:43], v[96:99], a[104:107], v[40:43]
    v_mfma_f32_16x16x32_bf16 v[40:43], v[100:103], a[120:123], v[40:43]
    buffer_load_dwordx4 a[204:207], v9, s[12:15], s43 offen offset:0 sc1
    v_mfma_f32_16x16x32_bf16 v[40:43], v[104:107], a[136:139], v[40:43]
    v_mfma_f32_16x16x32_bf16 v[44:47], v[104:107], a[140:143], v[44:47]
    v_mfma_f32_16x16x32_bf16 v[44:47], v[100:103], a[124:127], v[44:47]
    v_mfma_f32_16x16x32_bf16 v[44:47], v[96:99], a[108:111], v[44:47]
    s_waitcnt lgkmcnt(0)
    buffer_load_dwordx4 a[220:223], v9, s[12:15], s43 offen offset:1024 sc1
    v_mfma_f32_16x16x32_bf16 v[48:51], v[108:111], a[96:99], v[48:51]
    ds_read_b128 v[96:99], v2 offset:18432
    v_mfma_f32_16x16x32_bf16 v[48:51], v[112:115], a[112:115], v[48:51]
    v_mfma_f32_16x16x32_bf16 v[48:51], v[116:119], a[128:131], v[48:51]
    ds_read_b128 v[100:103], v2 offset:20480
    v_mfma_f32_16x16x32_bf16 v[52:55], v[116:119], a[132:135], v[52:55]
    buffer_load_dwordx4 a[236:239], v9, s[12:15], s43 offen offset:2048 sc1
    v_mfma_f32_16x16x32_bf16 v[52:55], v[112:115], a[116:119], v[52:55]
    ds_read_b128 v[104:107], v2 offset:22528
    v_mfma_f32_16x16x32_bf16 v[52:55], v[108:111], a[100:103], v[52:55]
    v_mfma_f32_16x16x32_bf16 v[56:59], v[108:111], a[104:107], v[56:59]
    v_mfma_f32_16x16x32_bf16 v[56:59], v[112:115], a[120:123], v[56:59]
    v_mfma_f32_16x16x32_bf16 v[56:59], v[116:119], a[136:139], v[56:59]
    buffer_load_dwordx4 a[240:243], v2, s[12:15], s43 offen offset:3072 sc1
    v_mfma_f32_16x16x32_bf16 v[60:63], v[116:119], a[140:143], v[60:63]
    v_mfma_f32_16x16x32_bf16 v[60:63], v[112:115], a[124:127], v[60:63]
    v_mfma_f32_16x16x32_bf16 v[60:63], v[108:111], a[108:111], v[60:63]
    s_waitcnt vmcnt(22) lgkmcnt(0)
    v_mfma_f32_16x16x32_bf16 v[148:151], v[96:99], a[144:147], v[148:151]
    ds_read_b128 v[108:111], v2 offset:19456
    buffer_load_dwordx4 v[224:227], v2, s[12:15], s44 offen offset:0 sc1
    v_mfma_f32_16x16x32_bf16 v[148:151], v[100:103], a[160:163], v[148:151]
    v_mfma_f32_16x16x32_bf16 v[148:151], v[104:107], a[176:179], v[148:151]
    s_waitcnt vmcnt(20)
    ds_read_b128 v[112:115], v2 offset:21504
    v_mfma_f32_16x16x32_bf16 v[152:155], v[104:107], a[180:183], v[152:155]
    v_mfma_f32_16x16x32_bf16 v[152:155], v[100:103], a[164:167], v[152:155]
    ds_read_b128 v[116:119], v2 offset:23552
    v_mfma_f32_16x16x32_bf16 v[152:155], v[96:99], a[148:151], v[152:155]
    s_waitcnt vmcnt(17)
    buffer_load_dwordx4 v[240:243], v2, s[12:15], s44 offen offset:1024 sc1
    v_mfma_f32_16x16x32_bf16 v[156:159], v[96:99], a[152:155], v[156:159]
    v_mfma_f32_16x16x32_bf16 v[156:159], v[100:103], a[168:171], v[156:159]
    v_mfma_f32_16x16x32_bf16 v[156:159], v[104:107], a[184:187], v[156:159]
    s_waitcnt vmcnt(15)
    v_mfma_f32_16x16x32_bf16 v[160:163], v[104:107], a[188:191], v[160:163]
    buffer_load_dwordx4 a[244:247], v7, s[12:15], s43 offen offset:3072 sc1
    v_mfma_f32_16x16x32_bf16 v[160:163], v[100:103], a[172:175], v[160:163]
    v_mfma_f32_16x16x32_bf16 v[160:163], v[96:99], a[156:159], v[160:163]
    s_waitcnt lgkmcnt(0)
    v_mfma_f32_16x16x32_bf16 v[164:167], v[108:111], a[144:147], v[164:167]
    ds_read_b128 v[96:99], v4 offset:18432
    v_mfma_f32_16x16x32_bf16 v[164:167], v[112:115], a[160:163], v[164:167]
    buffer_load_dwordx4 v[228:231], v7, s[12:15], s44 offen offset:0 sc1
    v_mfma_f32_16x16x32_bf16 v[164:167], v[116:119], a[176:179], v[164:167]
    ds_read_b128 v[100:103], v4 offset:20480
    v_mfma_f32_16x16x32_bf16 v[168:171], v[116:119], a[180:183], v[168:171]
    v_mfma_f32_16x16x32_bf16 v[168:171], v[112:115], a[164:167], v[168:171]
    ds_read_b128 v[104:107], v4 offset:22528
    v_mfma_f32_16x16x32_bf16 v[168:171], v[108:111], a[148:151], v[168:171]
    v_mfma_f32_16x16x32_bf16 v[172:175], v[108:111], a[152:155], v[172:175]
    buffer_load_dwordx4 v[244:247], v7, s[12:15], s44 offen offset:1024 sc1
    v_mfma_f32_16x16x32_bf16 v[172:175], v[112:115], a[168:171], v[172:175]
    v_mfma_f32_16x16x32_bf16 v[172:175], v[116:119], a[184:187], v[172:175]
    v_mfma_f32_16x16x32_bf16 v[176:179], v[116:119], a[188:191], v[176:179]
    v_mfma_f32_16x16x32_bf16 v[176:179], v[112:115], a[172:175], v[176:179]
    buffer_load_dwordx4 a[248:251], v8, s[12:15], s43 offen offset:3072 sc1
    v_mfma_f32_16x16x32_bf16 v[176:179], v[108:111], a[156:159], v[176:179]
    s_waitcnt lgkmcnt(0)
    v_mfma_f32_16x16x32_bf16 v[64:67], v[96:99], a[144:147], v[64:67]
    ds_read_b128 v[108:111], v4 offset:19456
    v_mfma_f32_16x16x32_bf16 v[64:67], v[100:103], a[160:163], v[64:67]
    v_mfma_f32_16x16x32_bf16 v[64:67], v[104:107], a[176:179], v[64:67]
    ds_read_b128 v[112:115], v4 offset:21504
    v_mfma_f32_16x16x32_bf16 v[68:71], v[104:107], a[180:183], v[68:71]
    buffer_load_dwordx4 v[232:235], v8, s[12:15], s44 offen offset:0 sc1
    v_mfma_f32_16x16x32_bf16 v[68:71], v[100:103], a[164:167], v[68:71]
    ds_read_b128 v[116:119], v4 offset:23552
    v_mfma_f32_16x16x32_bf16 v[68:71], v[96:99], a[148:151], v[68:71]
    v_mfma_f32_16x16x32_bf16 v[72:75], v[96:99], a[152:155], v[72:75]
    v_mfma_f32_16x16x32_bf16 v[72:75], v[100:103], a[168:171], v[72:75]
    buffer_load_dwordx4 v[248:251], v8, s[12:15], s44 offen offset:1024 sc1
    v_mfma_f32_16x16x32_bf16 v[72:75], v[104:107], a[184:187], v[72:75]
    v_mfma_f32_16x16x32_bf16 v[76:79], v[104:107], a[188:191], v[76:79]
    v_mfma_f32_16x16x32_bf16 v[76:79], v[100:103], a[172:175], v[76:79]
    v_mfma_f32_16x16x32_bf16 v[76:79], v[96:99], a[156:159], v[76:79]
    s_waitcnt lgkmcnt(0)
    buffer_load_dwordx4 a[252:255], v9, s[12:15], s43 offen offset:3072 sc1
    v_mfma_f32_16x16x32_bf16 v[80:83], v[108:111], a[144:147], v[80:83]
    ds_read_b128 v[96:99], v5 offset:18432
    v_mfma_f32_16x16x32_bf16 v[80:83], v[112:115], a[160:163], v[80:83]
    v_mfma_f32_16x16x32_bf16 v[80:83], v[116:119], a[176:179], v[80:83]
    ds_read_b128 v[100:103], v5 offset:20480
    v_mfma_f32_16x16x32_bf16 v[84:87], v[116:119], a[180:183], v[84:87]
    v_mfma_f32_16x16x32_bf16 v[84:87], v[112:115], a[164:167], v[84:87]
    ds_read_b128 v[104:107], v5 offset:22528
    buffer_load_dwordx4 v[236:239], v9, s[12:15], s44 offen offset:0 sc1
    v_mfma_f32_16x16x32_bf16 v[84:87], v[108:111], a[148:151], v[84:87]
    v_mfma_f32_16x16x32_bf16 v[88:91], v[108:111], a[152:155], v[88:91]
    v_mfma_f32_16x16x32_bf16 v[88:91], v[112:115], a[168:171], v[88:91]
    v_mfma_f32_16x16x32_bf16 v[88:91], v[116:119], a[184:187], v[88:91]
    buffer_load_dwordx4 v[252:255], v9, s[12:15], s44 offen offset:1024 sc1
    v_mfma_f32_16x16x32_bf16 v[92:95], v[116:119], a[188:191], v[92:95]
    v_mfma_f32_16x16x32_bf16 v[92:95], v[112:115], a[172:175], v[92:95]
    v_mfma_f32_16x16x32_bf16 v[92:95], v[108:111], a[156:159], v[92:95]
    s_waitcnt lgkmcnt(0)
    v_mfma_f32_16x16x32_bf16 v[32:35], v[96:99], a[144:147], v[32:35]
    ds_read_b128 v[108:111], v5 offset:19456
    v_mfma_f32_16x16x32_bf16 v[32:35], v[100:103], a[160:163], v[32:35]
    buffer_load_dwordx4 v[196:199], v2, s[16:19], 0 offen offset:0 sc1
    v_mfma_f32_16x16x32_bf16 v[32:35], v[104:107], a[176:179], v[32:35]
    ds_read_b128 v[112:115], v5 offset:21504
    v_mfma_f32_16x16x32_bf16 v[36:39], v[104:107], a[180:183], v[36:39]
    v_mfma_f32_16x16x32_bf16 v[36:39], v[100:103], a[164:167], v[36:39]
    ds_read_b128 v[116:119], v5 offset:23552
    v_mfma_f32_16x16x32_bf16 v[36:39], v[96:99], a[148:151], v[36:39]
    buffer_load_dwordx4 v[202:205], v2, s[16:19], 0 offen offset:1024 sc1
    v_mfma_f32_16x16x32_bf16 v[40:43], v[96:99], a[152:155], v[40:43]
    v_mfma_f32_16x16x32_bf16 v[40:43], v[100:103], a[168:171], v[40:43]
    v_mfma_f32_16x16x32_bf16 v[40:43], v[104:107], a[184:187], v[40:43]
    v_mfma_f32_16x16x32_bf16 v[44:47], v[104:107], a[188:191], v[44:47]
    buffer_load_dwordx4 v[208:211], v2, s[16:19], 0 offen offset:2048 sc1
    v_mfma_f32_16x16x32_bf16 v[44:47], v[100:103], a[172:175], v[44:47]
    v_mfma_f32_16x16x32_bf16 v[44:47], v[96:99], a[156:159], v[44:47]
    s_waitcnt lgkmcnt(0)
    v_mfma_f32_16x16x32_bf16 v[48:51], v[108:111], a[144:147], v[48:51]
    ds_read_b128 v[96:99], v2 offset:24576
    v_mfma_f32_16x16x32_bf16 v[48:51], v[112:115], a[160:163], v[48:51]
    v_mfma_f32_16x16x32_bf16 v[48:51], v[116:119], a[176:179], v[48:51]
    ds_read_b128 v[100:103], v2 offset:26624
    buffer_load_dwordx4 v[214:217], v2, s[16:19], 0 offen offset:3072 sc1
    v_mfma_f32_16x16x32_bf16 v[52:55], v[116:119], a[180:183], v[52:55]
    s_add_u32 m0, s28, 0
    v_mfma_f32_16x16x32_bf16 v[52:55], v[112:115], a[164:167], v[52:55]
    s_add_u32 s29, s27, 0
    ds_read_b128 v[104:107], v2 offset:28672
    v_mfma_f32_16x16x32_bf16 v[52:55], v[108:111], a[148:151], v[52:55]
    buffer_load_dwordx4 v2, s[8:11], s29 offen offset:0 lds
    v_mfma_f32_16x16x32_bf16 v[56:59], v[108:111], a[152:155], v[56:59]
    v_mfma_f32_16x16x32_bf16 v[56:59], v[112:115], a[168:171], v[56:59]
    v_mfma_f32_16x16x32_bf16 v[56:59], v[116:119], a[184:187], v[56:59]
    buffer_load_dwordx4 v2, s[8:11], s29 offen offset:1024 lds
    v_mfma_f32_16x16x32_bf16 v[60:63], v[116:119], a[188:191], v[60:63]
    v_mfma_f32_16x16x32_bf16 v[60:63], v[112:115], a[172:175], v[60:63]
    v_mfma_f32_16x16x32_bf16 v[60:63], v[108:111], a[156:159], v[60:63]
    s_waitcnt vmcnt(27) lgkmcnt(0)
    v_mfma_f32_16x16x32_bf16 v[148:151], v[96:99], a[192:195], v[148:151]
    ds_read_b128 v[108:111], v2 offset:25600
    buffer_load_dwordx4 v2, s[8:11], s29 offen offset:2048 lds
    v_mfma_f32_16x16x32_bf16 v[148:151], v[100:103], a[208:211], v[148:151]
    v_mfma_f32_16x16x32_bf16 v[148:151], v[104:107], a[224:227], v[148:151]
    s_waitcnt vmcnt(25)
    ds_read_b128 v[112:115], v2 offset:27648
    v_mfma_f32_16x16x32_bf16 v[152:155], v[104:107], a[228:231], v[152:155]
    v_mfma_f32_16x16x32_bf16 v[152:155], v[100:103], a[212:215], v[152:155]
    ds_read_b128 v[116:119], v2 offset:29696
    buffer_load_dwordx4 v2, s[8:11], s29 offen offset:3072 lds
    v_mfma_f32_16x16x32_bf16 v[152:155], v[96:99], a[196:199], v[152:155]
    s_waitcnt vmcnt(23)
    v_mfma_f32_16x16x32_bf16 v[156:159], v[96:99], a[200:203], v[156:159]
    s_add_u32 m0, s28, 4096
    v_mfma_f32_16x16x32_bf16 v[156:159], v[100:103], a[216:219], v[156:159]
    s_add_u32 s29, s27, 4096
    v_mfma_f32_16x16x32_bf16 v[156:159], v[104:107], a[232:235], v[156:159]
    s_waitcnt vmcnt(20)
    buffer_load_dwordx4 v2, s[8:11], s29 offen offset:0 lds
    v_mfma_f32_16x16x32_bf16 v[160:163], v[104:107], a[236:239], v[160:163]
    v_mfma_f32_16x16x32_bf16 v[160:163], v[100:103], a[220:223], v[160:163]
    v_mfma_f32_16x16x32_bf16 v[160:163], v[96:99], a[204:207], v[160:163]
    s_waitcnt lgkmcnt(0)
    v_mfma_f32_16x16x32_bf16 v[164:167], v[108:111], a[192:195], v[164:167]
    ds_read_b128 v[96:99], v4 offset:24576
    buffer_load_dwordx4 v2, s[8:11], s29 offen offset:1024 lds
    v_mfma_f32_16x16x32_bf16 v[164:167], v[112:115], a[208:211], v[164:167]
    v_mfma_f32_16x16x32_bf16 v[164:167], v[116:119], a[224:227], v[164:167]
    ds_read_b128 v[100:103], v4 offset:26624
    v_mfma_f32_16x16x32_bf16 v[168:171], v[116:119], a[228:231], v[168:171]
    v_mfma_f32_16x16x32_bf16 v[168:171], v[112:115], a[212:215], v[168:171]
    ds_read_b128 v[104:107], v4 offset:28672
    buffer_load_dwordx4 v2, s[8:11], s29 offen offset:2048 lds
    v_mfma_f32_16x16x32_bf16 v[168:171], v[108:111], a[196:199], v[168:171]
    v_mfma_f32_16x16x32_bf16 v[172:175], v[108:111], a[200:203], v[172:175]
    v_mfma_f32_16x16x32_bf16 v[172:175], v[112:115], a[216:219], v[172:175]
    v_mfma_f32_16x16x32_bf16 v[172:175], v[116:119], a[232:235], v[172:175]
    buffer_load_dwordx4 v2, s[8:11], s29 offen offset:3072 lds
    v_mfma_f32_16x16x32_bf16 v[176:179], v[116:119], a[236:239], v[176:179]
    s_add_u32 m0, s28, 8192
    v_mfma_f32_16x16x32_bf16 v[176:179], v[112:115], a[220:223], v[176:179]
    s_add_u32 s29, s27, 8192
    v_mfma_f32_16x16x32_bf16 v[176:179], v[108:111], a[204:207], v[176:179]
    s_waitcnt lgkmcnt(0)
    v_mfma_f32_16x16x32_bf16 v[64:67], v[96:99], a[192:195], v[64:67]
    ds_read_b128 v[108:111], v4 offset:25600
    buffer_load_dwordx4 v2, s[8:11], s29 offen offset:0 lds
    v_mfma_f32_16x16x32_bf16 v[64:67], v[100:103], a[208:211], v[64:67]
    s_add_u32 s27, s27, 36864
    v_mfma_f32_16x16x32_bf16 v[64:67], v[104:107], a[224:227], v[64:67]
    s_add_u32 s38, s38, 1
    ds_read_b128 v[112:115], v4 offset:27648
    v_mfma_f32_16x16x32_bf16 v[68:71], v[104:107], a[228:231], v[68:71]
    s_and_b32 s38, s38, 3
    v_mfma_f32_16x16x32_bf16 v[68:71], v[100:103], a[212:215], v[68:71]
    s_mul_i32 s28, s38, 36864
    ds_read_b128 v[116:119], v4 offset:29696
    v_mfma_f32_16x16x32_bf16 v[68:71], v[96:99], a[196:199], v[68:71]
    s_add_u32 s28, s28, s26
    v_mfma_f32_16x16x32_bf16 v[72:75], v[96:99], a[200:203], v[72:75]
    s_add_u32 m0, s84, 0
    s_waitcnt vmcnt(12)
    v_add_f32 v196, v196, v198
    v_mfma_f32_16x16x32_bf16 v[72:75], v[100:103], a[216:219], v[72:75]
    s_add_u32 s86, s82, 0
    s_waitcnt vmcnt(11)
    v_add_f32 v202, v202, v204
    v_mfma_f32_16x16x32_bf16 v[72:75], v[104:107], a[232:235], v[72:75]
    buffer_load_dwordx4 v3, s[92:95], s86 offen nt lds
    s_waitcnt vmcnt(11)
    v_add_f32 v208, v208, v210
    v_mfma_f32_16x16x32_bf16 v[76:79], v[104:107], a[236:239], v[76:79]
    s_add_u32 m0, s84, 1024
    s_waitcnt vmcnt(10)
    v_add_f32 v214, v214, v216
    v_mfma_f32_16x16x32_bf16 v[76:79], v[100:103], a[220:223], v[76:79]
    s_add_u32 s86, s82, 9216
    v_add_f32 v197, v197, v199
    v_mfma_f32_16x16x32_bf16 v[76:79], v[96:99], a[204:207], v[76:79]
    s_waitcnt lgkmcnt(0)
    buffer_load_dwordx4 v6, s[92:95], s86 offen nt lds
    v_add_f32 v203, v203, v205
    v_mfma_f32_16x16x32_bf16 v[80:83], v[108:111], a[192:195], v[80:83]
    s_add_u32 m0, s84, 2048
    ds_read_b128 v[96:99], v5 offset:24576
    v_add_f32 v209, v209, v211
    v_mfma_f32_16x16x32_bf16 v[80:83], v[112:115], a[208:211], v[80:83]
    s_add_u32 s86, s82, 165888
    v_add_f32 v215, v215, v217
    v_mfma_f32_16x16x32_bf16 v[80:83], v[116:119], a[224:227], v[80:83]
    ds_read_b128 v[100:103], v5 offset:26624
    v_mov_b32 v198, v196
    v_mfma_f32_16x16x32_bf16 v[84:87], v[116:119], a[228:231], v[84:87]
    buffer_load_dwordx4 v3, s[92:95], s86 offen nt lds
    v_mov_b32 v204, v202
    v_mfma_f32_16x16x32_bf16 v[84:87], v[112:115], a[212:215], v[84:87]
    s_add_u32 m0, s84, 3072
    ds_read_b128 v[104:107], v5 offset:28672
    v_mov_b32 v210, v208
    v_mfma_f32_16x16x32_bf16 v[84:87], v[108:111], a[196:199], v[84:87]
    s_add_u32 s86, s82, 175104
    v_mov_b32 v216, v214
    v_mfma_f32_16x16x32_bf16 v[88:91], v[108:111], a[200:203], v[88:91]
    v_permlane16_swap_b32 v196, v198
    v_mfma_f32_16x16x32_bf16 v[88:91], v[112:115], a[216:219], v[88:91]
    buffer_load_dwordx4 v6, s[92:95], s86 offen nt lds
    v_mfma_f32_16x16x32_bf16 v[88:91], v[116:119], a[232:235], v[88:91]
    v_permlane16_swap_b32 v202, v204
    v_mfma_f32_16x16x32_bf16 v[92:95], v[116:119], a[236:239], v[92:95]
    v_permlane16_swap_b32 v208, v210
    v_mfma_f32_16x16x32_bf16 v[92:95], v[112:115], a[220:223], v[92:95]
    v_permlane16_swap_b32 v214, v216
    v_mfma_f32_16x16x32_bf16 v[92:95], v[108:111], a[204:207], v[92:95]
    s_waitcnt lgkmcnt(0)
    v_add_f32 v196, v196, v198
    v_mfma_f32_16x16x32_bf16 v[32:35], v[96:99], a[192:195], v[32:35]
    ds_read_b128 v[108:111], v5 offset:25600
    v_add_f32 v202, v202, v204
    v_mfma_f32_16x16x32_bf16 v[32:35], v[100:103], a[208:211], v[32:35]
    v_add_f32 v208, v208, v210
    v_mfma_f32_16x16x32_bf16 v[32:35], v[104:107], a[224:227], v[32:35]
    ds_read_b128 v[112:115], v5 offset:27648
    v_add_f32 v214, v214, v216
    v_mfma_f32_16x16x32_bf16 v[36:39], v[104:107], a[228:231], v[36:39]
    v_mov_b32 v198, v196
    v_mfma_f32_16x16x32_bf16 v[36:39], v[100:103], a[212:215], v[36:39]
    ds_read_b128 v[116:119], v5 offset:29696
    v_mov_b32 v204, v202
    v_mfma_f32_16x16x32_bf16 v[36:39], v[96:99], a[196:199], v[36:39]
    v_mov_b32 v210, v208
    v_mfma_f32_16x16x32_bf16 v[40:43], v[96:99], a[200:203], v[40:43]
    v_mov_b32 v216, v214
    v_mfma_f32_16x16x32_bf16 v[40:43], v[100:103], a[216:219], v[40:43]
    v_permlane32_swap_b32 v196, v198
    v_mfma_f32_16x16x32_bf16 v[40:43], v[104:107], a[232:235], v[40:43]
    v_mfma_f32_16x16x32_bf16 v[44:47], v[104:107], a[236:239], v[44:47]
    v_permlane32_swap_b32 v202, v204
    v_mfma_f32_16x16x32_bf16 v[44:47], v[100:103], a[220:223], v[44:47]
    v_permlane32_swap_b32 v208, v210
    v_mfma_f32_16x16x32_bf16 v[44:47], v[96:99], a[204:207], v[44:47]
    s_waitcnt lgkmcnt(0)
    v_permlane32_swap_b32 v214, v216
    v_mfma_f32_16x16x32_bf16 v[48:51], v[108:111], a[192:195], v[48:51]
    ds_read_b128 v[96:99], v2 offset:30720
    v_add_f32 v196, v196, v198
    v_mfma_f32_16x16x32_bf16 v[48:51], v[112:115], a[208:211], v[48:51]
    v_add_f32 v202, v202, v204
    v_mfma_f32_16x16x32_bf16 v[48:51], v[116:119], a[224:227], v[48:51]
    ds_read_b128 v[100:103], v2 offset:32768
    v_add_f32 v208, v208, v210
    v_mfma_f32_16x16x32_bf16 v[52:55], v[116:119], a[228:231], v[52:55]
    v_add_f32 v214, v214, v216
    v_mfma_f32_16x16x32_bf16 v[52:55], v[112:115], a[212:215], v[52:55]
    ds_read_b128 v[104:107], v2 offset:34816
    v_mov_b32 v199, v197
    v_mfma_f32_16x16x32_bf16 v[52:55], v[108:111], a[196:199], v[52:55]
    v_mov_b32 v205, v203
    v_mfma_f32_16x16x32_bf16 v[56:59], v[108:111], a[200:203], v[56:59]
    v_mov_b32 v211, v209
    v_mfma_f32_16x16x32_bf16 v[56:59], v[112:115], a[216:219], v[56:59]
    v_mov_b32 v217, v215
    v_mfma_f32_16x16x32_bf16 v[56:59], v[116:119], a[232:235], v[56:59]
    v_permlane16_swap_b32 v197, v199
    v_mfma_f32_16x16x32_bf16 v[60:63], v[116:119], a[236:239], v[60:63]
    v_permlane16_swap_b32 v203, v205
    v_mfma_f32_16x16x32_bf16 v[60:63], v[112:115], a[220:223], v[60:63]
    v_mfma_f32_16x16x32_bf16 v[60:63], v[108:111], a[204:207], v[60:63]
    s_waitcnt lgkmcnt(0)
    v_permlane16_swap_b32 v209, v211
    v_mfma_f32_16x16x32_bf16 v[148:151], v[96:99], a[240:243], v[148:151]
    ds_read_b128 v[108:111], v2 offset:31744
    v_permlane16_swap_b32 v215, v217
    v_mfma_f32_16x16x32_bf16 v[148:151], v[100:103], v[224:227], v[148:151]
    v_add_f32 v197, v197, v199
    v_mfma_f32_16x16x32_bf16 v[148:151], v[104:107], v[240:243], v[148:151]
    ds_read_b128 v[112:115], v2 offset:33792
    v_add_f32 v203, v203, v205
    v_mfma_f32_16x16x32_bf16 v[152:155], v[104:107], v[244:247], v[152:155]
    v_add_f32 v209, v209, v211
    v_mfma_f32_16x16x32_bf16 v[152:155], v[100:103], v[228:231], v[152:155]
    ds_read_b128 v[116:119], v2 offset:35840
    v_add_f32 v215, v215, v217
    v_mfma_f32_16x16x32_bf16 v[152:155], v[96:99], a[244:247], v[152:155]
    v_mov_b32 v199, v197
    v_mfma_f32_16x16x32_bf16 v[156:159], v[96:99], a[248:251], v[156:159]
    v_mov_b32 v205, v203
    v_mfma_f32_16x16x32_bf16 v[156:159], v[100:103], v[232:235], v[156:159]
    v_mov_b32 v211, v209
    v_mfma_f32_16x16x32_bf16 v[156:159], v[104:107], v[248:251], v[156:159]
    v_mov_b32 v217, v215
    v_mfma_f32_16x16x32_bf16 v[160:163], v[104:107], v[252:255], v[160:163]
    v_permlane32_swap_b32 v197, v199
    v_mfma_f32_16x16x32_bf16 v[160:163], v[100:103], v[236:239], v[160:163]
    v_permlane32_swap_b32 v203, v205
    v_mfma_f32_16x16x32_bf16 v[160:163], v[96:99], a[252:255], v[160:163]
    s_waitcnt lgkmcnt(0)
    v_mfma_f32_16x16x32_bf16 v[164:167], v[108:111], a[240:243], v[164:167]
    ds_read_b128 v[96:99], v4 offset:30720
    v_permlane32_swap_b32 v209, v211
    v_mfma_f32_16x16x32_bf16 v[164:167], v[112:115], v[224:227], v[164:167]
    v_permlane32_swap_b32 v215, v217
    v_mfma_f32_16x16x32_bf16 v[164:167], v[116:119], v[240:243], v[164:167]
    ds_read_b128 v[100:103], v4 offset:32768
    v_add_f32 v197, v197, v199
    v_mfma_f32_16x16x32_bf16 v[168:171], v[116:119], v[244:247], v[168:171]
    v_add_f32 v203, v203, v205
    v_mfma_f32_16x16x32_bf16 v[168:171], v[112:115], v[228:231], v[168:171]
    ds_read_b128 v[104:107], v4 offset:34816
    v_add_f32 v209, v209, v211
    v_mfma_f32_16x16x32_bf16 v[168:171], v[108:111], a[244:247], v[168:171]
    v_add_f32 v215, v215, v217
    v_mfma_f32_16x16x32_bf16 v[172:175], v[108:111], a[248:251], v[172:175]
    v_mul_f32 v16, 0x3ae38e39, v196
    v_mfma_f32_16x16x32_bf16 v[172:175], v[112:115], v[232:235], v[172:175]
    v_mul_f32 v17, 0x3ae38e39, v202
    v_mfma_f32_16x16x32_bf16 v[172:175], v[116:119], v[248:251], v[172:175]
    v_mul_f32 v18, 0x3ae38e39, v208
    v_mfma_f32_16x16x32_bf16 v[176:179], v[116:119], v[252:255], v[176:179]
    v_mul_f32 v19, 0x3ae38e39, v214
    v_mfma_f32_16x16x32_bf16 v[176:179], v[112:115], v[236:239], v[176:179]
    v_mul_f32 v197, 0x3ae38e39, v197
    v_mfma_f32_16x16x32_bf16 v[176:179], v[108:111], a[252:255], v[176:179]
    s_waitcnt lgkmcnt(0)
    v_mul_f32 v203, 0x3ae38e39, v203
    v_mfma_f32_16x16x32_bf16 v[64:67], v[96:99], a[240:243], v[64:67]
    ds_read_b128 v[108:111], v4 offset:31744
    v_mul_f32 v209, 0x3ae38e39, v209
    v_mfma_f32_16x16x32_bf16 v[64:67], v[100:103], v[224:227], v[64:67]
    v_mfma_f32_16x16x32_bf16 v[64:67], v[104:107], v[240:243], v[64:67]
    ds_read_b128 v[112:115], v4 offset:33792
    v_mul_f32 v215, 0x3ae38e39, v215
    v_mfma_f32_16x16x32_bf16 v[68:71], v[104:107], v[244:247], v[68:71]
    v_fma_f32 v197, -v16, v16, v197
    v_mfma_f32_16x16x32_bf16 v[68:71], v[100:103], v[228:231], v[68:71]
    ds_read_b128 v[116:119], v4 offset:35840
    v_fma_f32 v203, -v17, v17, v203
    v_mfma_f32_16x16x32_bf16 v[68:71], v[96:99], a[244:247], v[68:71]
    v_fma_f32 v209, -v18, v18, v209
    v_mfma_f32_16x16x32_bf16 v[72:75], v[96:99], a[248:251], v[72:75]
    v_fma_f32 v215, -v19, v19, v215
    v_mfma_f32_16x16x32_bf16 v[72:75], v[100:103], v[232:235], v[72:75]
    v_max_f32 v197, 0, v197
    v_mfma_f32_16x16x32_bf16 v[72:75], v[104:107], v[248:251], v[72:75]
    v_max_f32 v203, 0, v203
    v_mfma_f32_16x16x32_bf16 v[76:79], v[104:107], v[252:255], v[76:79]
    v_max_f32 v209, 0, v209
    v_mfma_f32_16x16x32_bf16 v[76:79], v[100:103], v[236:239], v[76:79]
    v_max_f32 v215, 0, v215
    v_mfma_f32_16x16x32_bf16 v[76:79], v[96:99], a[252:255], v[76:79]
    s_waitcnt lgkmcnt(0)
    v_add_f32 v28, 0x3727c5ac, v197
    v_mfma_f32_16x16x32_bf16 v[80:83], v[108:111], a[240:243], v[80:83]
    ds_read_b128 v[96:99], v5 offset:30720
    v_add_f32 v29, 0x3727c5ac, v203
    v_mfma_f32_16x16x32_bf16 v[80:83], v[112:115], v[224:227], v[80:83]
    v_add_f32 v30, 0x3727c5ac, v209
    v_mfma_f32_16x16x32_bf16 v[80:83], v[116:119], v[240:243], v[80:83]
    ds_read_b128 v[100:103], v5 offset:32768
    v_mfma_f32_16x16x32_bf16 v[84:87], v[116:119], v[244:247], v[84:87]
    v_add_f32 v31, 0x3727c5ac, v215
    v_mfma_f32_16x16x32_bf16 v[84:87], v[112:115], v[228:231], v[84:87]
    ds_read_b128 v[104:107], v5 offset:34816
    v_mfma_f32_16x16x32_bf16 v[84:87], v[108:111], a[244:247], v[84:87]
    v_rsq_f32 v200, v28
    v_mfma_f32_16x16x32_bf16 v[88:91], v[108:111], a[248:251], v[88:91]
    v_rsq_f32 v206, v29
    v_mfma_f32_16x16x32_bf16 v[88:91], v[112:115], v[232:235], v[88:91]
    v_mfma_f32_16x16x32_bf16 v[88:91], v[116:119], v[248:251], v[88:91]
    v_rsq_f32 v212, v30
    v_mfma_f32_16x16x32_bf16 v[92:95], v[116:119], v[252:255], v[92:95]
    v_mfma_f32_16x16x32_bf16 v[92:95], v[112:115], v[236:239], v[92:95]
    v_rsq_f32 v218, v31
    v_mfma_f32_16x16x32_bf16 v[92:95], v[108:111], a[252:255], v[92:95]
    s_waitcnt lgkmcnt(0)
    v_mfma_f32_16x16x32_bf16 v[32:35], v[96:99], a[240:243], v[32:35]
    ds_read_b128 v[108:111], v5 offset:31744
    v_mul_f32 v20, 0xc0135761, v200
    v_mfma_f32_16x16x32_bf16 v[32:35], v[100:103], v[224:227], v[32:35]
    v_mul_f32 v21, 0xc0135761, v206
    v_mfma_f32_16x16x32_bf16 v[32:35], v[104:107], v[240:243], v[32:35]
    ds_read_b128 v[112:115], v5 offset:33792
    v_mul_f32 v22, 0xc0135761, v212
    v_mfma_f32_16x16x32_bf16 v[36:39], v[104:107], v[244:247], v[36:39]
    v_mul_f32 v23, 0xc0135761, v218
    v_mfma_f32_16x16x32_bf16 v[36:39], v[100:103], v[228:231], v[36:39]
    ds_read_b128 v[116:119], v5 offset:35840
    v_mfma_f32_16x16x32_bf16 v[36:39], v[96:99], a[244:247], v[36:39]
    v_mul_f32 v196, v200, v200
    v_mfma_f32_16x16x32_bf16 v[40:43], v[96:99], a[248:251], v[40:43]
    v_mul_f32 v202, v206, v206
    v_mfma_f32_16x16x32_bf16 v[40:43], v[100:103], v[232:235], v[40:43]
    v_mul_f32 v208, v212, v212
    v_mfma_f32_16x16x32_bf16 v[40:43], v[104:107], v[248:251], v[40:43]
    v_mul_f32 v214, v218, v218
    v_mfma_f32_16x16x32_bf16 v[44:47], v[104:107], v[252:255], v[44:47]
    v_mul_f32 v196, v196, v200
    v_mfma_f32_16x16x32_bf16 v[44:47], v[100:103], v[236:239], v[44:47]
    v_mul_f32 v202, v202, v206
    v_mfma_f32_16x16x32_bf16 v[44:47], v[96:99], a[252:255], v[44:47]
    s_waitcnt lgkmcnt(0)
    v_mul_f32 v208, v208, v212
    v_mfma_f32_16x16x32_bf16 v[48:51], v[108:111], a[240:243], v[48:51]
    v_mul_f32 v214, v214, v218
    v_mfma_f32_16x16x32_bf16 v[48:51], v[112:115], v[224:227], v[48:51]
    v_mul_f32 v24, 0xbdd2d3e8, v196
    v_mfma_f32_16x16x32_bf16 v[48:51], v[116:119], v[240:243], v[48:51]
    v_mul_f32 v25, 0xbdd2d3e8, v202
    v_mfma_f32_16x16x32_bf16 v[52:55], v[116:119], v[244:247], v[52:55]
    v_mul_f32 v26, 0xbdd2d3e8, v208
    v_mfma_f32_16x16x32_bf16 v[52:55], v[112:115], v[228:231], v[52:55]
    v_mul_f32 v27, 0xbdd2d3e8, v214
    v_mfma_f32_16x16x32_bf16 v[52:55], v[108:111], a[244:247], v[52:55]
    v_mfma_f32_16x16x32_bf16 v[56:59], v[108:111], a[248:251], v[56:59]
    v_mfma_f32_16x16x32_bf16 v[56:59], v[112:115], v[232:235], v[56:59]
    v_mfma_f32_16x16x32_bf16 v[56:59], v[116:119], v[248:251], v[56:59]
    v_mfma_f32_16x16x32_bf16 v[60:63], v[116:119], v[252:255], v[60:63]
    v_mfma_f32_16x16x32_bf16 v[60:63], v[112:115], v[236:239], v[60:63]
    v_mfma_f32_16x16x32_bf16 v[60:63], v[108:111], a[252:255], v[60:63]
    s_waitcnt vmcnt(4)
    s_barrier
    v_pk_fma_f32 v[148:149], v[16:17], v[180:181], v[148:149] op_sel:[0,0,0] op_sel_hi:[0,1,1] neg_lo:[1,0,0] neg_hi:[1,0,0]
    v_pk_fma_f32 v[150:151], v[16:17], v[182:183], v[150:151] op_sel:[0,0,0] op_sel_hi:[0,1,1] neg_lo:[1,0,0] neg_hi:[1,0,0]
    v_pk_fma_f32 v[152:153], v[16:17], v[180:181], v[152:153] op_sel:[1,0,0] op_sel_hi:[1,1,1] neg_lo:[1,0,0] neg_hi:[1,0,0]
    v_pk_fma_f32 v[154:155], v[16:17], v[182:183], v[154:155] op_sel:[1,0,0] op_sel_hi:[1,1,1] neg_lo:[1,0,0] neg_hi:[1,0,0]
    s_add_u32 m0, s28, 0
    v_pk_fma_f32 v[164:165], v[16:17], v[184:185], v[164:165] op_sel:[0,0,0] op_sel_hi:[0,1,1] neg_lo:[1,0,0] neg_hi:[1,0,0]
    v_pk_fma_f32 v[166:167], v[16:17], v[186:187], v[166:167] op_sel:[0,0,0] op_sel_hi:[0,1,1] neg_lo:[1,0,0] neg_hi:[1,0,0]
    v_pk_fma_f32 v[168:169], v[16:17], v[184:185], v[168:169] op_sel:[1,0,0] op_sel_hi:[1,1,1] neg_lo:[1,0,0] neg_hi:[1,0,0]
    v_pk_fma_f32 v[170:171], v[16:17], v[186:187], v[170:171] op_sel:[1,0,0] op_sel_hi:[1,1,1] neg_lo:[1,0,0] neg_hi:[1,0,0]
    s_add_u32 s29, s27, 0
    v_pk_mul_f32 v[128:129], v[148:149], v[148:149]
    v_pk_mul_f32 v[130:131], v[150:151], v[150:151]
    v_pk_mul_f32 v[132:133], v[152:153], v[152:153]
    v_pk_mul_f32 v[134:135], v[154:155], v[154:155]
    buffer_load_dwordx4 v2, s[8:11], s29 offen offset:0 lds
    v_pk_fma_f32 v[128:129], v[128:129], v[24:25], v[20:21] op_sel:[0,0,0] op_sel_hi:[1,0,0]
    v_pk_fma_f32 v[130:131], v[130:131], v[24:25], v[20:21] op_sel:[0,0,0] op_sel_hi:[1,0,0]
    v_pk_fma_f32 v[132:133], v[132:133], v[24:25], v[20:21] op_sel:[0,1,1] op_sel_hi:[1,1,1]
    v_pk_fma_f32 v[134:135], v[134:135], v[24:25], v[20:21] op_sel:[0,1,1] op_sel_hi:[1,1,1]
    buffer_load_dwordx4 v2, s[8:11], s29 offen offset:1024 lds
    v_pk_mul_f32 v[128:129], v[128:129], v[148:149]
    v_pk_mul_f32 v[130:131], v[130:131], v[150:151]
    v_pk_mul_f32 v[132:133], v[132:133], v[152:153]
    v_pk_mul_f32 v[134:135], v[134:135], v[154:155]
    buffer_load_dwordx4 v2, s[8:11], s29 offen offset:2048 lds
    v_exp_f32 v128, v128
    v_exp_f32 v130, v130
    v_exp_f32 v132, v132
    v_exp_f32 v134, v134
    buffer_load_dwordx4 v2, s[8:11], s29 offen offset:3072 lds
    v_exp_f32 v129, v129
    v_exp_f32 v131, v131
    v_exp_f32 v133, v133
    v_exp_f32 v135, v135
    s_add_u32 m0, s28, 4096
    v_pk_mul_f32 v[164:165], v[148:149], v[164:165]
    v_pk_mul_f32 v[166:167], v[150:151], v[166:167]
    v_pk_mul_f32 v[168:169], v[152:153], v[168:169]
    v_pk_mul_f32 v[170:171], v[154:155], v[170:171]
    s_add_u32 s29, s27, 4096
    v_pk_fma_f32 v[128:129], v[128:129], v[28:29], v[28:29] op_sel:[0,0,0] op_sel_hi:[1,0,0]
    v_pk_fma_f32 v[130:131], v[130:131], v[28:29], v[28:29] op_sel:[0,0,0] op_sel_hi:[1,0,0]
    v_pk_fma_f32 v[132:133], v[132:133], v[28:29], v[28:29] op_sel:[0,1,1] op_sel_hi:[1,1,1]
    v_pk_fma_f32 v[134:135], v[134:135], v[28:29], v[28:29] op_sel:[0,1,1] op_sel_hi:[1,1,1]
    buffer_load_dwordx4 v2, s[8:11], s29 offen offset:0 lds
    v_rcp_f32 v128, v128
    v_rcp_f32 v130, v130
    v_rcp_f32 v132, v132
    v_rcp_f32 v134, v134
    buffer_load_dwordx4 v2, s[8:11], s29 offen offset:1024 lds
    v_rcp_f32 v129, v129
    v_rcp_f32 v131, v131
    v_rcp_f32 v133, v133
    v_rcp_f32 v135, v135
    buffer_load_dwordx4 v2, s[8:11], s29 offen offset:2048 lds
    v_pk_mul_f32 v[164:165], v[164:165], v[128:129]
    v_pk_mul_f32 v[166:167], v[166:167], v[130:131]
    v_pk_mul_f32 v[168:169], v[168:169], v[132:133]
    v_pk_mul_f32 v[170:171], v[170:171], v[134:135]
    buffer_load_dwordx4 v2, s[8:11], s29 offen offset:3072 lds
    v_cvt_pk_bf16_f32 v140, v164, v165
    v_cvt_pk_bf16_f32 v141, v166, v167
    v_cvt_pk_bf16_f32 v142, v168, v169
    v_cvt_pk_bf16_f32 v143, v170, v171
    s_add_u32 m0, s28, 8192
    v_pk_fma_f32 v[156:157], v[18:19], v[180:181], v[156:157] op_sel:[0,0,0] op_sel_hi:[0,1,1] neg_lo:[1,0,0] neg_hi:[1,0,0]
    v_pk_fma_f32 v[158:159], v[18:19], v[182:183], v[158:159] op_sel:[0,0,0] op_sel_hi:[0,1,1] neg_lo:[1,0,0] neg_hi:[1,0,0]
    v_pk_fma_f32 v[160:161], v[18:19], v[180:181], v[160:161] op_sel:[1,0,0] op_sel_hi:[1,1,1] neg_lo:[1,0,0] neg_hi:[1,0,0]
    v_pk_fma_f32 v[162:163], v[18:19], v[182:183], v[162:163] op_sel:[1,0,0] op_sel_hi:[1,1,1] neg_lo:[1,0,0] neg_hi:[1,0,0]
    v_permlane32_swap_b32 v140, v142
    v_permlane32_swap_b32 v141, v143
    buffer_store_dwordx4 v[140:143], v13, s[88:91], s34 offen sc1
    s_add_u32 s29, s27, 8192
    v_pk_fma_f32 v[172:173], v[18:19], v[184:185], v[172:173] op_sel:[0,0,0] op_sel_hi:[0,1,1] neg_lo:[1,0,0] neg_hi:[1,0,0]
    v_pk_fma_f32 v[174:175], v[18:19], v[186:187], v[174:175] op_sel:[0,0,0] op_sel_hi:[0,1,1] neg_lo:[1,0,0] neg_hi:[1,0,0]
    v_pk_fma_f32 v[176:177], v[18:19], v[184:185], v[176:177] op_sel:[1,0,0] op_sel_hi:[1,1,1] neg_lo:[1,0,0] neg_hi:[1,0,0]
    v_pk_fma_f32 v[178:179], v[18:19], v[186:187], v[178:179] op_sel:[1,0,0] op_sel_hi:[1,1,1] neg_lo:[1,0,0] neg_hi:[1,0,0]
    buffer_load_dwordx4 v2, s[8:11], s29 offen offset:0 lds
    v_pk_mul_f32 v[128:129], v[156:157], v[156:157]
    v_pk_mul_f32 v[130:131], v[158:159], v[158:159]
    v_pk_mul_f32 v[132:133], v[160:161], v[160:161]
    v_pk_mul_f32 v[134:135], v[162:163], v[162:163]
    s_add_u32 s27, s27, 36864
    v_pk_fma_f32 v[128:129], v[128:129], v[26:27], v[22:23] op_sel:[0,0,0] op_sel_hi:[1,0,0]
    v_pk_fma_f32 v[130:131], v[130:131], v[26:27], v[22:23] op_sel:[0,0,0] op_sel_hi:[1,0,0]
    v_pk_fma_f32 v[132:133], v[132:133], v[26:27], v[22:23] op_sel:[0,1,1] op_sel_hi:[1,1,1]
    v_pk_fma_f32 v[134:135], v[134:135], v[26:27], v[22:23] op_sel:[0,1,1] op_sel_hi:[1,1,1]
    s_add_u32 s38, s38, 1
    v_pk_mul_f32 v[128:129], v[128:129], v[156:157]
    v_pk_mul_f32 v[130:131], v[130:131], v[158:159]
    v_pk_mul_f32 v[132:133], v[132:133], v[160:161]
    v_pk_mul_f32 v[134:135], v[134:135], v[162:163]
    s_and_b32 s38, s38, 3
    v_exp_f32 v128, v128
    v_exp_f32 v130, v130
    v_exp_f32 v132, v132
    v_exp_f32 v134, v134
    s_mul_i32 s28, s38, 36864
    v_exp_f32 v129, v129
    v_exp_f32 v131, v131
    v_exp_f32 v133, v133
    v_exp_f32 v135, v135
    s_add_u32 s28, s28, s26
    v_pk_mul_f32 v[172:173], v[156:157], v[172:173]
    v_pk_mul_f32 v[174:175], v[158:159], v[174:175]
    v_pk_mul_f32 v[176:177], v[160:161], v[176:177]
    v_pk_mul_f32 v[178:179], v[162:163], v[178:179]
    v_pk_fma_f32 v[128:129], v[128:129], v[30:31], v[30:31] op_sel:[0,0,0] op_sel_hi:[1,0,0]
    v_pk_fma_f32 v[130:131], v[130:131], v[30:31], v[30:31] op_sel:[0,0,0] op_sel_hi:[1,0,0]
    v_pk_fma_f32 v[132:133], v[132:133], v[30:31], v[30:31] op_sel:[0,1,1] op_sel_hi:[1,1,1]
    v_pk_fma_f32 v[134:135], v[134:135], v[30:31], v[30:31] op_sel:[0,1,1] op_sel_hi:[1,1,1]
    v_rcp_f32 v128, v128
    v_rcp_f32 v130, v130
    v_rcp_f32 v132, v132
    v_rcp_f32 v134, v134
    v_rcp_f32 v129, v129
    v_rcp_f32 v131, v131
    v_rcp_f32 v133, v133
    v_rcp_f32 v135, v135
    v_pk_mul_f32 v[172:173], v[172:173], v[128:129]
    v_pk_mul_f32 v[174:175], v[174:175], v[130:131]
    v_pk_mul_f32 v[176:177], v[176:177], v[132:133]
    v_pk_mul_f32 v[178:179], v[178:179], v[134:135]
    v_cvt_pk_bf16_f32 v144, v172, v173
    v_cvt_pk_bf16_f32 v145, v174, v175
    v_cvt_pk_bf16_f32 v146, v176, v177
    v_cvt_pk_bf16_f32 v147, v178, v179
    s_nop 0
    v_permlane32_swap_b32 v144, v146
    v_permlane32_swap_b32 v145, v147
    buffer_store_dwordx4 v[144:147], v13, s[88:91], s35 offen sc1
    s_add_u32 s34, s34, 4096
    s_add_u32 s35, s35, 4096
    v_pk_fma_f32 v[64:65], v[16:17], v[188:189], v[64:65] op_sel:[0,0,0] op_sel_hi:[0,1,1] neg_lo:[1,0,0] neg_hi:[1,0,0]
    v_pk_fma_f32 v[66:67], v[16:17], v[190:191], v[66:67] op_sel:[0,0,0] op_sel_hi:[0,1,1] neg_lo:[1,0,0] neg_hi:[1,0,0]
    v_pk_fma_f32 v[68:69], v[16:17], v[188:189], v[68:69] op_sel:[1,0,0] op_sel_hi:[1,1,1] neg_lo:[1,0,0] neg_hi:[1,0,0]
    v_pk_fma_f32 v[70:71], v[16:17], v[190:191], v[70:71] op_sel:[1,0,0] op_sel_hi:[1,1,1] neg_lo:[1,0,0] neg_hi:[1,0,0]
    v_pk_fma_f32 v[80:81], v[16:17], v[192:193], v[80:81] op_sel:[0,0,0] op_sel_hi:[0,1,1] neg_lo:[1,0,0] neg_hi:[1,0,0]
    v_pk_fma_f32 v[82:83], v[16:17], v[194:195], v[82:83] op_sel:[0,0,0] op_sel_hi:[0,1,1] neg_lo:[1,0,0] neg_hi:[1,0,0]
    v_pk_fma_f32 v[84:85], v[16:17], v[192:193], v[84:85] op_sel:[1,0,0] op_sel_hi:[1,1,1] neg_lo:[1,0,0] neg_hi:[1,0,0]
    v_pk_fma_f32 v[86:87], v[16:17], v[194:195], v[86:87] op_sel:[1,0,0] op_sel_hi:[1,1,1] neg_lo:[1,0,0] neg_hi:[1,0,0]
    v_pk_mul_f32 v[128:129], v[64:65], v[64:65]
    v_pk_mul_f32 v[130:131], v[66:67], v[66:67]
    v_pk_mul_f32 v[132:133], v[68:69], v[68:69]
    v_pk_mul_f32 v[134:135], v[70:71], v[70:71]
    v_pk_fma_f32 v[128:129], v[128:129], v[24:25], v[20:21] op_sel:[0,0,0] op_sel_hi:[1,0,0]
    v_pk_fma_f32 v[130:131], v[130:131], v[24:25], v[20:21] op_sel:[0,0,0] op_sel_hi:[1,0,0]
    v_pk_fma_f32 v[132:133], v[132:133], v[24:25], v[20:21] op_sel:[0,1,1] op_sel_hi:[1,1,1]
    v_pk_fma_f32 v[134:135], v[134:135], v[24:25], v[20:21] op_sel:[0,1,1] op_sel_hi:[1,1,1]
    v_pk_mul_f32 v[128:129], v[128:129], v[64:65]
    v_pk_mul_f32 v[130:131], v[130:131], v[66:67]
    v_pk_mul_f32 v[132:133], v[132:133], v[68:69]
    v_pk_mul_f32 v[134:135], v[134:135], v[70:71]
    v_exp_f32 v128, v128
    v_exp_f32 v130, v130
    v_exp_f32 v132, v132
    v_exp_f32 v134, v134
    v_exp_f32 v129, v129
    v_exp_f32 v131, v131
    v_exp_f32 v133, v133
    v_exp_f32 v135, v135
    v_pk_mul_f32 v[80:81], v[64:65], v[80:81]
    v_pk_mul_f32 v[82:83], v[66:67], v[82:83]
    v_pk_mul_f32 v[84:85], v[68:69], v[84:85]
    v_pk_mul_f32 v[86:87], v[70:71], v[86:87]
    v_pk_fma_f32 v[128:129], v[128:129], v[28:29], v[28:29] op_sel:[0,0,0] op_sel_hi:[1,0,0]
    v_pk_fma_f32 v[130:131], v[130:131], v[28:29], v[28:29] op_sel:[0,0,0] op_sel_hi:[1,0,0]
    v_pk_fma_f32 v[132:133], v[132:133], v[28:29], v[28:29] op_sel:[0,1,1] op_sel_hi:[1,1,1]
    v_pk_fma_f32 v[134:135], v[134:135], v[28:29], v[28:29] op_sel:[0,1,1] op_sel_hi:[1,1,1]
    v_rcp_f32 v128, v128
    v_rcp_f32 v130, v130
    v_rcp_f32 v132, v132
    v_rcp_f32 v134, v134
    v_rcp_f32 v129, v129
    v_rcp_f32 v131, v131
    v_rcp_f32 v133, v133
    v_rcp_f32 v135, v135
    v_pk_mul_f32 v[80:81], v[80:81], v[128:129]
    v_pk_mul_f32 v[82:83], v[82:83], v[130:131]
    v_pk_mul_f32 v[84:85], v[84:85], v[132:133]
    v_pk_mul_f32 v[86:87], v[86:87], v[134:135]
    v_cvt_pk_bf16_f32 v140, v80, v81
    v_cvt_pk_bf16_f32 v141, v82, v83
    v_cvt_pk_bf16_f32 v142, v84, v85
    v_cvt_pk_bf16_f32 v143, v86, v87
    v_pk_fma_f32 v[72:73], v[18:19], v[188:189], v[72:73] op_sel:[0,0,0] op_sel_hi:[0,1,1] neg_lo:[1,0,0] neg_hi:[1,0,0]
    v_pk_fma_f32 v[74:75], v[18:19], v[190:191], v[74:75] op_sel:[0,0,0] op_sel_hi:[0,1,1] neg_lo:[1,0,0] neg_hi:[1,0,0]
    v_pk_fma_f32 v[76:77], v[18:19], v[188:189], v[76:77] op_sel:[1,0,0] op_sel_hi:[1,1,1] neg_lo:[1,0,0] neg_hi:[1,0,0]
    v_pk_fma_f32 v[78:79], v[18:19], v[190:191], v[78:79] op_sel:[1,0,0] op_sel_hi:[1,1,1] neg_lo:[1,0,0] neg_hi:[1,0,0]
    v_permlane32_swap_b32 v140, v142
    v_permlane32_swap_b32 v141, v143
    buffer_store_dwordx4 v[140:143], v13, s[88:91], s34 offen sc1
    v_pk_fma_f32 v[88:89], v[18:19], v[192:193], v[88:89] op_sel:[0,0,0] op_sel_hi:[0,1,1] neg_lo:[1,0,0] neg_hi:[1,0,0]
    v_pk_fma_f32 v[90:91], v[18:19], v[194:195], v[90:91] op_sel:[0,0,0] op_sel_hi:[0,1,1] neg_lo:[1,0,0] neg_hi:[1,0,0]
    v_pk_fma_f32 v[92:93], v[18:19], v[192:193], v[92:93] op_sel:[1,0,0] op_sel_hi:[1,1,1] neg_lo:[1,0,0] neg_hi:[1,0,0]
    v_pk_fma_f32 v[94:95], v[18:19], v[194:195], v[94:95] op_sel:[1,0,0] op_sel_hi:[1,1,1] neg_lo:[1,0,0] neg_hi:[1,0,0]
    v_pk_mul_f32 v[128:129], v[72:73], v[72:73]
    v_pk_mul_f32 v[130:131], v[74:75], v[74:75]
    v_pk_mul_f32 v[132:133], v[76:77], v[76:77]
    v_pk_mul_f32 v[134:135], v[78:79], v[78:79]
    v_pk_fma_f32 v[128:129], v[128:129], v[26:27], v[22:23] op_sel:[0,0,0] op_sel_hi:[1,0,0]
    v_pk_fma_f32 v[130:131], v[130:131], v[26:27], v[22:23] op_sel:[0,0,0] op_sel_hi:[1,0,0]
    v_pk_fma_f32 v[132:133], v[132:133], v[26:27], v[22:23] op_sel:[0,1,1] op_sel_hi:[1,1,1]
    v_pk_fma_f32 v[134:135], v[134:135], v[26:27], v[22:23] op_sel:[0,1,1] op_sel_hi:[1,1,1]
    v_pk_mul_f32 v[128:129], v[128:129], v[72:73]
    v_pk_mul_f32 v[130:131], v[130:131], v[74:75]
    v_pk_mul_f32 v[132:133], v[132:133], v[76:77]
    v_pk_mul_f32 v[134:135], v[134:135], v[78:79]
    v_exp_f32 v128, v128
    v_exp_f32 v130, v130
    v_exp_f32 v132, v132
    v_exp_f32 v134, v134
    v_exp_f32 v129, v129
    v_exp_f32 v131, v131
    v_exp_f32 v133, v133
    v_exp_f32 v135, v135
    v_pk_mul_f32 v[88:89], v[72:73], v[88:89]
    v_pk_mul_f32 v[90:91], v[74:75], v[90:91]
    v_pk_mul_f32 v[92:93], v[76:77], v[92:93]
    v_pk_mul_f32 v[94:95], v[78:79], v[94:95]
    v_pk_fma_f32 v[128:129], v[128:129], v[30:31], v[30:31] op_sel:[0,0,0] op_sel_hi:[1,0,0]
    v_pk_fma_f32 v[130:131], v[130:131], v[30:31], v[30:31] op_sel:[0,0,0] op_sel_hi:[1,0,0]
    v_pk_fma_f32 v[132:133], v[132:133], v[30:31], v[30:31] op_sel:[0,1,1] op_sel_hi:[1,1,1]
    v_pk_fma_f32 v[134:135], v[134:135], v[30:31], v[30:31] op_sel:[0,1,1] op_sel_hi:[1,1,1]
    v_rcp_f32 v128, v128
    v_rcp_f32 v130, v130
    v_rcp_f32 v132, v132
    v_rcp_f32 v134, v134
    v_rcp_f32 v129, v129
    v_rcp_f32 v131, v131
    v_rcp_f32 v133, v133
    v_rcp_f32 v135, v135
    v_pk_mul_f32 v[88:89], v[88:89], v[128:129]
    v_pk_mul_f32 v[90:91], v[90:91], v[130:131]
    v_pk_mul_f32 v[92:93], v[92:93], v[132:133]
    v_pk_mul_f32 v[94:95], v[94:95], v[134:135]
    v_cvt_pk_bf16_f32 v144, v88, v89
    v_cvt_pk_bf16_f32 v145, v90, v91
    v_cvt_pk_bf16_f32 v146, v92, v93
    v_cvt_pk_bf16_f32 v147, v94, v95
    s_nop 0
    v_permlane32_swap_b32 v144, v146
    v_permlane32_swap_b32 v145, v147
    buffer_store_dwordx4 v[144:147], v13, s[88:91], s35 offen sc1
    s_add_u32 s34, s34, 4096
    s_add_u32 s35, s35, 4096
    s_cmp_eq_u32 s83, 1
    s_cbranch_scc0 SK_mk_13
    v_lshrrev_b32 v148, 4, v1
    v_bfe_u32 v149, v1, 2, 2
    v_lshl_add_u32 v148, v148, 3, v149
    v_lshlrev_b32 v148, 7, v148
    v_add_u32 v148, s84, v148
    v_and_b32 v149, 1, v1
    v_lshl_add_u32 v148, v149, 4, v148
    v_bfe_u32 v149, v1, 1, 1
    v_lshl_add_u32 v148, v149, 3, v148
    v_bfe_u32 v149, v1, 3, 2
    s_waitcnt vmcnt(13)
    v_xor_b32 v150, 0, v149
    v_lshl_add_u32 v151, v150, 5, v148
    ds_read_b64_tr_b16 v[156:157], v151
    ds_read_b64_tr_b16 v[158:159], v151 offset:512
    v_xor_b32 v150, 1, v149
    v_lshl_add_u32 v152, v150, 5, v148
    ds_read_b64_tr_b16 v[160:161], v152
    ds_read_b64_tr_b16 v[162:163], v152 offset:512
    v_xor_b32 v150, 2, v149
    v_lshl_add_u32 v153, v150, 5, v148
    ds_read_b64_tr_b16 v[164:165], v153
    ds_read_b64_tr_b16 v[166:167], v153 offset:512
    v_xor_b32 v150, 3, v149
    v_lshl_add_u32 v154, v150, 5, v148
    ds_read_b64_tr_b16 v[168:169], v154
    ds_read_b64_tr_b16 v[170:171], v154 offset:512
    s_lshl_b32 s76, s78, 2
    s_add_u32 s76, s76, 0
    s_mul_i32 s77, s76, 57
    s_lshr_b32 s77, s77, 9
    s_mul_i32 s79, s77, 9
    s_sub_u32 s76, s76, s79
    s_mul_i32 s77, s77, 144
    s_add_u32 s77, s77, s81
    s_mul_i32 s77, s77, 9
    s_add_u32 s77, s77, s76
    s_lshl_b32 s77, s77, 10
    s_add_u32 s77, s77, 13418496
    s_waitcnt lgkmcnt(6)
    buffer_store_dwordx4 v[156:159], v2, s[8:11], s77 offen sc1
    s_lshl_b32 s76, s78, 2
    s_add_u32 s76, s76, 1
    s_mul_i32 s77, s76, 57
    s_lshr_b32 s77, s77, 9
    s_mul_i32 s79, s77, 9
    s_sub_u32 s76, s76, s79
    s_mul_i32 s77, s77, 144
    s_add_u32 s77, s77, s81
    s_mul_i32 s77, s77, 9
    s_add_u32 s77, s77, s76
    s_lshl_b32 s77, s77, 10
    s_add_u32 s77, s77, 13418496
    s_waitcnt lgkmcnt(4)
    buffer_store_dwordx4 v[160:163], v2, s[8:11], s77 offen sc1
    s_lshl_b32 s76, s78, 2
    s_add_u32 s76, s76, 2
    s_mul_i32 s77, s76, 57
    s_lshr_b32 s77, s77, 9
    s_mul_i32 s79, s77, 9
    s_sub_u32 s76, s76, s79
    s_mul_i32 s77, s77, 144
    s_add_u32 s77, s77, s81
    s_mul_i32 s77, s77, 9
    s_add_u32 s77, s77, s76
    s_lshl_b32 s77, s77, 10
    s_add_u32 s77, s77, 13418496
    s_waitcnt lgkmcnt(2)
    buffer_store_dwordx4 v[164:167], v2, s[8:11], s77 offen sc1
    s_lshl_b32 s76, s78, 2
    s_add_u32 s76, s76, 3
    s_mul_i32 s77, s76, 57
    s_lshr_b32 s77, s77, 9
    s_mul_i32 s79, s77, 9
    s_sub_u32 s76, s76, s79
    s_mul_i32 s77, s77, 144
    s_add_u32 s77, s77, s81
    s_mul_i32 s77, s77, 9
    s_add_u32 s77, s77, s76
    s_lshl_b32 s77, s77, 10
    s_add_u32 s77, s77, 13418496
    s_waitcnt lgkmcnt(0)
    buffer_store_dwordx4 v[168:171], v2, s[8:11], s77 offen sc1
SK_mk_13:
    s_lshr_b32 s80, s6, 1
    s_and_b32 s81, s6, 1
    s_lshl_b32 s81, s81, 3
    s_and_b32 s82, s7, 7
    s_add_u32 s81, s81, s82
    s_lshr_b32 s82, s7, 3
    s_lshl_b32 s83, s81, 3
    s_lshl_b32 s84, s3, 1
    s_add_u32 s83, s83, s84
    s_and_b32 s87, s83, 65532
    s_add_u32 s87, s87, s80
    s_add_u32 s87, s87, 1424
    s_lshl_b32 s87, s87, 7
    s_mul_i32 s81, s83, 147456
    s_mul_i32 s82, s80, 36864
    s_add_u32 s81, s81, s82
    s_add_u32 s81, s81, 9424896
    s_add_u32 s76, s58, s81
    s_addc_u32 s77, s59, 0
    s_mov_b32 s78, 184320
    s_mov_b32 s79, 0x20000
    v_add_u32 v4, 147456, v2
    v_mov_b32 v6, 0
    ds_read_b128 v[96:99], v10 offset:0
    ds_read_b128 v[100:103], v10 offset:2048
    ds_read_b128 v[104:107], v10 offset:4096
    v_fma_f32 v64, -v16, v120, v32
    v_fma_f32 v65, -v16, v121, v33
    v_fma_f32 v66, -v16, v122, v34
    v_fma_f32 v67, -v16, v123, v35
    v_fma_f32 v68, -v17, v120, v36
    v_fma_f32 v69, -v17, v121, v37
    v_fma_f32 v70, -v17, v122, v38
    v_fma_f32 v71, -v17, v123, v39
    v_fma_f32 v72, -v18, v120, v40
    v_fma_f32 v73, -v18, v121, v41
    v_fma_f32 v74, -v18, v122, v42
    v_fma_f32 v75, -v18, v123, v43
    v_fma_f32 v76, -v19, v120, v44
    v_fma_f32 v77, -v19, v121, v45
    v_fma_f32 v78, -v19, v122, v46
    v_fma_f32 v79, -v19, v123, v47
    s_waitcnt lgkmcnt(0)
    s_mov_b32 s37, 5
.p2align 2
LP_mk_14:
    v_mfma_f32_16x16x32_bf16 v[32:35], v[96:99], a[0:3], 0
    ds_read_b128 v[108:111], v10 offset:1024
    v_fma_f32 v80, -v16, v124, v48
    v_mfma_f32_16x16x32_bf16 v[32:35], v[100:103], a[16:19], v[32:35]
    v_fma_f32 v81, -v16, v125, v49
    v_fma_f32 v82, -v16, v126, v50
    v_mfma_f32_16x16x32_bf16 v[32:35], v[104:107], a[32:35], v[32:35]
    ds_read_b128 v[112:115], v10 offset:3072
    v_fma_f32 v83, -v16, v127, v51
    v_mfma_f32_16x16x32_bf16 v[36:39], v[104:107], a[36:39], 0
    v_fma_f32 v84, -v17, v124, v52
    v_fma_f32 v85, -v17, v125, v53
    v_mfma_f32_16x16x32_bf16 v[36:39], v[100:103], a[20:23], v[36:39]
    ds_read_b128 v[116:119], v10 offset:5120
    v_fma_f32 v86, -v17, v126, v54
    v_mfma_f32_16x16x32_bf16 v[36:39], v[96:99], a[4:7], v[36:39]
    v_fma_f32 v87, -v17, v127, v55
    v_fma_f32 v88, -v18, v124, v56
    v_mfma_f32_16x16x32_bf16 v[40:43], v[96:99], a[8:11], 0
    v_fma_f32 v89, -v18, v125, v57
    v_fma_f32 v90, -v18, v126, v58
    v_mfma_f32_16x16x32_bf16 v[40:43], v[100:103], a[24:27], v[40:43]
    v_fma_f32 v91, -v18, v127, v59
    v_fma_f32 v92, -v19, v124, v60
    v_mfma_f32_16x16x32_bf16 v[40:43], v[104:107], a[40:43], v[40:43]
    v_fma_f32 v93, -v19, v125, v61
    v_fma_f32 v94, -v19, v126, v62
    v_mfma_f32_16x16x32_bf16 v[44:47], v[104:107], a[44:47], 0
    v_fma_f32 v95, -v19, v127, v63
    v_mfma_f32_16x16x32_bf16 v[44:47], v[100:103], a[28:31], v[44:47]
    v_mfma_f32_16x16x32_bf16 v[44:47], v[96:99], a[12:15], v[44:47]
    s_waitcnt lgkmcnt(0)
    v_mul_f32 v128, v64, v64
    v_mul_f32 v129, v65, v65
    v_mfma_f32_16x16x32_bf16 v[48:51], v[108:111], a[0:3], 0
    ds_read_b128 v[96:99], v10 offset:6144
    buffer_load_dwordx4 v[120:123], v12, s[52:55], s33 offen sc1
    v_mfma_f32_16x16x32_bf16 v[48:51], v[112:115], a[16:19], v[48:51]
    buffer_load_dwordx4 v[124:127], v12, s[52:55], s33 offen offset:64 sc1
    v_fma_f32 v128, v128, v24, v20
    v_mfma_f32_16x16x32_bf16 v[48:51], v[116:119], a[32:35], v[48:51]
    s_add_u32 s33, s33, 128
    ds_read_b128 v[100:103], v10 offset:8192
    v_mul_f32 v128, v128, v64
    v_mfma_f32_16x16x32_bf16 v[52:55], v[116:119], a[36:39], 0
    v_exp_f32 v128, v128
    v_mfma_f32_16x16x32_bf16 v[52:55], v[112:115], a[20:23], v[52:55]
    ds_read_b128 v[104:107], v10 offset:10240
    v_mul_f32 v80, v64, v80
    v_mfma_f32_16x16x32_bf16 v[52:55], v[108:111], a[4:7], v[52:55]
    v_fma_f32 v128, v128, v28, v28
    v_fma_f32 v129, v129, v24, v20
    v_mfma_f32_16x16x32_bf16 v[56:59], v[108:111], a[8:11], 0
    s_add_u32 m0, s28, 0
    v_rcp_f32 v128, v128
    v_mfma_f32_16x16x32_bf16 v[56:59], v[112:115], a[24:27], v[56:59]
    v_mul_f32 v80, v80, v128
    v_mul_f32 v129, v129, v65
    v_mfma_f32_16x16x32_bf16 v[56:59], v[116:119], a[40:43], v[56:59]
    v_exp_f32 v129, v129
    v_mfma_f32_16x16x32_bf16 v[60:63], v[116:119], a[44:47], 0
    s_add_u32 s29, s27, 0
    v_mul_f32 v81, v65, v81
    v_mul_f32 v130, v66, v66
    v_mfma_f32_16x16x32_bf16 v[60:63], v[112:115], a[28:31], v[60:63]
    v_fma_f32 v129, v129, v28, v28
    v_fma_f32 v130, v130, v24, v20
    v_mfma_f32_16x16x32_bf16 v[60:63], v[108:111], a[12:15], v[60:63]
    s_waitcnt lgkmcnt(0)
    v_rcp_f32 v129, v129
    v_mfma_f32_16x16x32_bf16 v[32:35], v[96:99], a[48:51], v[32:35]
    ds_read_b128 v[108:111], v10 offset:7168
    buffer_load_dwordx4 v2, s[8:11], s29 offen offset:0 lds
    v_mfma_f32_16x16x32_bf16 v[32:35], v[100:103], a[64:67], v[32:35]
    v_mul_f32 v81, v81, v129
    v_mul_f32 v130, v130, v66
    v_mfma_f32_16x16x32_bf16 v[32:35], v[104:107], a[80:83], v[32:35]
    ds_read_b128 v[112:115], v10 offset:9216
    v_cvt_pk_bf16_f32 v140, v80, v81
    v_mfma_f32_16x16x32_bf16 v[36:39], v[104:107], a[84:87], v[36:39]
    v_exp_f32 v130, v130
    v_mfma_f32_16x16x32_bf16 v[36:39], v[100:103], a[68:71], v[36:39]
    ds_read_b128 v[116:119], v10 offset:11264
    buffer_load_dwordx4 v2, s[8:11], s29 offen offset:1024 lds
    v_mfma_f32_16x16x32_bf16 v[36:39], v[96:99], a[52:55], v[36:39]
    v_mul_f32 v82, v66, v82
    v_mul_f32 v131, v67, v67
    v_mfma_f32_16x16x32_bf16 v[40:43], v[96:99], a[56:59], v[40:43]
    v_fma_f32 v130, v130, v28, v28
    v_fma_f32 v131, v131, v24, v20
    v_mfma_f32_16x16x32_bf16 v[40:43], v[100:103], a[72:75], v[40:43]
    buffer_load_dwordx4 v2, s[8:11], s29 offen offset:2048 lds
    v_mul_f32 v131, v131, v67
    v_mfma_f32_16x16x32_bf16 v[40:43], v[104:107], a[88:91], v[40:43]
    v_rcp_f32 v130, v130
    v_mfma_f32_16x16x32_bf16 v[44:47], v[104:107], a[92:95], v[44:47]
    v_exp_f32 v131, v131
    v_mfma_f32_16x16x32_bf16 v[44:47], v[100:103], a[76:79], v[44:47]
    v_mul_f32 v82, v82, v130
    v_mul_f32 v83, v67, v83
    v_mfma_f32_16x16x32_bf16 v[44:47], v[96:99], a[60:63], v[44:47]
    s_waitcnt lgkmcnt(0)
    buffer_load_dwordx4 v2, s[8:11], s29 offen offset:3072 lds
    v_fma_f32 v131, v131, v28, v28
    v_mfma_f32_16x16x32_bf16 v[48:51], v[108:111], a[48:51], v[48:51]
    ds_read_b128 v[96:99], v10 offset:12288
    v_mul_f32 v128, v68, v68
    v_mfma_f32_16x16x32_bf16 v[48:51], v[112:115], a[64:67], v[48:51]
    v_rcp_f32 v131, v131
    v_mfma_f32_16x16x32_bf16 v[48:51], v[116:119], a[80:83], v[48:51]
    s_add_u32 m0, s28, 4096
    ds_read_b128 v[100:103], v10 offset:14336
    v_mul_f32 v83, v83, v131
    v_mfma_f32_16x16x32_bf16 v[52:55], v[116:119], a[84:87], v[52:55]
    v_cvt_pk_bf16_f32 v141, v82, v83
    v_fma_f32 v128, v128, v25, v21
    v_mfma_f32_16x16x32_bf16 v[52:55], v[112:115], a[68:71], v[52:55]
    ds_read_b128 v[104:107], v10 offset:16384
    v_mul_f32 v128, v128, v68
    v_mfma_f32_16x16x32_bf16 v[52:55], v[108:111], a[52:55], v[52:55]
    v_exp_f32 v128, v128
    v_mfma_f32_16x16x32_bf16 v[56:59], v[108:111], a[56:59], v[56:59]
    s_add_u32 s29, s27, 4096
    v_mul_f32 v84, v68, v84
    v_mul_f32 v129, v69, v69
    v_mfma_f32_16x16x32_bf16 v[56:59], v[112:115], a[72:75], v[56:59]
    v_fma_f32 v128, v128, v29, v29
    v_fma_f32 v129, v129, v25, v21
    v_mfma_f32_16x16x32_bf16 v[56:59], v[116:119], a[88:91], v[56:59]
    v_rcp_f32 v128, v128
    v_mfma_f32_16x16x32_bf16 v[60:63], v[116:119], a[92:95], v[60:63]
    buffer_load_dwordx4 v2, s[8:11], s29 offen offset:0 lds
    v_mul_f32 v84, v84, v128
    v_mfma_f32_16x16x32_bf16 v[60:63], v[112:115], a[76:79], v[60:63]
    v_mul_f32 v129, v129, v69
    v_mul_f32 v130, v70, v70
    v_mfma_f32_16x16x32_bf16 v[60:63], v[108:111], a[60:63], v[60:63]
    s_waitcnt lgkmcnt(0)
    v_exp_f32 v129, v129
    v_mfma_f32_16x16x32_bf16 v[32:35], v[96:99], a[96:99], v[32:35]
    ds_read_b128 v[108:111], v10 offset:13312
    v_mul_f32 v85, v69, v85
    v_mfma_f32_16x16x32_bf16 v[32:35], v[100:103], a[112:115], v[32:35]
    buffer_load_dwordx4 v2, s[8:11], s29 offen offset:1024 lds
    v_fma_f32 v129, v129, v29, v29
    v_mfma_f32_16x16x32_bf16 v[32:35], v[104:107], a[128:131], v[32:35]
    ds_read_b128 v[112:115], v10 offset:15360
    v_fma_f32 v130, v130, v25, v21
    v_mfma_f32_16x16x32_bf16 v[36:39], v[104:107], a[132:135], v[36:39]
    v_rcp_f32 v129, v129
    v_mfma_f32_16x16x32_bf16 v[36:39], v[100:103], a[116:119], v[36:39]
    ds_read_b128 v[116:119], v10 offset:17408
    buffer_load_dwordx4 v2, s[8:11], s29 offen offset:2048 lds
    v_mfma_f32_16x16x32_bf16 v[36:39], v[96:99], a[100:103], v[36:39]
    v_mul_f32 v85, v85, v129
    v_mul_f32 v130, v130, v70
    v_mfma_f32_16x16x32_bf16 v[40:43], v[96:99], a[104:107], v[40:43]
    v_cvt_pk_bf16_f32 v142, v84, v85
    v_mul_f32 v131, v71, v71
    v_mfma_f32_16x16x32_bf16 v[40:43], v[100:103], a[120:123], v[40:43]
    v_exp_f32 v130, v130
    v_mfma_f32_16x16x32_bf16 v[40:43], v[104:107], a[136:139], v[40:43]
    s_xor_b32 s57, s37, 1
    buffer_load_dwordx4 v2, s[8:11], s29 offen offset:3072 lds
    v_mul_f32 v86, v70, v86
    v_mfma_f32_16x16x32_bf16 v[44:47], v[104:107], a[140:143], v[44:47]
    v_fma_f32 v130, v130, v29, v29
    v_fma_f32 v131, v131, v25, v21
    v_mfma_f32_16x16x32_bf16 v[44:47], v[100:103], a[124:127], v[44:47]
    v_rcp_f32 v130, v130
    v_mfma_f32_16x16x32_bf16 v[44:47], v[96:99], a[108:111], v[44:47]
    s_waitcnt lgkmcnt(0)
    v_mul_f32 v86, v86, v130
    v_mul_f32 v131, v131, v71
    v_mfma_f32_16x16x32_bf16 v[48:51], v[108:111], a[96:99], v[48:51]
    s_add_u32 m0, s28, 8192
    ds_read_b128 v[96:99], v10 offset:18432
    v_mul_f32 v128, v72, v72
    v_mfma_f32_16x16x32_bf16 v[48:51], v[112:115], a[112:115], v[48:51]
    s_sub_u32 s57, s57, 1
    v_exp_f32 v131, v131
    v_mfma_f32_16x16x32_bf16 v[48:51], v[116:119], a[128:131], v[48:51]
    s_lshr_b32 s57, s57, 31
    ds_read_b128 v[100:103], v10 offset:20480
    v_mul_f32 v87, v71, v87
    v_mfma_f32_16x16x32_bf16 v[52:55], v[116:119], a[132:135], v[52:55]
    s_add_u32 s29, s27, 8192
    v_fma_f32 v131, v131, v29, v29
    v_mul_f32 v129, v73, v73
    v_mfma_f32_16x16x32_bf16 v[52:55], v[112:115], a[116:119], v[52:55]
    ds_read_b128 v[104:107], v10 offset:22528
    v_fma_f32 v128, v128, v26, v22
    v_mfma_f32_16x16x32_bf16 v[52:55], v[108:111], a[100:103], v[52:55]
    s_xor_b32 s57, s57, 1
    v_rcp_f32 v131, v131
    v_mfma_f32_16x16x32_bf16 v[56:59], v[108:111], a[104:107], v[56:59]
    buffer_load_dwordx4 v2, s[8:11], s29 offen offset:0 lds
    v_mul_f32 v87, v87, v131
    v_mfma_f32_16x16x32_bf16 v[56:59], v[112:115], a[120:123], v[56:59]
    v_cvt_pk_bf16_f32 v143, v86, v87
    v_mul_f32 v128, v128, v72
    v_mfma_f32_16x16x32_bf16 v[56:59], v[116:119], a[136:139], v[56:59]
    v_exp_f32 v128, v128
    v_mfma_f32_16x16x32_bf16 v[60:63], v[116:119], a[140:143], v[60:63]
    s_lshl_b32 s57, s57, 30
    v_permlane32_swap_b32 v140, v142
    v_mfma_f32_16x16x32_bf16 v[60:63], v[112:115], a[124:127], v[60:63]
    s_add_u32 s27, s27, 36864
    v_permlane32_swap_b32 v141, v143
    v_mfma_f32_16x16x32_bf16 v[60:63], v[108:111], a[108:111], v[60:63]
    s_waitcnt lgkmcnt(0)
    buffer_store_dwordx4 v[140:143], v13, s[88:91], s34 offen sc1
    v_mul_f32 v88, v72, v88
    v_mfma_f32_16x16x32_bf16 v[32:35], v[96:99], a[144:147], v[32:35]
    s_or_b32 s86, s57, s85
    ds_read_b128 v[108:111], v10 offset:19456
    v_fma_f32 v128, v128, v30, v30
    v_mfma_f32_16x16x32_bf16 v[32:35], v[100:103], a[160:163], v[32:35]
    s_add_u32 s38, s38, 1
    v_rcp_f32 v128, v128
    v_mfma_f32_16x16x32_bf16 v[32:35], v[104:107], a[176:179], v[32:35]
    ds_read_b128 v[112:115], v10 offset:21504
    v_mul_f32 v88, v88, v128
    v_mfma_f32_16x16x32_bf16 v[36:39], v[104:107], a[180:183], v[36:39]
    s_or_b32 s57, s57, s40
    v_fma_f32 v129, v129, v26, v22
    v_mul_f32 v130, v74, v74
    v_mfma_f32_16x16x32_bf16 v[36:39], v[100:103], a[164:167], v[36:39]
    ds_read_b128 v[116:119], v10 offset:23552
    v_mul_f32 v129, v129, v73
    v_mfma_f32_16x16x32_bf16 v[36:39], v[96:99], a[148:151], v[36:39]
    s_and_b32 s38, s38, 3
    v_exp_f32 v129, v129
    v_mfma_f32_16x16x32_bf16 v[40:43], v[96:99], a[152:155], v[40:43]
    s_xor_b32 s84, s37, 3
    v_mul_f32 v89, v73, v89
    v_fma_f32 v130, v130, v26, v22
    v_mfma_f32_16x16x32_bf16 v[40:43], v[100:103], a[168:171], v[40:43]
    v_fma_f32 v129, v129, v30, v30
    v_mul_f32 v130, v130, v74
    v_mfma_f32_16x16x32_bf16 v[40:43], v[104:107], a[184:187], v[40:43]
    s_mul_i32 s28, s38, 36864
    v_rcp_f32 v129, v129
    v_mfma_f32_16x16x32_bf16 v[44:47], v[104:107], a[188:191], v[44:47]
    v_exp_f32 v130, v130
    v_mfma_f32_16x16x32_bf16 v[44:47], v[100:103], a[172:175], v[44:47]
    s_sub_u32 s84, s84, 1
    v_mul_f32 v89, v89, v129
    v_mfma_f32_16x16x32_bf16 v[44:47], v[96:99], a[156:159], v[44:47]
    s_waitcnt lgkmcnt(0)
    v_cvt_pk_bf16_f32 v144, v88, v89
    v_mfma_f32_16x16x32_bf16 v[48:51], v[108:111], a[144:147], v[48:51]
    s_add_u32 s28, s28, s26
    ds_read_b128 v[96:99], v10 offset:24576
    v_mul_f32 v90, v74, v90
    v_mfma_f32_16x16x32_bf16 v[48:51], v[112:115], a[160:163], v[48:51]
    s_ashr_i32 s84, s84, 31
    v_fma_f32 v130, v130, v30, v30
    v_mul_f32 v131, v75, v75
    v_mfma_f32_16x16x32_bf16 v[48:51], v[116:119], a[176:179], v[48:51]
    ds_read_b128 v[100:103], v10 offset:26624
    v_fma_f32 v131, v131, v26, v22
    v_mfma_f32_16x16x32_bf16 v[52:55], v[116:119], a[180:183], v[52:55]
    s_xor_b32 s56, s37, 2
    v_rcp_f32 v130, v130
    v_mfma_f32_16x16x32_bf16 v[52:55], v[112:115], a[164:167], v[52:55]
    s_and_b32 s84, s84, 3221325824
    ds_read_b128 v[104:107], v10 offset:28672
    v_mul_f32 v90, v90, v130
    v_mfma_f32_16x16x32_bf16 v[52:55], v[108:111], a[148:151], v[52:55]
    v_mul_f32 v131, v131, v75
    v_mul_f32 v128, v76, v76
    v_mfma_f32_16x16x32_bf16 v[56:59], v[108:111], a[152:155], v[56:59]
    v_exp_f32 v131, v131
    v_mfma_f32_16x16x32_bf16 v[56:59], v[112:115], a[168:171], v[56:59]
    s_sub_u32 s56, s56, 1
    v_mul_f32 v91, v75, v91
    v_mfma_f32_16x16x32_bf16 v[56:59], v[116:119], a[184:187], v[56:59]
    s_add_u32 s57, s57, s84
    v_fma_f32 v131, v131, v30, v30
    v_fma_f32 v128, v128, v27, v23
    v_mfma_f32_16x16x32_bf16 v[60:63], v[116:119], a[188:191], v[60:63]
    v_rcp_f32 v131, v131
    v_mfma_f32_16x16x32_bf16 v[60:63], v[112:115], a[172:175], v[60:63]
    s_ashr_i32 s56, s56, 31
    v_mul_f32 v91, v91, v131
    v_mfma_f32_16x16x32_bf16 v[60:63], v[108:111], a[156:159], v[60:63]
    s_waitcnt lgkmcnt(0)
    v_cvt_pk_bf16_f32 v145, v90, v91
    v_mul_f32 v128, v128, v76
    v_mfma_f32_16x16x32_bf16 v[32:35], v[96:99], a[192:195], v[32:35]
    ds_read_b128 v[108:111], v10 offset:25600
    v_mul_f32 v129, v77, v77
    v_mfma_f32_16x16x32_bf16 v[32:35], v[100:103], a[208:211], v[32:35]
    v_exp_f32 v128, v128
    v_mfma_f32_16x16x32_bf16 v[32:35], v[104:107], a[224:227], v[32:35]
    s_and_b32 s56, s56, s36
    ds_read_b128 v[112:115], v10 offset:27648
    v_mul_f32 v92, v76, v92
    v_mfma_f32_16x16x32_bf16 v[36:39], v[104:107], a[228:231], v[36:39]
    s_waitcnt vmcnt(12)
    buffer_atomic_add v15, v11, s[96:99], s57 offen
    v_fma_f32 v128, v128, v31, v31
    v_mfma_f32_16x16x32_bf16 v[36:39], v[100:103], a[212:215], v[36:39]
    ds_read_b128 v[116:119], v10 offset:29696
    buffer_atomic_add v15, v11, s[96:99], s86 offen
    v_mfma_f32_16x16x32_bf16 v[36:39], v[96:99], a[196:199], v[36:39]
    s_add_u32 s27, s27, s56
    v_rcp_f32 v128, v128
    v_mfma_f32_16x16x32_bf16 v[40:43], v[96:99], a[200:203], v[40:43]
    v_mul_f32 v92, v92, v128
    v_fma_f32 v129, v129, v27, v23
    v_mfma_f32_16x16x32_bf16 v[40:43], v[100:103], a[216:219], v[40:43]
    v_mul_f32 v129, v129, v77
    v_mul_f32 v130, v78, v78
    v_mfma_f32_16x16x32_bf16 v[40:43], v[104:107], a[232:235], v[40:43]
    v_exp_f32 v129, v129
    v_mfma_f32_16x16x32_bf16 v[44:47], v[104:107], a[236:239], v[44:47]
    v_mul_f32 v93, v77, v93
    v_fma_f32 v130, v130, v27, v23
    v_mfma_f32_16x16x32_bf16 v[44:47], v[100:103], a[220:223], v[44:47]
    v_fma_f32 v129, v129, v31, v31
    v_mfma_f32_16x16x32_bf16 v[44:47], v[96:99], a[204:207], v[44:47]
    s_waitcnt lgkmcnt(0)
    v_rcp_f32 v129, v129
    v_mfma_f32_16x16x32_bf16 v[48:51], v[108:111], a[192:195], v[48:51]
    s_add_u32 s39, s39, 1
    ds_read_b128 v[96:99], v10 offset:30720
    v_mul_f32 v93, v93, v129
    v_mfma_f32_16x16x32_bf16 v[48:51], v[112:115], a[208:211], v[48:51]
    s_and_b32 s39, s39, 3
    v_cvt_pk_bf16_f32 v146, v92, v93
    v_mul_f32 v130, v130, v78
    v_mfma_f32_16x16x32_bf16 v[48:51], v[116:119], a[224:227], v[48:51]
    s_mul_i32 s32, s39, 36864
    ds_read_b128 v[100:103], v10 offset:32768
    v_mul_f32 v131, v79, v79
    v_mfma_f32_16x16x32_bf16 v[52:55], v[116:119], a[228:231], v[52:55]
    v_exp_f32 v130, v130
    v_mfma_f32_16x16x32_bf16 v[52:55], v[112:115], a[212:215], v[52:55]
    ds_read_b128 v[104:107], v10 offset:34816
    v_mul_f32 v94, v78, v94
    v_mfma_f32_16x16x32_bf16 v[52:55], v[108:111], a[196:199], v[52:55]
    v_fma_f32 v130, v130, v31, v31
    v_fma_f32 v131, v131, v27, v23
    v_mfma_f32_16x16x32_bf16 v[56:59], v[108:111], a[200:203], v[56:59]
    v_rcp_f32 v130, v130
    v_mfma_f32_16x16x32_bf16 v[56:59], v[112:115], a[216:219], v[56:59]
    v_mul_f32 v94, v94, v130
    v_mfma_f32_16x16x32_bf16 v[56:59], v[116:119], a[232:235], v[56:59]
    v_mul_f32 v131, v131, v79
    v_mfma_f32_16x16x32_bf16 v[60:63], v[116:119], a[236:239], v[60:63]
    v_exp_f32 v131, v131
    v_mfma_f32_16x16x32_bf16 v[60:63], v[112:115], a[220:223], v[60:63]
    v_mul_f32 v95, v79, v95
    v_mfma_f32_16x16x32_bf16 v[60:63], v[108:111], a[204:207], v[60:63]
    s_waitcnt lgkmcnt(0)
    v_fma_f32 v131, v131, v31, v31
    v_mfma_f32_16x16x32_bf16 v[32:35], v[96:99], a[240:243], v[32:35]
    ds_read_b128 v[108:111], v10 offset:31744
    v_mfma_f32_16x16x32_bf16 v[32:35], v[100:103], v[224:227], v[32:35]
    v_rcp_f32 v131, v131
    v_mfma_f32_16x16x32_bf16 v[32:35], v[104:107], v[240:243], v[32:35]
    ds_read_b128 v[112:115], v10 offset:33792
    v_mul_f32 v95, v95, v131
    v_mfma_f32_16x16x32_bf16 v[36:39], v[104:107], v[244:247], v[36:39]
    v_cvt_pk_bf16_f32 v147, v94, v95
    v_mfma_f32_16x16x32_bf16 v[36:39], v[100:103], v[228:231], v[36:39]
    ds_read_b128 v[116:119], v10 offset:35840
    v_add_u32 v10, s32, v2
    v_mfma_f32_16x16x32_bf16 v[36:39], v[96:99], a[244:247], v[36:39]
    v_permlane32_swap_b32 v144, v146
    v_mfma_f32_16x16x32_bf16 v[40:43], v[96:99], a[248:251], v[40:43]
    s_barrier
    v_permlane32_swap_b32 v145, v147
    v_mfma_f32_16x16x32_bf16 v[40:43], v[100:103], v[232:235], v[40:43]
    buffer_store_dwordx4 v[144:147], v13, s[88:91], s35 offen sc1
    v_mfma_f32_16x16x32_bf16 v[40:43], v[104:107], v[248:251], v[40:43]
    v_mfma_f32_16x16x32_bf16 v[44:47], v[104:107], v[252:255], v[44:47]
    v_mfma_f32_16x16x32_bf16 v[44:47], v[100:103], v[236:239], v[44:47]
    s_waitcnt vmcnt(13)
    v_mfma_f32_16x16x32_bf16 v[44:47], v[96:99], a[252:255], v[44:47]
    s_waitcnt lgkmcnt(0)
    v_mfma_f32_16x16x32_bf16 v[48:51], v[108:111], a[240:243], v[48:51]
    s_add_u32 s34, s34, s41
    ds_read_b128 v[96:99], v10 offset:0
    v_mfma_f32_16x16x32_bf16 v[48:51], v[112:115], v[224:227], v[48:51]
    s_add_u32 s35, s35, s41
    v_fma_f32 v64, -v16, v120, v32
    v_fma_f32 v65, -v16, v121, v33
    v_mfma_f32_16x16x32_bf16 v[48:51], v[116:119], v[240:243], v[48:51]
    s_sub_u32 s37, s37, 1
    ds_read_b128 v[100:103], v10 offset:2048
    v_fma_f32 v66, -v16, v122, v34
    v_mfma_f32_16x16x32_bf16 v[52:55], v[116:119], v[244:247], v[52:55]
    s_cmp_lg_u32 s37, 0
    v_fma_f32 v67, -v16, v123, v35
    v_fma_f32 v68, -v17, v120, v36
    v_mfma_f32_16x16x32_bf16 v[52:55], v[112:115], v[228:231], v[52:55]
    ds_read_b128 v[104:107], v10 offset:4096
    v_fma_f32 v69, -v17, v121, v37
    v_mfma_f32_16x16x32_bf16 v[52:55], v[108:111], a[244:247], v[52:55]
    v_fma_f32 v70, -v17, v122, v38
    v_fma_f32 v71, -v17, v123, v39
    v_mfma_f32_16x16x32_bf16 v[56:59], v[108:111], a[248:251], v[56:59]
    v_fma_f32 v72, -v18, v120, v40
    v_fma_f32 v73, -v18, v121, v41
    v_mfma_f32_16x16x32_bf16 v[56:59], v[112:115], v[232:235], v[56:59]
    v_fma_f32 v74, -v18, v122, v42
    v_fma_f32 v75, -v18, v123, v43
    v_mfma_f32_16x16x32_bf16 v[56:59], v[116:119], v[248:251], v[56:59]
    v_fma_f32 v76, -v19, v120, v44
    v_fma_f32 v77, -v19, v121, v45
    v_mfma_f32_16x16x32_bf16 v[60:63], v[116:119], v[252:255], v[60:63]
    v_fma_f32 v78, -v19, v122, v46
    v_fma_f32 v79, -v19, v123, v47
    v_mfma_f32_16x16x32_bf16 v[60:63], v[112:115], v[236:239], v[60:63]
    v_mfma_f32_16x16x32_bf16 v[60:63], v[108:111], a[252:255], v[60:63]
    s_waitcnt lgkmcnt(0)
    s_cbranch_scc1 LP_mk_14
    v_mfma_f32_16x16x32_bf16 v[32:35], v[96:99], a[0:3], 0
    ds_read_b128 v[108:111], v10 offset:1024
    v_fma_f32 v80, -v16, v124, v48
    v_mfma_f32_16x16x32_bf16 v[32:35], v[100:103], a[16:19], v[32:35]
    v_fma_f32 v81, -v16, v125, v49
    v_fma_f32 v82, -v16, v126, v50
    v_mfma_f32_16x16x32_bf16 v[32:35], v[104:107], a[32:35], v[32:35]
    ds_read_b128 v[112:115], v10 offset:3072
    v_fma_f32 v83, -v16, v127, v51
    v_mfma_f32_16x16x32_bf16 v[36:39], v[104:107], a[36:39], 0
    v_fma_f32 v84, -v17, v124, v52
    v_fma_f32 v85, -v17, v125, v53
    v_mfma_f32_16x16x32_bf16 v[36:39], v[100:103], a[20:23], v[36:39]
    ds_read_b128 v[116:119], v10 offset:5120
    v_fma_f32 v86, -v17, v126, v54
    v_mfma_f32_16x16x32_bf16 v[36:39], v[96:99], a[4:7], v[36:39]
    v_fma_f32 v87, -v17, v127, v55
    v_fma_f32 v88, -v18, v124, v56
    v_mfma_f32_16x16x32_bf16 v[40:43], v[96:99], a[8:11], 0
    v_fma_f32 v89, -v18, v125, v57
    v_fma_f32 v90, -v18, v126, v58
    v_mfma_f32_16x16x32_bf16 v[40:43], v[100:103], a[24:27], v[40:43]
    v_fma_f32 v91, -v18, v127, v59
    v_fma_f32 v92, -v19, v124, v60
    v_mfma_f32_16x16x32_bf16 v[40:43], v[104:107], a[40:43], v[40:43]
    v_fma_f32 v93, -v19, v125, v61
    v_fma_f32 v94, -v19, v126, v62
    v_mfma_f32_16x16x32_bf16 v[44:47], v[104:107], a[44:47], 0
    buffer_load_dword v5, v6, s[96:99], s87 offen sc1
    v_fma_f32 v95, -v19, v127, v63
    v_mfma_f32_16x16x32_bf16 v[44:47], v[100:103], a[28:31], v[44:47]
    v_mfma_f32_16x16x32_bf16 v[44:47], v[96:99], a[12:15], v[44:47]
    s_waitcnt lgkmcnt(0)
    v_mul_f32 v128, v64, v64
    v_mul_f32 v129, v65, v65
    v_mfma_f32_16x16x32_bf16 v[48:51], v[108:111], a[0:3], 0
    ds_read_b128 v[96:99], v10 offset:6144
    buffer_load_dwordx4 v[120:123], v12, s[52:55], s33 offen sc1
    v_mfma_f32_16x16x32_bf16 v[48:51], v[112:115], a[16:19], v[48:51]
    buffer_load_dwordx4 v[124:127], v12, s[52:55], s33 offen offset:64 sc1
    v_fma_f32 v128, v128, v24, v20
    v_mfma_f32_16x16x32_bf16 v[48:51], v[116:119], a[32:35], v[48:51]
    s_add_u32 s33, s33, 128
    ds_read_b128 v[100:103], v10 offset:8192
    v_mul_f32 v128, v128, v64
    v_mfma_f32_16x16x32_bf16 v[52:55], v[116:119], a[36:39], 0
    v_exp_f32 v128, v128
    v_mfma_f32_16x16x32_bf16 v[52:55], v[112:115], a[20:23], v[52:55]
    ds_read_b128 v[104:107], v10 offset:10240
    v_mul_f32 v80, v64, v80
    v_mfma_f32_16x16x32_bf16 v[52:55], v[108:111], a[4:7], v[52:55]
    v_fma_f32 v128, v128, v28, v28
    v_fma_f32 v129, v129, v24, v20
    v_mfma_f32_16x16x32_bf16 v[56:59], v[108:111], a[8:11], 0
    s_add_u32 m0, s28, 0
    v_rcp_f32 v128, v128
    v_mfma_f32_16x16x32_bf16 v[56:59], v[112:115], a[24:27], v[56:59]
    v_mul_f32 v80, v80, v128
    v_mul_f32 v129, v129, v65
    v_mfma_f32_16x16x32_bf16 v[56:59], v[116:119], a[40:43], v[56:59]
    s_add_u32 s29, s27, 0
    v_exp_f32 v129, v129
    v_mfma_f32_16x16x32_bf16 v[60:63], v[116:119], a[44:47], 0
    v_mul_f32 v81, v65, v81
    v_mul_f32 v130, v66, v66
    v_mfma_f32_16x16x32_bf16 v[60:63], v[112:115], a[28:31], v[60:63]
    buffer_load_dwordx4 v2, s[8:11], s29 offen offset:0 lds
    v_fma_f32 v129, v129, v28, v28
    v_mfma_f32_16x16x32_bf16 v[60:63], v[108:111], a[12:15], v[60:63]
    s_waitcnt lgkmcnt(0)
    v_rcp_f32 v129, v129
    v_mfma_f32_16x16x32_bf16 v[32:35], v[96:99], a[48:51], v[32:35]
    ds_read_b128 v[108:111], v10 offset:7168
    v_mul_f32 v81, v81, v129
    v_mfma_f32_16x16x32_bf16 v[32:35], v[100:103], a[64:67], v[32:35]
    buffer_load_dwordx4 v2, s[8:11], s29 offen offset:1024 lds
    v_cvt_pk_bf16_f32 v140, v80, v81
    v_mfma_f32_16x16x32_bf16 v[32:35], v[104:107], a[80:83], v[32:35]
    ds_read_b128 v[112:115], v10 offset:9216
    v_fma_f32 v130, v130, v24, v20
    v_mfma_f32_16x16x32_bf16 v[36:39], v[104:107], a[84:87], v[36:39]
    buffer_load_dwordx4 v2, s[8:11], s29 offen offset:2048 lds
    v_mul_f32 v130, v130, v66
    v_mfma_f32_16x16x32_bf16 v[36:39], v[100:103], a[68:71], v[36:39]
    ds_read_b128 v[116:119], v10 offset:11264
    v_mul_f32 v131, v67, v67
    v_mfma_f32_16x16x32_bf16 v[36:39], v[96:99], a[52:55], v[36:39]
    v_exp_f32 v130, v130
    v_mfma_f32_16x16x32_bf16 v[40:43], v[96:99], a[56:59], v[40:43]
    buffer_load_dwordx4 v2, s[8:11], s29 offen offset:3072 lds
    v_mul_f32 v82, v66, v82
    v_mfma_f32_16x16x32_bf16 v[40:43], v[100:103], a[72:75], v[40:43]
    v_fma_f32 v130, v130, v28, v28
    v_fma_f32 v131, v131, v24, v20
    v_mfma_f32_16x16x32_bf16 v[40:43], v[104:107], a[88:91], v[40:43]
    s_add_u32 m0, s28, 4096
    v_rcp_f32 v130, v130
    v_mfma_f32_16x16x32_bf16 v[44:47], v[104:107], a[92:95], v[44:47]
    v_mul_f32 v82, v82, v130
    v_mul_f32 v131, v131, v67
    v_mfma_f32_16x16x32_bf16 v[44:47], v[100:103], a[76:79], v[44:47]
    v_exp_f32 v131, v131
    v_mfma_f32_16x16x32_bf16 v[44:47], v[96:99], a[60:63], v[44:47]
    s_waitcnt lgkmcnt(0)
    v_mul_f32 v83, v67, v83
    v_mfma_f32_16x16x32_bf16 v[48:51], v[108:111], a[48:51], v[48:51]
    s_add_u32 s29, s27, 4096
    ds_read_b128 v[96:99], v10 offset:12288
    v_mul_f32 v128, v68, v68
    v_mfma_f32_16x16x32_bf16 v[48:51], v[112:115], a[64:67], v[48:51]
    buffer_load_dwordx4 v2, s[8:11], s29 offen offset:0 lds
    v_fma_f32 v131, v131, v28, v28
    v_mfma_f32_16x16x32_bf16 v[48:51], v[116:119], a[80:83], v[48:51]
    ds_read_b128 v[100:103], v10 offset:14336
    v_fma_f32 v128, v128, v25, v21
    v_mfma_f32_16x16x32_bf16 v[52:55], v[116:119], a[84:87], v[52:55]
    v_rcp_f32 v131, v131
    v_mfma_f32_16x16x32_bf16 v[52:55], v[112:115], a[68:71], v[52:55]
    ds_read_b128 v[104:107], v10 offset:16384
    buffer_load_dwordx4 v2, s[8:11], s29 offen offset:1024 lds
    v_mfma_f32_16x16x32_bf16 v[52:55], v[108:111], a[52:55], v[52:55]
    v_mul_f32 v83, v83, v131
    v_mul_f32 v128, v128, v68
    v_mfma_f32_16x16x32_bf16 v[56:59], v[108:111], a[56:59], v[56:59]
    buffer_load_dwordx4 v2, s[8:11], s29 offen offset:2048 lds
    v_cvt_pk_bf16_f32 v141, v82, v83
    v_mfma_f32_16x16x32_bf16 v[56:59], v[112:115], a[72:75], v[56:59]
    v_exp_f32 v128, v128
    v_mfma_f32_16x16x32_bf16 v[56:59], v[116:119], a[88:91], v[56:59]
    buffer_load_dwordx4 v2, s[8:11], s29 offen offset:3072 lds
    v_mul_f32 v84, v68, v84
    v_mfma_f32_16x16x32_bf16 v[60:63], v[116:119], a[92:95], v[60:63]
    v_fma_f32 v128, v128, v29, v29
    v_mul_f32 v129, v69, v69
    v_mfma_f32_16x16x32_bf16 v[60:63], v[112:115], a[76:79], v[60:63]
    v_rcp_f32 v128, v128
    v_mfma_f32_16x16x32_bf16 v[60:63], v[108:111], a[60:63], v[60:63]
    s_waitcnt lgkmcnt(0)
    v_mul_f32 v84, v84, v128
    v_mfma_f32_16x16x32_bf16 v[32:35], v[96:99], a[96:99], v[32:35]
    s_add_u32 m0, s28, 8192
    ds_read_b128 v[108:111], v10 offset:13312
    v_mul_f32 v130, v70, v70
    v_mfma_f32_16x16x32_bf16 v[32:35], v[100:103], a[112:115], v[32:35]
    s_add_u32 s29, s27, 8192
    v_fma_f32 v129, v129, v25, v21
    v_mul_f32 v131, v71, v71
    v_mfma_f32_16x16x32_bf16 v[32:35], v[104:107], a[128:131], v[32:35]
    ds_read_b128 v[112:115], v10 offset:15360
    v_mul_f32 v129, v129, v69
    v_mfma_f32_16x16x32_bf16 v[36:39], v[104:107], a[132:135], v[36:39]
    v_exp_f32 v129, v129
    v_mfma_f32_16x16x32_bf16 v[36:39], v[100:103], a[116:119], v[36:39]
    ds_read_b128 v[116:119], v10 offset:17408
    buffer_load_dwordx4 v2, s[8:11], s29 offen offset:0 lds
    v_mfma_f32_16x16x32_bf16 v[36:39], v[96:99], a[100:103], v[36:39]
    v_mul_f32 v85, v69, v85
    v_fma_f32 v130, v130, v25, v21
    v_mfma_f32_16x16x32_bf16 v[40:43], v[96:99], a[104:107], v[40:43]
    s_add_u32 s27, s27, 36864
    v_fma_f32 v129, v129, v29, v29
    v_mul_f32 v130, v130, v70
    v_mfma_f32_16x16x32_bf16 v[40:43], v[100:103], a[120:123], v[40:43]
    v_rcp_f32 v129, v129
    v_mfma_f32_16x16x32_bf16 v[40:43], v[104:107], a[136:139], v[40:43]
    v_exp_f32 v130, v130
    v_mfma_f32_16x16x32_bf16 v[44:47], v[104:107], a[140:143], v[44:47]
    s_add_u32 s38, s38, 1
    v_mfma_f32_16x16x32_bf16 v[44:47], v[100:103], a[124:127], v[44:47]
    v_mul_f32 v85, v85, v129
    v_mfma_f32_16x16x32_bf16 v[44:47], v[96:99], a[108:111], v[44:47]
    s_waitcnt lgkmcnt(0)
    v_cvt_pk_bf16_f32 v142, v84, v85
    v_mul_f32 v86, v70, v86
    v_mfma_f32_16x16x32_bf16 v[48:51], v[108:111], a[96:99], v[48:51]
    s_and_b32 s38, s38, 3
    ds_read_b128 v[96:99], v10 offset:18432
    v_fma_f32 v130, v130, v29, v29
    v_mfma_f32_16x16x32_bf16 v[48:51], v[112:115], a[112:115], v[48:51]
    v_rcp_f32 v130, v130
    v_mfma_f32_16x16x32_bf16 v[48:51], v[116:119], a[128:131], v[48:51]
    s_mul_i32 s28, s38, 36864
    ds_read_b128 v[100:103], v10 offset:20480
    v_mul_f32 v86, v86, v130
    v_mfma_f32_16x16x32_bf16 v[52:55], v[116:119], a[132:135], v[52:55]
    v_fma_f32 v131, v131, v25, v21
    v_mfma_f32_16x16x32_bf16 v[52:55], v[112:115], a[116:119], v[52:55]
    s_add_u32 s28, s28, s26
    ds_read_b128 v[104:107], v10 offset:22528
    v_mul_f32 v131, v131, v71
    v_mfma_f32_16x16x32_bf16 v[52:55], v[108:111], a[100:103], v[52:55]
    v_exp_f32 v131, v131
    v_mfma_f32_16x16x32_bf16 v[56:59], v[108:111], a[104:107], v[56:59]
    v_mul_f32 v87, v71, v87
    v_mfma_f32_16x16x32_bf16 v[56:59], v[112:115], a[120:123], v[56:59]
    v_fma_f32 v131, v131, v29, v29
    v_mul_f32 v128, v72, v72
    v_mfma_f32_16x16x32_bf16 v[56:59], v[116:119], a[136:139], v[56:59]
    v_rcp_f32 v131, v131
    v_mfma_f32_16x16x32_bf16 v[60:63], v[116:119], a[140:143], v[60:63]
    s_waitcnt vmcnt(11)
    v_cmp_gt_u32 vcc, 8, v5
    s_nop 0
    s_cbranch_vccz CHK_mk_15
    v_mov_b32 v212, 0
    s_mov_b64 exec, 1
    s_mov_b32 s61, 200000
POLL_tmp_16:
    buffer_load_dword v213, v212, s[96:99], s87 offen sc1
    s_waitcnt vmcnt(0)
    v_cmp_gt_u32 vcc, 8, v213
    s_nop 0
    s_cbranch_vccz PDONE_tmp_17
    s_sub_u32 s61, s61, 1
    s_cmp_lg_u32 s61, 0
    s_cbranch_scc1 POLL_tmp_16
PDONE_tmp_17:
    s_mov_b64 exec, -1
CHK_mk_15:
    v_mfma_f32_16x16x32_bf16 v[60:63], v[112:115], a[124:127], v[60:63]
    v_mul_f32 v87, v87, v131
    v_fma_f32 v128, v128, v26, v22
    v_mfma_f32_16x16x32_bf16 v[60:63], v[108:111], a[108:111], v[60:63]
    s_waitcnt lgkmcnt(0)
    buffer_load_dwordx4 v[148:151], v2, s[76:79], 0 offen offset:0 sc1
    v_cvt_pk_bf16_f32 v143, v86, v87
    v_mfma_f32_16x16x32_bf16 v[32:35], v[96:99], a[144:147], v[32:35]
    ds_read_b128 v[108:111], v10 offset:19456
    v_mul_f32 v128, v128, v72
    v_mfma_f32_16x16x32_bf16 v[32:35], v[100:103], a[160:163], v[32:35]
    v_permlane32_swap_b32 v140, v142
    v_mfma_f32_16x16x32_bf16 v[32:35], v[104:107], a[176:179], v[32:35]
    ds_read_b128 v[112:115], v10 offset:21504
    v_mul_f32 v129, v73, v73
    v_mfma_f32_16x16x32_bf16 v[36:39], v[104:107], a[180:183], v[36:39]
    buffer_load_dwordx4 v[152:155], v4, s[76:79], 0 offen offset:0 sc1
    v_fma_f32 v129, v129, v26, v22
    v_mfma_f32_16x16x32_bf16 v[36:39], v[100:103], a[164:167], v[36:39]
    ds_read_b128 v[116:119], v10 offset:23552
    v_mul_f32 v129, v129, v73
    v_mfma_f32_16x16x32_bf16 v[36:39], v[96:99], a[148:151], v[36:39]
    v_permlane32_swap_b32 v141, v143
    v_mfma_f32_16x16x32_bf16 v[40:43], v[96:99], a[152:155], v[40:43]
    buffer_store_dwordx4 v[140:143], v13, s[88:91], s34 offen sc1
    v_mul_f32 v130, v74, v74
    v_mfma_f32_16x16x32_bf16 v[40:43], v[100:103], a[168:171], v[40:43]
    buffer_load_dwordx4 v[156:159], v2, s[76:79], 0 offen offset:1024 sc1
    v_fma_f32 v130, v130, v26, v22
    v_mfma_f32_16x16x32_bf16 v[40:43], v[104:107], a[184:187], v[40:43]
    v_exp_f32 v128, v128
    v_mfma_f32_16x16x32_bf16 v[44:47], v[104:107], a[188:191], v[44:47]
    v_exp_f32 v129, v129
    v_mfma_f32_16x16x32_bf16 v[44:47], v[100:103], a[172:175], v[44:47]
    v_mul_f32 v88, v72, v88
    v_mfma_f32_16x16x32_bf16 v[44:47], v[96:99], a[156:159], v[44:47]
    s_waitcnt lgkmcnt(0)
    buffer_load_dwordx4 v[160:163], v4, s[76:79], 0 offen offset:1024 sc1
    v_fma_f32 v128, v128, v30, v30
    v_mfma_f32_16x16x32_bf16 v[48:51], v[108:111], a[144:147], v[48:51]
    ds_read_b128 v[96:99], v10 offset:24576
    v_mul_f32 v89, v73, v89
    v_mfma_f32_16x16x32_bf16 v[48:51], v[112:115], a[160:163], v[48:51]
    v_rcp_f32 v128, v128
    v_mfma_f32_16x16x32_bf16 v[48:51], v[116:119], a[176:179], v[48:51]
    ds_read_b128 v[100:103], v10 offset:26624
    v_mul_f32 v88, v88, v128
    v_mfma_f32_16x16x32_bf16 v[52:55], v[116:119], a[180:183], v[52:55]
    buffer_load_dwordx4 v[164:167], v2, s[76:79], 0 offen offset:2048 sc1
    v_fma_f32 v129, v129, v30, v30
    v_mfma_f32_16x16x32_bf16 v[52:55], v[112:115], a[164:167], v[52:55]
    ds_read_b128 v[104:107], v10 offset:28672
    v_mul_f32 v130, v130, v74
    v_mfma_f32_16x16x32_bf16 v[52:55], v[108:111], a[148:151], v[52:55]
    v_rcp_f32 v129, v129
    v_mfma_f32_16x16x32_bf16 v[56:59], v[108:111], a[152:155], v[56:59]
    v_exp_f32 v130, v130
    v_mfma_f32_16x16x32_bf16 v[56:59], v[112:115], a[168:171], v[56:59]
    v_mul_f32 v89, v89, v129
    v_mul_f32 v90, v74, v90
    v_mfma_f32_16x16x32_bf16 v[56:59], v[116:119], a[184:187], v[56:59]
    buffer_load_dwordx4 v[168:171], v4, s[76:79], 0 offen offset:2048 sc1
    v_cvt_pk_bf16_f32 v144, v88, v89
    v_mfma_f32_16x16x32_bf16 v[60:63], v[116:119], a[188:191], v[60:63]
    v_fma_f32 v130, v130, v30, v30
    v_mul_f32 v131, v75, v75
    v_mfma_f32_16x16x32_bf16 v[60:63], v[112:115], a[172:175], v[60:63]
    v_rcp_f32 v130, v130
    v_mfma_f32_16x16x32_bf16 v[60:63], v[108:111], a[156:159], v[60:63]
    s_waitcnt lgkmcnt(0)
    v_mfma_f32_16x16x32_bf16 v[32:35], v[96:99], a[192:195], v[32:35]
    ds_read_b128 v[108:111], v10 offset:25600
    buffer_load_dwordx4 v[172:175], v2, s[76:79], 0 offen offset:3072 sc1
    v_mfma_f32_16x16x32_bf16 v[32:35], v[100:103], a[208:211], v[32:35]
    v_mul_f32 v90, v90, v130
    v_fma_f32 v131, v131, v26, v22
    v_mfma_f32_16x16x32_bf16 v[32:35], v[104:107], a[224:227], v[32:35]
    ds_read_b128 v[112:115], v10 offset:27648
    v_mul_f32 v131, v131, v75
    v_mfma_f32_16x16x32_bf16 v[36:39], v[104:107], a[228:231], v[36:39]
    v_exp_f32 v131, v131
    v_mfma_f32_16x16x32_bf16 v[36:39], v[100:103], a[212:215], v[36:39]
    ds_read_b128 v[116:119], v10 offset:29696
    buffer_load_dwordx4 v[176:179], v4, s[76:79], 0 offen offset:3072 sc1
    v_mfma_f32_16x16x32_bf16 v[36:39], v[96:99], a[196:199], v[36:39]
    v_mul_f32 v91, v75, v91
    v_mul_f32 v128, v76, v76
    v_mfma_f32_16x16x32_bf16 v[40:43], v[96:99], a[200:203], v[40:43]
    v_fma_f32 v131, v131, v30, v30
    v_fma_f32 v128, v128, v27, v23
    v_mfma_f32_16x16x32_bf16 v[40:43], v[100:103], a[216:219], v[40:43]
    v_rcp_f32 v131, v131
    v_mfma_f32_16x16x32_bf16 v[40:43], v[104:107], a[232:235], v[40:43]
    buffer_load_dwordx4 v[180:183], v2, s[76:79], s41 offen offset:0 sc1
    v_mul_f32 v91, v91, v131
    v_mfma_f32_16x16x32_bf16 v[44:47], v[104:107], a[236:239], v[44:47]
    v_cvt_pk_bf16_f32 v145, v90, v91
    v_mul_f32 v128, v128, v76
    v_mfma_f32_16x16x32_bf16 v[44:47], v[100:103], a[220:223], v[44:47]
    v_exp_f32 v128, v128
    v_mfma_f32_16x16x32_bf16 v[44:47], v[96:99], a[204:207], v[44:47]
    s_waitcnt lgkmcnt(0)
    v_mul_f32 v92, v76, v92
    v_mfma_f32_16x16x32_bf16 v[48:51], v[108:111], a[192:195], v[48:51]
    ds_read_b128 v[96:99], v10 offset:30720
    buffer_load_dwordx4 v[184:187], v4, s[76:79], s41 offen offset:0 sc1
    v_mfma_f32_16x16x32_bf16 v[48:51], v[112:115], a[208:211], v[48:51]
    v_fma_f32 v128, v128, v31, v31
    v_mul_f32 v129, v77, v77
    v_mfma_f32_16x16x32_bf16 v[48:51], v[116:119], a[224:227], v[48:51]
    ds_read_b128 v[100:103], v10 offset:32768
    v_fma_f32 v129, v129, v27, v23
    v_mfma_f32_16x16x32_bf16 v[52:55], v[116:119], a[228:231], v[52:55]
    v_rcp_f32 v128, v128
    v_mfma_f32_16x16x32_bf16 v[52:55], v[112:115], a[212:215], v[52:55]
    ds_read_b128 v[104:107], v10 offset:34816
    v_mul_f32 v92, v92, v128
    v_mfma_f32_16x16x32_bf16 v[52:55], v[108:111], a[196:199], v[52:55]
    buffer_load_dwordx4 v[188:191], v2, s[76:79], s41 offen offset:1024 sc1
    v_mul_f32 v129, v129, v77
    v_mfma_f32_16x16x32_bf16 v[56:59], v[108:111], a[200:203], v[56:59]
    v_exp_f32 v129, v129
    v_mfma_f32_16x16x32_bf16 v[56:59], v[112:115], a[216:219], v[56:59]
    v_mul_f32 v93, v77, v93
    v_mul_f32 v130, v78, v78
    v_mfma_f32_16x16x32_bf16 v[56:59], v[116:119], a[232:235], v[56:59]
    v_fma_f32 v129, v129, v31, v31
    v_mfma_f32_16x16x32_bf16 v[60:63], v[116:119], a[236:239], v[60:63]
    buffer_load_dwordx4 v[192:195], v4, s[76:79], s41 offen offset:1024 sc1
    v_fma_f32 v130, v130, v27, v23
    v_mfma_f32_16x16x32_bf16 v[60:63], v[112:115], a[220:223], v[60:63]
    v_rcp_f32 v129, v129
    v_mfma_f32_16x16x32_bf16 v[60:63], v[108:111], a[204:207], v[60:63]
    s_waitcnt lgkmcnt(0)
    v_mul_f32 v93, v93, v129
    v_mfma_f32_16x16x32_bf16 v[32:35], v[96:99], a[240:243], v[32:35]
    ds_read_b128 v[108:111], v10 offset:31744
    v_cvt_pk_bf16_f32 v146, v92, v93
    v_mfma_f32_16x16x32_bf16 v[32:35], v[100:103], v[224:227], v[32:35]
    buffer_load_dwordx4 v[196:199], v2, s[76:79], s41 offen offset:2048 sc1
    v_mul_f32 v130, v130, v78
    v_mfma_f32_16x16x32_bf16 v[32:35], v[104:107], v[240:243], v[32:35]
    ds_read_b128 v[112:115], v10 offset:33792
    v_mul_f32 v131, v79, v79
    v_mfma_f32_16x16x32_bf16 v[36:39], v[104:107], v[244:247], v[36:39]
    v_exp_f32 v130, v130
    v_mfma_f32_16x16x32_bf16 v[36:39], v[100:103], v[228:231], v[36:39]
    ds_read_b128 v[116:119], v10 offset:35840
    v_mul_f32 v94, v78, v94
    v_mfma_f32_16x16x32_bf16 v[36:39], v[96:99], a[244:247], v[36:39]
    buffer_load_dwordx4 v[200:203], v4, s[76:79], s41 offen offset:2048 sc1
    v_fma_f32 v130, v130, v31, v31
    v_mfma_f32_16x16x32_bf16 v[40:43], v[96:99], a[248:251], v[40:43]
    s_barrier
    v_rcp_f32 v130, v130
    v_mfma_f32_16x16x32_bf16 v[40:43], v[100:103], v[232:235], v[40:43]
    v_mul_f32 v94, v94, v130
    v_fma_f32 v131, v131, v27, v23
    v_mfma_f32_16x16x32_bf16 v[40:43], v[104:107], v[248:251], v[40:43]
    v_mul_f32 v131, v131, v79
    v_mfma_f32_16x16x32_bf16 v[44:47], v[104:107], v[252:255], v[44:47]
    buffer_load_dwordx4 v[204:207], v2, s[76:79], s41 offen offset:3072 sc1
    v_mfma_f32_16x16x32_bf16 v[44:47], v[100:103], v[236:239], v[44:47]
    v_exp_f32 v131, v131
    v_mfma_f32_16x16x32_bf16 v[44:47], v[96:99], a[252:255], v[44:47]
    s_waitcnt lgkmcnt(0)
    v_mul_f32 v95, v79, v95
    v_mfma_f32_16x16x32_bf16 v[48:51], v[108:111], a[240:243], v[48:51]
    v_fma_f32 v131, v131, v31, v31
    v_mfma_f32_16x16x32_bf16 v[48:51], v[112:115], v[224:227], v[48:51]
    v_rcp_f32 v131, v131
    v_mfma_f32_16x16x32_bf16 v[48:51], v[116:119], v[240:243], v[48:51]
    buffer_load_dwordx4 v[208:211], v4, s[76:79], s41 offen offset:3072 sc1
    v_mul_f32 v95, v95, v131
    v_mfma_f32_16x16x32_bf16 v[52:55], v[116:119], v[244:247], v[52:55]
    v_cvt_pk_bf16_f32 v147, v94, v95
    v_mfma_f32_16x16x32_bf16 v[52:55], v[112:115], v[228:231], v[52:55]
    v_mfma_f32_16x16x32_bf16 v[52:55], v[108:111], a[244:247], v[52:55]
    v_permlane32_swap_b32 v144, v146
    v_mfma_f32_16x16x32_bf16 v[56:59], v[108:111], a[248:251], v[56:59]
    v_permlane32_swap_b32 v145, v147
    v_mfma_f32_16x16x32_bf16 v[56:59], v[112:115], v[232:235], v[56:59]
    buffer_store_dwordx4 v[144:147], v13, s[88:91], s35 offen sc1
    v_mfma_f32_16x16x32_bf16 v[56:59], v[116:119], v[248:251], v[56:59]
    v_mfma_f32_16x16x32_bf16 v[60:63], v[116:119], v[252:255], v[60:63]
    v_mfma_f32_16x16x32_bf16 v[60:63], v[112:115], v[236:239], v[60:63]
    v_mfma_f32_16x16x32_bf16 v[60:63], v[108:111], a[252:255], v[60:63]
    s_add_u32 s34, s34, s41
    s_add_u32 s35, s35, s41
    s_lshr_b32 s20, s6, 1
    s_and_b32 s21, s6, 1
    s_lshl_b32 s21, s21, 3
    s_and_b32 s22, s7, 7
    s_add_u32 s21, s21, s22
    s_lshr_b32 s22, s7, 3
    s_lshl_b32 s38, s21, 3
    s_lshl_b32 s24, s3, 1
    s_add_u32 s38, s38, s24
    s_add_u32 s24, s87, 4294866944
    s_mov_b32 s30, 8192
    s_mov_b32 s31, 9
    v_add_u32 v5, 1408, v1
    v_lshlrev_b32 v5, 7, v5
    v_mov_b32 v6, s24
    v_cmp_gt_u32 vcc, 16, v1
    s_nop 1
    v_cndmask_b32 v5, v6, v5, vcc
    v_cndmask_b32 v6, 8, 64, vcc
    s_mov_b64 exec, 0x1ffff
    buffer_load_dword v7, v5, s[96:99], 0 offen sc1
    s_mov_b64 exec, -1
    s_add_u32 s39, s24, 16384
    s_lshl_b32 s25, s22, 2
    s_add_u32 s25, s25, s20
    s_mul_i32 s25, s25, 331776
    s_add_u32 s25, s25, 13418496
    s_add_u32 s8, s4, s25
    s_addc_u32 s9, s5, 0
    s_mov_b32 s10, 331776
    s_mov_b32 s11, 0x20000
    s_mul_i32 s26, s3, 9216
    v_add_u32 v3, s26, v2
    s_waitcnt vmcnt(29)
    v_pk_fma_f32 v[32:33], v[16:17], v[120:121], v[32:33] op_sel:[0,0,0] op_sel_hi:[0,1,1] neg_lo:[1,0,0] neg_hi:[1,0,0]
    v_pk_fma_f32 v[34:35], v[16:17], v[122:123], v[34:35] op_sel:[0,0,0] op_sel_hi:[0,1,1] neg_lo:[1,0,0] neg_hi:[1,0,0]
    v_pk_fma_f32 v[36:37], v[16:17], v[120:121], v[36:37] op_sel:[1,0,0] op_sel_hi:[1,1,1] neg_lo:[1,0,0] neg_hi:[1,0,0]
    v_pk_fma_f32 v[38:39], v[16:17], v[122:123], v[38:39] op_sel:[1,0,0] op_sel_hi:[1,1,1] neg_lo:[1,0,0] neg_hi:[1,0,0]
    buffer_load_dwordx4 a[0:3], v2, s[76:79], s42 offen offset:0 sc1
    s_waitcnt vmcnt(29)
    v_pk_fma_f32 v[48:49], v[16:17], v[124:125], v[48:49] op_sel:[0,0,0] op_sel_hi:[0,1,1] neg_lo:[1,0,0] neg_hi:[1,0,0]
    v_pk_fma_f32 v[50:51], v[16:17], v[126:127], v[50:51] op_sel:[0,0,0] op_sel_hi:[0,1,1] neg_lo:[1,0,0] neg_hi:[1,0,0]
    v_pk_fma_f32 v[52:53], v[16:17], v[124:125], v[52:53] op_sel:[1,0,0] op_sel_hi:[1,1,1] neg_lo:[1,0,0] neg_hi:[1,0,0]
    v_pk_fma_f32 v[54:55], v[16:17], v[126:127], v[54:55] op_sel:[1,0,0] op_sel_hi:[1,1,1] neg_lo:[1,0,0] neg_hi:[1,0,0]
    buffer_load_dwordx4 a[4:7], v4, s[76:79], s42 offen offset:0 sc1
    v_pk_mul_f32 v[128:129], v[32:33], v[32:33]
    v_pk_mul_f32 v[130:131], v[34:35], v[34:35]
    v_pk_mul_f32 v[132:133], v[36:37], v[36:37]
    v_pk_mul_f32 v[134:135], v[38:39], v[38:39]
    buffer_load_dwordx4 a[8:11], v2, s[76:79], s42 offen offset:1024 sc1
    v_pk_fma_f32 v[128:129], v[128:129], v[24:25], v[20:21] op_sel:[0,0,0] op_sel_hi:[1,0,0]
    v_pk_fma_f32 v[130:131], v[130:131], v[24:25], v[20:21] op_sel:[0,0,0] op_sel_hi:[1,0,0]
    v_pk_fma_f32 v[132:133], v[132:133], v[24:25], v[20:21] op_sel:[0,1,1] op_sel_hi:[1,1,1]
    v_pk_fma_f32 v[134:135], v[134:135], v[24:25], v[20:21] op_sel:[0,1,1] op_sel_hi:[1,1,1]
    buffer_load_dwordx4 a[12:15], v4, s[76:79], s42 offen offset:1024 sc1
    v_pk_mul_f32 v[128:129], v[128:129], v[32:33]
    v_pk_mul_f32 v[130:131], v[130:131], v[34:35]
    v_pk_mul_f32 v[132:133], v[132:133], v[36:37]
    v_pk_mul_f32 v[134:135], v[134:135], v[38:39]
    buffer_load_dwordx4 a[16:19], v2, s[76:79], s42 offen offset:2048 sc1
    v_exp_f32 v128, v128
    v_exp_f32 v130, v130
    v_exp_f32 v132, v132
    v_exp_f32 v134, v134
    buffer_load_dwordx4 a[20:23], v4, s[76:79], s42 offen offset:2048 sc1
    v_exp_f32 v129, v129
    v_exp_f32 v131, v131
    v_exp_f32 v133, v133
    v_exp_f32 v135, v135
    buffer_load_dwordx4 a[24:27], v2, s[76:79], s42 offen offset:3072 sc1
    v_pk_mul_f32 v[48:49], v[32:33], v[48:49]
    v_pk_mul_f32 v[50:51], v[34:35], v[50:51]
    v_pk_mul_f32 v[52:53], v[36:37], v[52:53]
    v_pk_mul_f32 v[54:55], v[38:39], v[54:55]
    buffer_load_dwordx4 a[28:31], v4, s[76:79], s42 offen offset:3072 sc1
    v_pk_fma_f32 v[128:129], v[128:129], v[28:29], v[28:29] op_sel:[0,0,0] op_sel_hi:[1,0,0]
    v_pk_fma_f32 v[130:131], v[130:131], v[28:29], v[28:29] op_sel:[0,0,0] op_sel_hi:[1,0,0]
    v_pk_fma_f32 v[132:133], v[132:133], v[28:29], v[28:29] op_sel:[0,1,1] op_sel_hi:[1,1,1]
    v_pk_fma_f32 v[134:135], v[134:135], v[28:29], v[28:29] op_sel:[0,1,1] op_sel_hi:[1,1,1]
    v_rcp_f32 v128, v128
    v_rcp_f32 v130, v130
    v_rcp_f32 v132, v132
    v_rcp_f32 v134, v134
    v_rcp_f32 v129, v129
    v_rcp_f32 v131, v131
    v_rcp_f32 v133, v133
    v_rcp_f32 v135, v135
    v_pk_mul_f32 v[48:49], v[48:49], v[128:129]
    v_pk_mul_f32 v[50:51], v[50:51], v[130:131]
    v_pk_mul_f32 v[52:53], v[52:53], v[132:133]
    v_pk_mul_f32 v[54:55], v[54:55], v[134:135]
    v_cvt_pk_bf16_f32 v140, v48, v49
    v_cvt_pk_bf16_f32 v141, v50, v51
    v_cvt_pk_bf16_f32 v142, v52, v53
    v_cvt_pk_bf16_f32 v143, v54, v55
    v_pk_fma_f32 v[40:41], v[18:19], v[120:121], v[40:41] op_sel:[0,0,0] op_sel_hi:[0,1,1] neg_lo:[1,0,0] neg_hi:[1,0,0]
    v_pk_fma_f32 v[42:43], v[18:19], v[122:123], v[42:43] op_sel:[0,0,0] op_sel_hi:[0,1,1] neg_lo:[1,0,0] neg_hi:[1,0,0]
    v_pk_fma_f32 v[44:45], v[18:19], v[120:121], v[44:45] op_sel:[1,0,0] op_sel_hi:[1,1,1] neg_lo:[1,0,0] neg_hi:[1,0,0]
    v_pk_fma_f32 v[46:47], v[18:19], v[122:123], v[46:47] op_sel:[1,0,0] op_sel_hi:[1,1,1] neg_lo:[1,0,0] neg_hi:[1,0,0]
    v_permlane32_swap_b32 v140, v142
    v_permlane32_swap_b32 v141, v143
    buffer_store_dwordx4 v[140:143], v13, s[88:91], s34 offen sc1
    v_pk_fma_f32 v[56:57], v[18:19], v[124:125], v[56:57] op_sel:[0,0,0] op_sel_hi:[0,1,1] neg_lo:[1,0,0] neg_hi:[1,0,0]
    v_pk_fma_f32 v[58:59], v[18:19], v[126:127], v[58:59] op_sel:[0,0,0] op_sel_hi:[0,1,1] neg_lo:[1,0,0] neg_hi:[1,0,0]
    v_pk_fma_f32 v[60:61], v[18:19], v[124:125], v[60:61] op_sel:[1,0,0] op_sel_hi:[1,1,1] neg_lo:[1,0,0] neg_hi:[1,0,0]
    v_pk_fma_f32 v[62:63], v[18:19], v[126:127], v[62:63] op_sel:[1,0,0] op_sel_hi:[1,1,1] neg_lo:[1,0,0] neg_hi:[1,0,0]
    v_pk_mul_f32 v[128:129], v[40:41], v[40:41]
    v_pk_mul_f32 v[130:131], v[42:43], v[42:43]
    v_pk_mul_f32 v[132:133], v[44:45], v[44:45]
    v_pk_mul_f32 v[134:135], v[46:47], v[46:47]
    v_pk_fma_f32 v[128:129], v[128:129], v[26:27], v[22:23] op_sel:[0,0,0] op_sel_hi:[1,0,0]
    v_pk_fma_f32 v[130:131], v[130:131], v[26:27], v[22:23] op_sel:[0,0,0] op_sel_hi:[1,0,0]
    v_pk_fma_f32 v[132:133], v[132:133], v[26:27], v[22:23] op_sel:[0,1,1] op_sel_hi:[1,1,1]
    v_pk_fma_f32 v[134:135], v[134:135], v[26:27], v[22:23] op_sel:[0,1,1] op_sel_hi:[1,1,1]
    v_pk_mul_f32 v[128:129], v[128:129], v[40:41]
    v_pk_mul_f32 v[130:131], v[130:131], v[42:43]
    v_pk_mul_f32 v[132:133], v[132:133], v[44:45]
    v_pk_mul_f32 v[134:135], v[134:135], v[46:47]
    v_exp_f32 v128, v128
    v_exp_f32 v130, v130
    v_exp_f32 v132, v132
    v_exp_f32 v134, v134
    v_exp_f32 v129, v129
    v_exp_f32 v131, v131
    v_exp_f32 v133, v133
    v_exp_f32 v135, v135
    v_pk_mul_f32 v[56:57], v[40:41], v[56:57]
    v_pk_mul_f32 v[58:59], v[42:43], v[58:59]
    v_pk_mul_f32 v[60:61], v[44:45], v[60:61]
    v_pk_mul_f32 v[62:63], v[46:47], v[62:63]
    v_pk_fma_f32 v[128:129], v[128:129], v[30:31], v[30:31] op_sel:[0,0,0] op_sel_hi:[1,0,0]
    v_pk_fma_f32 v[130:131], v[130:131], v[30:31], v[30:31] op_sel:[0,0,0] op_sel_hi:[1,0,0]
    v_pk_fma_f32 v[132:133], v[132:133], v[30:31], v[30:31] op_sel:[0,1,1] op_sel_hi:[1,1,1]
    v_pk_fma_f32 v[134:135], v[134:135], v[30:31], v[30:31] op_sel:[0,1,1] op_sel_hi:[1,1,1]
    v_rcp_f32 v128, v128
    v_rcp_f32 v130, v130
    v_rcp_f32 v132, v132
    v_rcp_f32 v134, v134
    v_rcp_f32 v129, v129
    v_rcp_f32 v131, v131
    v_rcp_f32 v133, v133
    v_rcp_f32 v135, v135
    v_pk_mul_f32 v[56:57], v[56:57], v[128:129]
    v_pk_mul_f32 v[58:59], v[58:59], v[130:131]
    v_pk_mul_f32 v[60:61], v[60:61], v[132:133]
    v_pk_mul_f32 v[62:63], v[62:63], v[134:135]
    v_cvt_pk_bf16_f32 v144, v56, v57
    v_cvt_pk_bf16_f32 v145, v58, v59
    v_cvt_pk_bf16_f32 v146, v60, v61
    v_cvt_pk_bf16_f32 v147, v62, v63
    s_nop 0
    v_permlane32_swap_b32 v144, v146
    v_permlane32_swap_b32 v145, v147
    buffer_store_dwordx4 v[144:147], v13, s[88:91], s35 offen sc1
    s_add_u32 s34, s34, 4096
    s_add_u32 s35, s35, 4096
    s_waitcnt vmcnt(10)
    v_cmp_gt_u32 vcc, v6, v7
    s_nop 0
    s_and_b64 vcc, vcc, 0x1ffff
    s_cbranch_vccz CHK_mk_18
    s_mov_b64 exec, 131071
    s_mov_b32 s61, 200000
POLL_tmp_19:
    buffer_load_dword v7, v5, s[96:99], 0 offen sc1
    s_waitcnt vmcnt(0)
    v_cmp_gt_u32 vcc, v6, v7
    s_nop 0
    s_cbranch_vccz PDONE_tmp_20
    s_sub_u32 s61, s61, 1
    s_cmp_lg_u32 s61, 0
    s_cbranch_scc1 POLL_tmp_19
PDONE_tmp_20:
    s_mov_b64 exec, -1
CHK_mk_18:
    v_add_u32 v8, 36864, v2
    v_add_u32 v9, 73728, v2
    v_add_u32 v10, 110592, v2
    ds_read_b128 v[16:19], v8 offset:0
    ds_read_b128 v[20:23], v8 offset:9216
    ds_read_b128 v[24:27], v8 offset:18432
    ds_read_b128 v[28:31], v8 offset:27648
    ds_read_b128 v[32:35], v8 offset:1024
    ds_read_b128 v[36:39], v8 offset:10240
    ds_read_b128 v[40:43], v8 offset:19456
    ds_read_b128 v[44:47], v8 offset:28672
    s_add_u32 s24, s40, 16384
    v_mov_b32 v6, 0
    s_mul_i32 s25, s38, 18432
    s_mul_i32 s28, s20, 2359296
    s_add_u32 s25, s25, s28
    s_mul_i32 s28, s22, 4608
    s_add_u32 s25, s25, s28
    s_add_u32 s25, s25, 28299264
    s_add_u32 s16, s58, s25
    s_addc_u32 s17, s59, 0
    s_mov_b32 s18, 23040
    s_mov_b32 s19, 0x20000
    v_lshrrev_b32 v13, 5, v1
    v_mul_u32_u24 v13, 18432, v13
    v_and_b32 v14, 31, v1
    v_lshl_add_u32 v13, v14, 4, v13
    s_lshr_b32 s28, s6, 2
    s_lshl_b32 s28, s28, 3
    s_lshr_b32 s29, s7, 2
    s_add_u32 s28, s28, s29
    s_mul_i32 s28, s28, 129024
    s_add_u32 s28, s28, 0
    s_cmp_eq_u32 s60, 2
    s_cselect_b32 s29, 129024, 0
    s_add_u32 s92, s4, s28
    s_addc_u32 s93, s5, 0
    s_mov_b32 s94, s29
    s_mov_b32 s95, 0x20000
    s_lshl_b32 s29, s3, 12
    s_waitcnt lgkmcnt(6)
    v_mfma_f32_16x16x32_bf16 v[64:67], v[16:19], v[148:151], 0
    s_add_u32 m0, s26, 110592
    ds_read_b128 v[48:51], v8 offset:2048
    v_mfma_f32_16x16x32_bf16 v[64:67], v[20:23], v[156:159], v[64:67]
    s_waitcnt lgkmcnt(5)
    v_mfma_f32_16x16x32_bf16 v[64:67], v[24:27], v[164:167], v[64:67]
    s_mov_b32 s27, 73728
    ds_read_b128 v[52:55], v8 offset:11264
    v_mfma_f32_16x16x32_bf16 v[64:67], v[28:31], v[172:175], v[64:67]
    buffer_load_dwordx4 v3, s[8:11], s27 offen offset:0 sc1 lds
    v_mfma_f32_16x16x32_bf16 v[100:103], v[28:31], v[176:179], 0
    ds_read_b128 v[56:59], v8 offset:20480
    buffer_load_dwordx4 v3, s[8:11], s27 offen offset:1024 sc1 lds
    v_mfma_f32_16x16x32_bf16 v[100:103], v[24:27], v[168:171], v[100:103]
    ds_read_b128 v[60:63], v8 offset:29696
    v_mfma_f32_16x16x32_bf16 v[100:103], v[20:23], v[160:163], v[100:103]
    v_mfma_f32_16x16x32_bf16 v[100:103], v[16:19], v[152:155], v[100:103]
    s_waitcnt lgkmcnt(6)
    ds_read_b128 v[16:19], v8 offset:3072
    v_mfma_f32_16x16x32_bf16 v[68:71], v[32:35], v[148:151], 0
    buffer_load_dwordx4 v3, s[8:11], s27 offen offset:2048 sc1 lds
    v_mfma_f32_16x16x32_bf16 v[68:71], v[36:39], v[156:159], v[68:71]
    s_waitcnt lgkmcnt(5)
    ds_read_b128 v[20:23], v8 offset:12288
    v_mfma_f32_16x16x32_bf16 v[68:71], v[40:43], v[164:167], v[68:71]
    ds_read_b128 v[24:27], v8 offset:21504
    v_mfma_f32_16x16x32_bf16 v[68:71], v[44:47], v[172:175], v[68:71]
    v_mfma_f32_16x16x32_bf16 v[104:107], v[44:47], v[176:179], 0
    ds_read_b128 v[28:31], v8 offset:30720
    v_mfma_f32_16x16x32_bf16 v[104:107], v[40:43], v[168:171], v[104:107]
    buffer_load_dwordx4 v3, s[8:11], s27 offen offset:3072 sc1 lds
    v_mfma_f32_16x16x32_bf16 v[104:107], v[36:39], v[160:163], v[104:107]
    s_add_u32 m0, s26, 114688
    v_mfma_f32_16x16x32_bf16 v[104:107], v[32:35], v[152:155], v[104:107]
    s_waitcnt lgkmcnt(6)
    ds_read_b128 v[32:35], v8 offset:4096
    ds_read_b128 v[36:39], v8 offset:13312
    v_mfma_f32_16x16x32_bf16 v[72:75], v[48:51], v[148:151], 0
    s_mov_b32 s27, 77824
    v_mfma_f32_16x16x32_bf16 v[72:75], v[52:55], v[156:159], v[72:75]
    s_waitcnt lgkmcnt(6)
    ds_read_b128 v[40:43], v8 offset:22528
    buffer_load_dwordx4 v3, s[8:11], s27 offen offset:0 sc1 lds
    v_mfma_f32_16x16x32_bf16 v[72:75], v[56:59], v[164:167], v[72:75]
    v_mfma_f32_16x16x32_bf16 v[72:75], v[60:63], v[172:175], v[72:75]
    ds_read_b128 v[44:47], v8 offset:31744
    v_mfma_f32_16x16x32_bf16 v[108:111], v[60:63], v[176:179], 0
    s_waitcnt vmcnt(5)
    buffer_atomic_add v15, v11, s[96:99], s24 offen
    v_mfma_f32_16x16x32_bf16 v[108:111], v[56:59], v[168:171], v[108:111]
    v_mfma_f32_16x16x32_bf16 v[108:111], v[52:55], v[160:163], v[108:111]
    buffer_load_dwordx4 v3, s[8:11], s27 offen offset:1024 sc1 lds
    v_mfma_f32_16x16x32_bf16 v[108:111], v[48:51], v[152:155], v[108:111]
    s_waitcnt lgkmcnt(6)
    ds_read_b128 v[48:51], v8 offset:5120
    ds_read_b128 v[52:55], v8 offset:14336
    v_mfma_f32_16x16x32_bf16 v[76:79], v[16:19], v[148:151], 0
    ds_read_b128 v[56:59], v8 offset:23552
    v_mfma_f32_16x16x32_bf16 v[76:79], v[20:23], v[156:159], v[76:79]
    s_waitcnt lgkmcnt(7)
    ds_read_b128 v[60:63], v8 offset:32768
    v_mfma_f32_16x16x32_bf16 v[76:79], v[24:27], v[164:167], v[76:79]
    buffer_load_dwordx4 v3, s[8:11], s27 offen offset:2048 sc1 lds
    v_mfma_f32_16x16x32_bf16 v[76:79], v[28:31], v[172:175], v[76:79]
    v_mfma_f32_16x16x32_bf16 v[112:115], v[28:31], v[176:179], 0
    v_mfma_f32_16x16x32_bf16 v[112:115], v[24:27], v[168:171], v[112:115]
    v_mfma_f32_16x16x32_bf16 v[112:115], v[20:23], v[160:163], v[112:115]
    buffer_load_dwordx4 v3, s[8:11], s27 offen offset:3072 sc1 lds
    v_mfma_f32_16x16x32_bf16 v[112:115], v[16:19], v[152:155], v[112:115]
    s_waitcnt lgkmcnt(6)
    ds_read_b128 v[16:19], v8 offset:6144
    ds_read_b128 v[20:23], v8 offset:15360
    v_mfma_f32_16x16x32_bf16 v[80:83], v[32:35], v[148:151], 0
    ds_read_b128 v[24:27], v8 offset:24576
    ds_read_b128 v[28:31], v8 offset:33792
    v_mfma_f32_16x16x32_bf16 v[80:83], v[36:39], v[156:159], v[80:83]
    s_waitcnt lgkmcnt(8)
    v_mfma_f32_16x16x32_bf16 v[80:83], v[40:43], v[164:167], v[80:83]
    s_add_u32 m0, s26, 118784
    v_mfma_f32_16x16x32_bf16 v[80:83], v[44:47], v[172:175], v[80:83]
    s_mov_b32 s27, 81920
    v_mfma_f32_16x16x32_bf16 v[116:119], v[44:47], v[176:179], 0
    buffer_load_dwordx4 v3, s[8:11], s27 offen offset:0 sc1 lds
    v_mfma_f32_16x16x32_bf16 v[116:119], v[40:43], v[168:171], v[116:119]
    v_mfma_f32_16x16x32_bf16 v[116:119], v[36:39], v[160:163], v[116:119]
    v_mfma_f32_16x16x32_bf16 v[116:119], v[32:35], v[152:155], v[116:119]
    s_waitcnt lgkmcnt(6)
    ds_read_b128 v[32:35], v8 offset:7168
    ds_read_b128 v[36:39], v8 offset:16384
    v_mfma_f32_16x16x32_bf16 v[84:87], v[48:51], v[148:151], 0
    ds_read_b128 v[40:43], v8 offset:25600
    ds_read_b128 v[44:47], v8 offset:34816
    v_mfma_f32_16x16x32_bf16 v[84:87], v[52:55], v[156:159], v[84:87]
    s_waitcnt lgkmcnt(8)
    buffer_load_dwordx4 a[32:35], v2, s[76:79], s43 offen offset:0 sc1
    v_mfma_f32_16x16x32_bf16 v[84:87], v[56:59], v[164:167], v[84:87]
    v_mfma_f32_16x16x32_bf16 v[84:87], v[60:63], v[172:175], v[84:87]
    buffer_load_dwordx4 a[36:39], v4, s[76:79], s43 offen offset:0 sc1
    v_mfma_f32_16x16x32_bf16 v[120:123], v[60:63], v[176:179], 0
    v_mfma_f32_16x16x32_bf16 v[120:123], v[56:59], v[168:171], v[120:123]
    v_mfma_f32_16x16x32_bf16 v[120:123], v[52:55], v[160:163], v[120:123]
    v_mfma_f32_16x16x32_bf16 v[120:123], v[48:51], v[152:155], v[120:123]
    s_waitcnt lgkmcnt(6)
    ds_read_b128 v[48:51], v8 offset:8192
    ds_read_b128 v[52:55], v8 offset:17408
    v_mfma_f32_16x16x32_bf16 v[88:91], v[16:19], v[148:151], 0
    ds_read_b128 v[56:59], v8 offset:26624
    ds_read_b128 v[60:63], v8 offset:35840
    v_mfma_f32_16x16x32_bf16 v[88:91], v[20:23], v[156:159], v[88:91]
    s_waitcnt lgkmcnt(8)
    buffer_load_dwordx4 a[40:43], v2, s[76:79], s43 offen offset:1024 sc1
    v_mfma_f32_16x16x32_bf16 v[88:91], v[24:27], v[164:167], v[88:91]
    v_mfma_f32_16x16x32_bf16 v[88:91], v[28:31], v[172:175], v[88:91]
    v_mfma_f32_16x16x32_bf16 v[124:127], v[28:31], v[176:179], 0
    buffer_load_dwordx4 a[44:47], v4, s[76:79], s43 offen offset:1024 sc1
    v_mfma_f32_16x16x32_bf16 v[124:127], v[24:27], v[168:171], v[124:127]
    v_mfma_f32_16x16x32_bf16 v[124:127], v[20:23], v[160:163], v[124:127]
    s_waitcnt lgkmcnt(0)
    v_mfma_f32_16x16x32_bf16 v[124:127], v[16:19], v[152:155], v[124:127]
    v_mfma_f32_16x16x32_bf16 v[92:95], v[32:35], v[148:151], 0
    s_barrier
    v_mfma_f32_16x16x32_bf16 v[92:95], v[36:39], v[156:159], v[92:95]
    ds_read_b128 v[16:19], v9 offset:0
    buffer_load_dwordx4 a[48:51], v2, s[76:79], s43 offen offset:2048 sc1
    v_mfma_f32_16x16x32_bf16 v[92:95], v[40:43], v[164:167], v[92:95]
    ds_read_b128 v[20:23], v9 offset:9216
    v_mfma_f32_16x16x32_bf16 v[92:95], v[44:47], v[172:175], v[92:95]
    ds_read_b128 v[24:27], v9 offset:18432
    v_mfma_f32_16x16x32_bf16 v[128:131], v[44:47], v[176:179], 0
    ds_read_b128 v[28:31], v9 offset:27648
    v_mfma_f32_16x16x32_bf16 v[128:131], v[40:43], v[168:171], v[128:131]
    buffer_load_dwordx4 a[52:55], v4, s[76:79], s43 offen offset:2048 sc1
    v_mfma_f32_16x16x32_bf16 v[128:131], v[36:39], v[160:163], v[128:131]
    v_mfma_f32_16x16x32_bf16 v[128:131], v[32:35], v[152:155], v[128:131]
    ds_read_b128 v[32:35], v9 offset:1024
    ds_read_b128 v[36:39], v9 offset:10240
    v_mfma_f32_16x16x32_bf16 v[96:99], v[48:51], v[148:151], 0
    ds_read_b128 v[40:43], v9 offset:19456
    ds_read_b128 v[44:47], v9 offset:28672
    v_mfma_f32_16x16x32_bf16 v[96:99], v[52:55], v[156:159], v[96:99]
    buffer_load_dwordx4 a[56:59], v2, s[76:79], s43 offen offset:3072 sc1
    v_mfma_f32_16x16x32_bf16 v[96:99], v[56:59], v[164:167], v[96:99]
    v_mfma_f32_16x16x32_bf16 v[96:99], v[60:63], v[172:175], v[96:99]
    v_mfma_f32_16x16x32_bf16 v[132:135], v[60:63], v[176:179], 0
    v_mfma_f32_16x16x32_bf16 v[132:135], v[56:59], v[168:171], v[132:135]
    v_mfma_f32_16x16x32_bf16 v[132:135], v[52:55], v[160:163], v[132:135]
    buffer_load_dwordx4 a[60:63], v4, s[76:79], s43 offen offset:3072 sc1
    v_mfma_f32_16x16x32_bf16 v[132:135], v[48:51], v[152:155], v[132:135]
    s_waitcnt lgkmcnt(6)
    v_mfma_f32_16x16x32_bf16 v[64:67], v[16:19], v[180:183], v[64:67]
    s_add_u32 m0, s26, 0
    ds_read_b128 v[48:51], v9 offset:2048
    v_mfma_f32_16x16x32_bf16 v[64:67], v[20:23], v[188:191], v[64:67]
    s_waitcnt lgkmcnt(5)
    v_mfma_f32_16x16x32_bf16 v[64:67], v[24:27], v[196:199], v[64:67]
    s_mov_b32 s27, 110592
    ds_read_b128 v[52:55], v9 offset:11264
    v_mfma_f32_16x16x32_bf16 v[64:67], v[28:31], v[204:207], v[64:67]
    buffer_load_dwordx4 v3, s[8:11], s27 offen offset:0 sc1 lds
    v_mfma_f32_16x16x32_bf16 v[100:103], v[28:31], v[208:211], v[100:103]
    ds_read_b128 v[56:59], v9 offset:20480
    v_mfma_f32_16x16x32_bf16 v[100:103], v[24:27], v[200:203], v[100:103]
    ds_read_b128 v[60:63], v9 offset:29696
    v_mfma_f32_16x16x32_bf16 v[100:103], v[20:23], v[192:195], v[100:103]
    v_mfma_f32_16x16x32_bf16 v[100:103], v[16:19], v[184:187], v[100:103]
    s_waitcnt lgkmcnt(6)
    ds_read_b128 v[16:19], v9 offset:3072
    buffer_load_dwordx4 v3, s[8:11], s27 offen offset:1024 sc1 lds
    v_mfma_f32_16x16x32_bf16 v[68:71], v[32:35], v[180:183], v[68:71]
    v_mfma_f32_16x16x32_bf16 v[68:71], v[36:39], v[188:191], v[68:71]
    s_waitcnt lgkmcnt(5)
    ds_read_b128 v[20:23], v9 offset:12288
    v_mfma_f32_16x16x32_bf16 v[68:71], v[40:43], v[196:199], v[68:71]
    ds_read_b128 v[24:27], v9 offset:21504
    v_mfma_f32_16x16x32_bf16 v[68:71], v[44:47], v[204:207], v[68:71]
    buffer_load_dwordx4 v3, s[8:11], s27 offen offset:2048 sc1 lds
    v_mfma_f32_16x16x32_bf16 v[104:107], v[44:47], v[208:211], v[104:107]
    ds_read_b128 v[28:31], v9 offset:30720
    v_mfma_f32_16x16x32_bf16 v[104:107], v[40:43], v[200:203], v[104:107]
    v_mfma_f32_16x16x32_bf16 v[104:107], v[36:39], v[192:195], v[104:107]
    v_mfma_f32_16x16x32_bf16 v[104:107], v[32:35], v[184:187], v[104:107]
    s_waitcnt lgkmcnt(6)
    ds_read_b128 v[32:35], v9 offset:4096
    ds_read_b128 v[36:39], v9 offset:13312
    v_mfma_f32_16x16x32_bf16 v[72:75], v[48:51], v[180:183], v[72:75]
    buffer_load_dwordx4 v3, s[8:11], s27 offen offset:3072 sc1 lds
    v_mfma_f32_16x16x32_bf16 v[72:75], v[52:55], v[188:191], v[72:75]
    s_waitcnt lgkmcnt(6)
    ds_read_b128 v[40:43], v9 offset:22528
    v_mfma_f32_16x16x32_bf16 v[72:75], v[56:59], v[196:199], v[72:75]
    s_add_u32 m0, s26, 4096
    v_mfma_f32_16x16x32_bf16 v[72:75], v[60:63], v[204:207], v[72:75]
    s_mov_b32 s27, 114688
    ds_read_b128 v[44:47], v9 offset:31744
    v_mfma_f32_16x16x32_bf16 v[108:111], v[60:63], v[208:211], v[108:111]
    buffer_load_dwordx4 v3, s[8:11], s27 offen offset:0 sc1 lds
    v_mfma_f32_16x16x32_bf16 v[108:111], v[56:59], v[200:203], v[108:111]
    v_mfma_f32_16x16x32_bf16 v[108:111], v[52:55], v[192:195], v[108:111]
    v_mfma_f32_16x16x32_bf16 v[108:111], v[48:51], v[184:187], v[108:111]
    s_waitcnt lgkmcnt(6)
    ds_read_b128 v[48:51], v9 offset:5120
    ds_read_b128 v[52:55], v9 offset:14336
    v_mfma_f32_16x16x32_bf16 v[76:79], v[16:19], v[180:183], v[76:79]
    ds_read_b128 v[56:59], v9 offset:23552
    buffer_load_dwordx4 v3, s[8:11], s27 offen offset:1024 sc1 lds
    v_mfma_f32_16x16x32_bf16 v[76:79], v[20:23], v[188:191], v[76:79]
    s_waitcnt lgkmcnt(7)
    ds_read_b128 v[60:63], v9 offset:32768
    v_mfma_f32_16x16x32_bf16 v[76:79], v[24:27], v[196:199], v[76:79]
    v_mfma_f32_16x16x32_bf16 v[76:79], v[28:31], v[204:207], v[76:79]
    v_mfma_f32_16x16x32_bf16 v[112:115], v[28:31], v[208:211], v[112:115]
    v_mfma_f32_16x16x32_bf16 v[112:115], v[24:27], v[200:203], v[112:115]
    buffer_load_dwordx4 v3, s[8:11], s27 offen offset:2048 sc1 lds
    v_mfma_f32_16x16x32_bf16 v[112:115], v[20:23], v[192:195], v[112:115]
    v_mfma_f32_16x16x32_bf16 v[112:115], v[16:19], v[184:187], v[112:115]
    s_waitcnt lgkmcnt(6)
    ds_read_b128 v[16:19], v9 offset:6144
    ds_read_b128 v[20:23], v9 offset:15360
    v_mfma_f32_16x16x32_bf16 v[80:83], v[32:35], v[180:183], v[80:83]
    ds_read_b128 v[24:27], v9 offset:24576
    ds_read_b128 v[28:31], v9 offset:33792
    v_mfma_f32_16x16x32_bf16 v[80:83], v[36:39], v[188:191], v[80:83]
    s_waitcnt lgkmcnt(8)
    buffer_load_dwordx4 v3, s[8:11], s27 offen offset:3072 sc1 lds
    v_mfma_f32_16x16x32_bf16 v[80:83], v[40:43], v[196:199], v[80:83]
    v_mfma_f32_16x16x32_bf16 v[80:83], v[44:47], v[204:207], v[80:83]
    s_add_u32 m0, s26, 8192
    v_mfma_f32_16x16x32_bf16 v[116:119], v[44:47], v[208:211], v[116:119]
    s_mov_b32 s27, 118784
    v_mfma_f32_16x16x32_bf16 v[116:119], v[40:43], v[200:203], v[116:119]
    v_mfma_f32_16x16x32_bf16 v[116:119], v[36:39], v[192:195], v[116:119]
    buffer_load_dwordx4 v3, s[8:11], s27 offen offset:0 sc1 lds
    v_mfma_f32_16x16x32_bf16 v[116:119], v[32:35], v[184:187], v[116:119]
    s_waitcnt lgkmcnt(6)
    ds_read_b128 v[32:35], v9 offset:7168
    ds_read_b128 v[36:39], v9 offset:16384
    v_mfma_f32_16x16x32_bf16 v[84:87], v[48:51], v[180:183], v[84:87]
    ds_read_b128 v[40:43], v9 offset:25600
    ds_read_b128 v[44:47], v9 offset:34816
    v_mfma_f32_16x16x32_bf16 v[84:87], v[52:55], v[188:191], v[84:87]
    s_waitcnt lgkmcnt(8)
    v_mfma_f32_16x16x32_bf16 v[84:87], v[56:59], v[196:199], v[84:87]
    buffer_load_dwordx4 a[64:67], v2, s[76:79], s44 offen offset:0 sc1
    v_mfma_f32_16x16x32_bf16 v[84:87], v[60:63], v[204:207], v[84:87]
    v_mfma_f32_16x16x32_bf16 v[120:123], v[60:63], v[208:211], v[120:123]
    v_mfma_f32_16x16x32_bf16 v[120:123], v[56:59], v[200:203], v[120:123]
    v_mfma_f32_16x16x32_bf16 v[120:123], v[52:55], v[192:195], v[120:123]
    buffer_load_dwordx4 a[68:71], v4, s[76:79], s44 offen offset:0 sc1
    v_mfma_f32_16x16x32_bf16 v[120:123], v[48:51], v[184:187], v[120:123]
    s_waitcnt lgkmcnt(6)
    ds_read_b128 v[48:51], v9 offset:8192
    ds_read_b128 v[52:55], v9 offset:17408
    v_mfma_f32_16x16x32_bf16 v[88:91], v[16:19], v[180:183], v[88:91]
    ds_read_b128 v[56:59], v9 offset:26624
    ds_read_b128 v[60:63], v9 offset:35840
    v_mfma_f32_16x16x32_bf16 v[88:91], v[20:23], v[188:191], v[88:91]
    s_waitcnt lgkmcnt(8)
    v_mfma_f32_16x16x32_bf16 v[88:91], v[24:27], v[196:199], v[88:91]
    v_mfma_f32_16x16x32_bf16 v[88:91], v[28:31], v[204:207], v[88:91]
    buffer_load_dwordx4 a[72:75], v2, s[76:79], s44 offen offset:1024 sc1
    v_mfma_f32_16x16x32_bf16 v[124:127], v[28:31], v[208:211], v[124:127]
    v_mfma_f32_16x16x32_bf16 v[124:127], v[24:27], v[200:203], v[124:127]
    v_mfma_f32_16x16x32_bf16 v[124:127], v[20:23], v[192:195], v[124:127]
    s_waitcnt vmcnt(20) lgkmcnt(0)
    v_mfma_f32_16x16x32_bf16 v[124:127], v[16:19], v[184:187], v[124:127]
    buffer_load_dwordx4 a[76:79], v4, s[76:79], s44 offen offset:1024 sc1
    v_mfma_f32_16x16x32_bf16 v[92:95], v[32:35], v[180:183], v[92:95]
    s_barrier
    v_mfma_f32_16x16x32_bf16 v[92:95], v[36:39], v[188:191], v[92:95]
    ds_read_b128 v[16:19], v10 offset:0
    v_mfma_f32_16x16x32_bf16 v[92:95], v[40:43], v[196:199], v[92:95]
    ds_read_b128 v[20:23], v10 offset:9216
    v_mfma_f32_16x16x32_bf16 v[92:95], v[44:47], v[204:207], v[92:95]
    ds_read_b128 v[24:27], v10 offset:18432
    v_mfma_f32_16x16x32_bf16 v[128:131], v[44:47], v[208:211], v[128:131]
    ds_read_b128 v[28:31], v10 offset:27648
    buffer_load_dwordx4 a[80:83], v2, s[76:79], s44 offen offset:2048 sc1
    v_mfma_f32_16x16x32_bf16 v[128:131], v[40:43], v[200:203], v[128:131]
    v_mfma_f32_16x16x32_bf16 v[128:131], v[36:39], v[192:195], v[128:131]
    v_mfma_f32_16x16x32_bf16 v[128:131], v[32:35], v[184:187], v[128:131]
    ds_read_b128 v[32:35], v10 offset:1024
    ds_read_b128 v[36:39], v10 offset:10240
    v_mfma_f32_16x16x32_bf16 v[96:99], v[48:51], v[180:183], v[96:99]
    ds_read_b128 v[40:43], v10 offset:19456
    ds_read_b128 v[44:47], v10 offset:28672
    v_mfma_f32_16x16x32_bf16 v[96:99], v[52:55], v[188:191], v[96:99]
    buffer_load_dwordx4 a[84:87], v4, s[76:79], s44 offen offset:2048 sc1
    v_mfma_f32_16x16x32_bf16 v[96:99], v[56:59], v[196:199], v[96:99]
    v_mfma_f32_16x16x32_bf16 v[96:99], v[60:63], v[204:207], v[96:99]
    v_mfma_f32_16x16x32_bf16 v[132:135], v[60:63], v[208:211], v[132:135]
    buffer_load_dwordx4 a[88:91], v2, s[76:79], s44 offen offset:3072 sc1
    v_mfma_f32_16x16x32_bf16 v[132:135], v[56:59], v[200:203], v[132:135]
    v_mfma_f32_16x16x32_bf16 v[132:135], v[52:55], v[192:195], v[132:135]
    v_mfma_f32_16x16x32_bf16 v[132:135], v[48:51], v[184:187], v[132:135]
    s_waitcnt lgkmcnt(6)
    v_mfma_f32_16x16x32_bf16 v[64:67], v[16:19], a[0:3], v[64:67]
    ds_read_b128 v[48:51], v10 offset:2048
    v_mfma_f32_16x16x32_bf16 v[64:67], v[20:23], a[8:11], v[64:67]
    s_waitcnt lgkmcnt(5)
    buffer_load_dwordx4 a[92:95], v4, s[76:79], s44 offen offset:3072 sc1
    v_mfma_f32_16x16x32_bf16 v[64:67], v[24:27], a[16:19], v[64:67]
    s_add_u32 m0, s26, 36864
    ds_read_b128 v[52:55], v10 offset:11264
    v_mfma_f32_16x16x32_bf16 v[64:67], v[28:31], a[24:27], v[64:67]
    s_mov_b32 s27, 147456
    v_mfma_f32_16x16x32_bf16 v[100:103], v[28:31], a[28:31], v[100:103]
    ds_read_b128 v[56:59], v10 offset:20480
    v_mfma_f32_16x16x32_bf16 v[100:103], v[24:27], a[20:23], v[100:103]
    ds_read_b128 v[60:63], v10 offset:29696
    buffer_load_dwordx4 v3, s[8:11], s27 offen offset:0 sc1 lds
    v_mfma_f32_16x16x32_bf16 v[100:103], v[20:23], a[12:15], v[100:103]
    v_mfma_f32_16x16x32_bf16 v[100:103], v[16:19], a[4:7], v[100:103]
    s_waitcnt lgkmcnt(6)
    ds_read_b128 v[16:19], v10 offset:3072
    v_mfma_f32_16x16x32_bf16 v[68:71], v[32:35], a[0:3], v[68:71]
    v_mfma_f32_16x16x32_bf16 v[68:71], v[36:39], a[8:11], v[68:71]
    s_waitcnt lgkmcnt(5)
    ds_read_b128 v[20:23], v10 offset:12288
    v_mfma_f32_16x16x32_bf16 v[68:71], v[40:43], a[16:19], v[68:71]
    ds_read_b128 v[24:27], v10 offset:21504
    buffer_load_dwordx4 v3, s[8:11], s27 offen offset:1024 sc1 lds
    v_mfma_f32_16x16x32_bf16 v[68:71], v[44:47], a[24:27], v[68:71]
    v_mfma_f32_16x16x32_bf16 v[104:107], v[44:47], a[28:31], v[104:107]
    ds_read_b128 v[28:31], v10 offset:30720
    v_mfma_f32_16x16x32_bf16 v[104:107], v[40:43], a[20:23], v[104:107]
    v_mfma_f32_16x16x32_bf16 v[104:107], v[36:39], a[12:15], v[104:107]
    buffer_load_dwordx4 v3, s[8:11], s27 offen offset:2048 sc1 lds
    v_mfma_f32_16x16x32_bf16 v[104:107], v[32:35], a[4:7], v[104:107]
    s_waitcnt lgkmcnt(6)
    ds_read_b128 v[32:35], v10 offset:4096
    ds_read_b128 v[36:39], v10 offset:13312
    v_mfma_f32_16x16x32_bf16 v[72:75], v[48:51], a[0:3], v[72:75]
    v_mfma_f32_16x16x32_bf16 v[72:75], v[52:55], a[8:11], v[72:75]
    s_waitcnt lgkmcnt(6)
    ds_read_b128 v[40:43], v10 offset:22528
    v_mfma_f32_16x16x32_bf16 v[72:75], v[56:59], a[16:19], v[72:75]
    buffer_load_dwordx4 v3, s[8:11], s27 offen offset:3072 sc1 lds
    v_mfma_f32_16x16x32_bf16 v[72:75], v[60:63], a[24:27], v[72:75]
    ds_read_b128 v[44:47], v10 offset:31744
    v_mfma_f32_16x16x32_bf16 v[108:111], v[60:63], a[28:31], v[108:111]
    s_add_u32 m0, s26, 40960
    v_mfma_f32_16x16x32_bf16 v[108:111], v[56:59], a[20:23], v[108:111]
    s_mov_b32 s27, 151552
    v_mfma_f32_16x16x32_bf16 v[108:111], v[52:55], a[12:15], v[108:111]
    v_mfma_f32_16x16x32_bf16 v[108:111], v[48:51], a[4:7], v[108:111]
    s_waitcnt lgkmcnt(6)
    ds_read_b128 v[48:51], v10 offset:5120
    ds_read_b128 v[52:55], v10 offset:14336
    v_mfma_f32_16x16x32_bf16 v[76:79], v[16:19], a[0:3], v[76:79]
    ds_read_b128 v[56:59], v10 offset:23552
    buffer_load_dwordx4 v3, s[8:11], s27 offen offset:0 sc1 lds
    v_mfma_f32_16x16x32_bf16 v[76:79], v[20:23], a[8:11], v[76:79]
    s_waitcnt lgkmcnt(7)
    ds_read_b128 v[60:63], v10 offset:32768
    v_mfma_f32_16x16x32_bf16 v[76:79], v[24:27], a[16:19], v[76:79]
    v_mfma_f32_16x16x32_bf16 v[76:79], v[28:31], a[24:27], v[76:79]
    buffer_load_dwordx4 v3, s[8:11], s27 offen offset:1024 sc1 lds
    v_mfma_f32_16x16x32_bf16 v[112:115], v[28:31], a[28:31], v[112:115]
    v_mfma_f32_16x16x32_bf16 v[112:115], v[24:27], a[20:23], v[112:115]
    v_mfma_f32_16x16x32_bf16 v[112:115], v[20:23], a[12:15], v[112:115]
    v_mfma_f32_16x16x32_bf16 v[112:115], v[16:19], a[4:7], v[112:115]
    s_waitcnt lgkmcnt(6)
    ds_read_b128 v[16:19], v10 offset:6144
    ds_read_b128 v[20:23], v10 offset:15360
    v_mfma_f32_16x16x32_bf16 v[80:83], v[32:35], a[0:3], v[80:83]
    ds_read_b128 v[24:27], v10 offset:24576
    ds_read_b128 v[28:31], v10 offset:33792
    v_mfma_f32_16x16x32_bf16 v[80:83], v[36:39], a[8:11], v[80:83]
    s_waitcnt lgkmcnt(8)
    buffer_load_dwordx4 v3, s[8:11], s27 offen offset:2048 sc1 lds
    v_mfma_f32_16x16x32_bf16 v[80:83], v[40:43], a[16:19], v[80:83]
    v_mfma_f32_16x16x32_bf16 v[80:83], v[44:47], a[24:27], v[80:83]
    v_mfma_f32_16x16x32_bf16 v[116:119], v[44:47], a[28:31], v[116:119]
    buffer_load_dwordx4 v3, s[8:11], s27 offen offset:3072 sc1 lds
    v_mfma_f32_16x16x32_bf16 v[116:119], v[40:43], a[20:23], v[116:119]
    s_add_u32 m0, s26, 45056
    v_mfma_f32_16x16x32_bf16 v[116:119], v[36:39], a[12:15], v[116:119]
    s_mov_b32 s27, 155648
    v_mfma_f32_16x16x32_bf16 v[116:119], v[32:35], a[4:7], v[116:119]
    s_waitcnt lgkmcnt(6)
    ds_read_b128 v[32:35], v10 offset:7168
    ds_read_b128 v[36:39], v10 offset:16384
    v_mfma_f32_16x16x32_bf16 v[84:87], v[48:51], a[0:3], v[84:87]
    ds_read_b128 v[40:43], v10 offset:25600
    ds_read_b128 v[44:47], v10 offset:34816
    v_mfma_f32_16x16x32_bf16 v[84:87], v[52:55], a[8:11], v[84:87]
    s_waitcnt lgkmcnt(8)
    buffer_load_dwordx4 v3, s[8:11], s27 offen offset:0 sc1 lds
    v_mfma_f32_16x16x32_bf16 v[84:87], v[56:59], a[16:19], v[84:87]
    v_mfma_f32_16x16x32_bf16 v[84:87], v[60:63], a[24:27], v[84:87]
    v_mfma_f32_16x16x32_bf16 v[120:123], v[60:63], a[28:31], v[120:123]
    v_mfma_f32_16x16x32_bf16 v[120:123], v[56:59], a[20:23], v[120:123]
    buffer_load_dword v5, v6, s[96:99], s39 offen sc1
    v_mfma_f32_16x16x32_bf16 v[120:123], v[52:55], a[12:15], v[120:123]
    v_mfma_f32_16x16x32_bf16 v[120:123], v[48:51], a[4:7], v[120:123]
    s_waitcnt lgkmcnt(6)
    ds_read_b128 v[48:51], v10 offset:8192
    ds_read_b128 v[52:55], v10 offset:17408
    v_mfma_f32_16x16x32_bf16 v[88:91], v[16:19], a[0:3], v[88:91]
    ds_read_b128 v[56:59], v10 offset:26624
    ds_read_b128 v[60:63], v10 offset:35840
    v_mfma_f32_16x16x32_bf16 v[88:91], v[20:23], a[8:11], v[88:91]
    s_waitcnt lgkmcnt(8)
    buffer_load_dwordx4 a[96:99], v2, s[76:79], s45 offen offset:0 sc1
    v_mfma_f32_16x16x32_bf16 v[88:91], v[24:27], a[16:19], v[88:91]
    v_mfma_f32_16x16x32_bf16 v[88:91], v[28:31], a[24:27], v[88:91]
    v_mfma_f32_16x16x32_bf16 v[124:127], v[28:31], a[28:31], v[124:127]
    v_mfma_f32_16x16x32_bf16 v[124:127], v[24:27], a[20:23], v[124:127]
    v_mfma_f32_16x16x32_bf16 v[124:127], v[20:23], a[12:15], v[124:127]
    s_waitcnt vmcnt(19) lgkmcnt(0)
    buffer_load_dwordx4 a[100:103], v4, s[76:79], s45 offen offset:0 sc1
    v_mfma_f32_16x16x32_bf16 v[124:127], v[16:19], a[4:7], v[124:127]
    v_mfma_f32_16x16x32_bf16 v[92:95], v[32:35], a[0:3], v[92:95]
    s_barrier
    v_mfma_f32_16x16x32_bf16 v[92:95], v[36:39], a[8:11], v[92:95]
    ds_read_b128 v[16:19], v2 offset:0
    v_mfma_f32_16x16x32_bf16 v[92:95], v[40:43], a[16:19], v[92:95]
    ds_read_b128 v[20:23], v2 offset:9216
    buffer_load_dwordx4 a[104:107], v2, s[76:79], s45 offen offset:1024 sc1
    v_mfma_f32_16x16x32_bf16 v[92:95], v[44:47], a[24:27], v[92:95]
    ds_read_b128 v[24:27], v2 offset:18432
    v_mfma_f32_16x16x32_bf16 v[128:131], v[44:47], a[28:31], v[128:131]
    ds_read_b128 v[28:31], v2 offset:27648
    v_mfma_f32_16x16x32_bf16 v[128:131], v[40:43], a[20:23], v[128:131]
    v_mfma_f32_16x16x32_bf16 v[128:131], v[36:39], a[12:15], v[128:131]
    buffer_load_dwordx4 a[108:111], v4, s[76:79], s45 offen offset:1024 sc1
    v_mfma_f32_16x16x32_bf16 v[128:131], v[32:35], a[4:7], v[128:131]
    ds_read_b128 v[32:35], v2 offset:1024
    ds_read_b128 v[36:39], v2 offset:10240
    v_mfma_f32_16x16x32_bf16 v[96:99], v[48:51], a[0:3], v[96:99]
    ds_read_b128 v[40:43], v2 offset:19456
    ds_read_b128 v[44:47], v2 offset:28672
    v_mfma_f32_16x16x32_bf16 v[96:99], v[52:55], a[8:11], v[96:99]
    v_mfma_f32_16x16x32_bf16 v[96:99], v[56:59], a[16:19], v[96:99]
    v_mfma_f32_16x16x32_bf16 v[96:99], v[60:63], a[24:27], v[96:99]
    buffer_load_dwordx4 a[112:115], v2, s[76:79], s45 offen offset:2048 sc1
    v_mfma_f32_16x16x32_bf16 v[132:135], v[60:63], a[28:31], v[132:135]
    v_mfma_f32_16x16x32_bf16 v[132:135], v[56:59], a[20:23], v[132:135]
    v_mfma_f32_16x16x32_bf16 v[132:135], v[52:55], a[12:15], v[132:135]
    v_mfma_f32_16x16x32_bf16 v[132:135], v[48:51], a[4:7], v[132:135]
    s_waitcnt lgkmcnt(6)
    buffer_load_dwordx4 a[116:119], v4, s[76:79], s45 offen offset:2048 sc1
    v_mfma_f32_16x16x32_bf16 v[64:67], v[16:19], a[32:35], v[64:67]
    ds_read_b128 v[48:51], v2 offset:2048
    v_mfma_f32_16x16x32_bf16 v[64:67], v[20:23], a[40:43], v[64:67]
    s_waitcnt lgkmcnt(5)
    v_mfma_f32_16x16x32_bf16 v[64:67], v[24:27], a[48:51], v[64:67]
    ds_read_b128 v[52:55], v2 offset:11264
    v_mfma_f32_16x16x32_bf16 v[64:67], v[28:31], a[56:59], v[64:67]
    v_mfma_f32_16x16x32_bf16 v[100:103], v[28:31], a[60:63], v[100:103]
    ds_read_b128 v[56:59], v2 offset:20480
    buffer_load_dwordx4 a[120:123], v2, s[76:79], s45 offen offset:3072 sc1
    v_mfma_f32_16x16x32_bf16 v[100:103], v[24:27], a[52:55], v[100:103]
    ds_read_b128 v[60:63], v2 offset:29696
    v_mfma_f32_16x16x32_bf16 v[100:103], v[20:23], a[44:47], v[100:103]
    v_mfma_f32_16x16x32_bf16 v[100:103], v[16:19], a[36:39], v[100:103]
    s_waitcnt lgkmcnt(6)
    ds_read_b128 v[16:19], v2 offset:3072
    v_mfma_f32_16x16x32_bf16 v[68:71], v[32:35], a[32:35], v[68:71]
    buffer_load_dwordx4 a[124:127], v4, s[76:79], s45 offen offset:3072 sc1
    v_mfma_f32_16x16x32_bf16 v[68:71], v[36:39], a[40:43], v[68:71]
    s_waitcnt lgkmcnt(5)
    ds_read_b128 v[20:23], v2 offset:12288
    v_mfma_f32_16x16x32_bf16 v[68:71], v[40:43], a[48:51], v[68:71]
    s_add_u32 m0, s26, 73728
    ds_read_b128 v[24:27], v2 offset:21504
    v_mfma_f32_16x16x32_bf16 v[68:71], v[44:47], a[56:59], v[68:71]
    s_mov_b32 s27, 184320
    v_mfma_f32_16x16x32_bf16 v[104:107], v[44:47], a[60:63], v[104:107]
    ds_read_b128 v[28:31], v2 offset:30720
    buffer_load_dwordx4 v3, s[8:11], s27 offen offset:0 sc1 lds
    v_mfma_f32_16x16x32_bf16 v[104:107], v[40:43], a[52:55], v[104:107]
    v_mfma_f32_16x16x32_bf16 v[104:107], v[36:39], a[44:47], v[104:107]
    v_mfma_f32_16x16x32_bf16 v[104:107], v[32:35], a[36:39], v[104:107]
    s_waitcnt lgkmcnt(6)
    ds_read_b128 v[32:35], v2 offset:4096
    ds_read_b128 v[36:39], v2 offset:13312
    v_mfma_f32_16x16x32_bf16 v[72:75], v[48:51], a[32:35], v[72:75]
    v_mfma_f32_16x16x32_bf16 v[72:75], v[52:55], a[40:43], v[72:75]
    s_waitcnt lgkmcnt(6)
    ds_read_b128 v[40:43], v2 offset:22528
    buffer_load_dwordx4 v3, s[8:11], s27 offen offset:1024 sc1 lds
    v_mfma_f32_16x16x32_bf16 v[72:75], v[56:59], a[48:51], v[72:75]
    v_mfma_f32_16x16x32_bf16 v[72:75], v[60:63], a[56:59], v[72:75]
    ds_read_b128 v[44:47], v2 offset:31744
    v_mfma_f32_16x16x32_bf16 v[108:111], v[60:63], a[60:63], v[108:111]
    v_mfma_f32_16x16x32_bf16 v[108:111], v[56:59], a[52:55], v[108:111]
    buffer_load_dwordx4 v3, s[8:11], s27 offen offset:2048 sc1 lds
    v_mfma_f32_16x16x32_bf16 v[108:111], v[52:55], a[44:47], v[108:111]
    v_mfma_f32_16x16x32_bf16 v[108:111], v[48:51], a[36:39], v[108:111]
    s_waitcnt lgkmcnt(6)
    ds_read_b128 v[48:51], v2 offset:5120
    ds_read_b128 v[52:55], v2 offset:14336
    v_mfma_f32_16x16x32_bf16 v[76:79], v[16:19], a[32:35], v[76:79]
    ds_read_b128 v[56:59], v2 offset:23552
    v_mfma_f32_16x16x32_bf16 v[76:79], v[20:23], a[40:43], v[76:79]
    s_waitcnt lgkmcnt(7)
    ds_read_b128 v[60:63], v2 offset:32768
    v_mfma_f32_16x16x32_bf16 v[76:79], v[24:27], a[48:51], v[76:79]
    buffer_load_dwordx4 v3, s[8:11], s27 offen offset:3072 sc1 lds
    v_mfma_f32_16x16x32_bf16 v[76:79], v[28:31], a[56:59], v[76:79]
    s_add_u32 m0, s26, 77824
    v_mfma_f32_16x16x32_bf16 v[112:115], v[28:31], a[60:63], v[112:115]
    s_mov_b32 s27, 188416
    v_mfma_f32_16x16x32_bf16 v[112:115], v[24:27], a[52:55], v[112:115]
    v_mfma_f32_16x16x32_bf16 v[112:115], v[20:23], a[44:47], v[112:115]
    buffer_load_dwordx4 v3, s[8:11], s27 offen offset:0 sc1 lds
    v_mfma_f32_16x16x32_bf16 v[112:115], v[16:19], a[36:39], v[112:115]
    s_waitcnt lgkmcnt(6)
    ds_read_b128 v[16:19], v2 offset:6144
    ds_read_b128 v[20:23], v2 offset:15360
    v_mfma_f32_16x16x32_bf16 v[80:83], v[32:35], a[32:35], v[80:83]
    ds_read_b128 v[24:27], v2 offset:24576
    ds_read_b128 v[28:31], v2 offset:33792
    v_mfma_f32_16x16x32_bf16 v[80:83], v[36:39], a[40:43], v[80:83]
    s_waitcnt lgkmcnt(8)
    v_mfma_f32_16x16x32_bf16 v[80:83], v[40:43], a[48:51], v[80:83]
    buffer_load_dwordx4 v3, s[8:11], s27 offen offset:1024 sc1 lds
    v_mfma_f32_16x16x32_bf16 v[80:83], v[44:47], a[56:59], v[80:83]
    v_mfma_f32_16x16x32_bf16 v[116:119], v[44:47], a[60:63], v[116:119]
    v_mfma_f32_16x16x32_bf16 v[116:119], v[40:43], a[52:55], v[116:119]
    v_mfma_f32_16x16x32_bf16 v[116:119], v[36:39], a[44:47], v[116:119]
    v_mfma_f32_16x16x32_bf16 v[116:119], v[32:35], a[36:39], v[116:119]
    s_waitcnt lgkmcnt(6)
    ds_read_b128 v[32:35], v2 offset:7168
    ds_read_b128 v[36:39], v2 offset:16384
    v_mfma_f32_16x16x32_bf16 v[84:87], v[48:51], a[32:35], v[84:87]
    ds_read_b128 v[40:43], v2 offset:25600
    ds_read_b128 v[44:47], v2 offset:34816
    v_mfma_f32_16x16x32_bf16 v[84:87], v[52:55], a[40:43], v[84:87]
    s_waitcnt lgkmcnt(8)
    buffer_load_dwordx4 v3, s[8:11], s27 offen offset:2048 sc1 lds
    v_mfma_f32_16x16x32_bf16 v[84:87], v[56:59], a[48:51], v[84:87]
    v_mfma_f32_16x16x32_bf16 v[84:87], v[60:63], a[56:59], v[84:87]
    buffer_load_dwordx4 v3, s[8:11], s27 offen offset:3072 sc1 lds
    v_mfma_f32_16x16x32_bf16 v[120:123], v[60:63], a[60:63], v[120:123]
    v_mfma_f32_16x16x32_bf16 v[120:123], v[56:59], a[52:55], v[120:123]
    s_add_u32 m0, s26, 81920
    v_mfma_f32_16x16x32_bf16 v[120:123], v[52:55], a[44:47], v[120:123]
    s_mov_b32 s27, 192512
    v_mfma_f32_16x16x32_bf16 v[120:123], v[48:51], a[36:39], v[120:123]
    s_waitcnt lgkmcnt(6)
    ds_read_b128 v[48:51], v2 offset:8192
    ds_read_b128 v[52:55], v2 offset:17408
    v_mfma_f32_16x16x32_bf16 v[88:91], v[16:19], a[32:35], v[88:91]
    ds_read_b128 v[56:59], v2 offset:26624
    ds_read_b128 v[60:63], v2 offset:35840
    v_mfma_f32_16x16x32_bf16 v[88:91], v[20:23], a[40:43], v[88:91]
    s_waitcnt lgkmcnt(8)
    buffer_load_dwordx4 v3, s[8:11], s27 offen offset:0 sc1 lds
    v_mfma_f32_16x16x32_bf16 v[88:91], v[24:27], a[48:51], v[88:91]
    s_waitcnt vmcnt(17)
    v_cmp_gt_u32 vcc, 8, v5
    s_nop 0
    s_cbranch_vccz CHK_mk_21
    v_mov_b32 v140, 0
    s_mov_b64 exec, 1
    s_mov_b32 s61, 200000
POLL_tmp_22:
    buffer_load_dword v141, v140, s[96:99], s39 offen sc1
    s_waitcnt vmcnt(0)
    v_cmp_gt_u32 vcc, 8, v141
    s_nop 0
    s_cbranch_vccz PDONE_tmp_23
    s_sub_u32 s61, s61, 1
    s_cmp_lg_u32 s61, 0
    s_cbranch_scc1 POLL_tmp_22
PDONE_tmp_23:
    s_mov_b64 exec, -1
CHK_mk_21:
    v_mfma_f32_16x16x32_bf16 v[88:91], v[28:31], a[56:59], v[88:91]
    v_mfma_f32_16x16x32_bf16 v[124:127], v[28:31], a[60:63], v[124:127]
    buffer_load_dwordx4 a[128:131], v2, s[76:79], s46 offen offset:0 sc1
    v_mfma_f32_16x16x32_bf16 v[124:127], v[24:27], a[52:55], v[124:127]
    v_mfma_f32_16x16x32_bf16 v[124:127], v[20:23], a[44:47], v[124:127]
    s_waitcnt lgkmcnt(0)
    v_mfma_f32_16x16x32_bf16 v[124:127], v[16:19], a[36:39], v[124:127]
    v_mfma_f32_16x16x32_bf16 v[92:95], v[32:35], a[32:35], v[92:95]
    s_barrier
    buffer_load_dwordx4 a[132:135], v4, s[76:79], s46 offen offset:0 sc1
    v_mfma_f32_16x16x32_bf16 v[92:95], v[36:39], a[40:43], v[92:95]
    ds_read_b128 v[16:19], v8 offset:0
    v_mfma_f32_16x16x32_bf16 v[92:95], v[40:43], a[48:51], v[92:95]
    ds_read_b128 v[20:23], v8 offset:9216
    v_mfma_f32_16x16x32_bf16 v[92:95], v[44:47], a[56:59], v[92:95]
    ds_read_b128 v[24:27], v8 offset:18432
    v_mfma_f32_16x16x32_bf16 v[128:131], v[44:47], a[60:63], v[128:131]
    ds_read_b128 v[28:31], v8 offset:27648
    v_mfma_f32_16x16x32_bf16 v[128:131], v[40:43], a[52:55], v[128:131]
    buffer_load_dwordx4 a[136:139], v2, s[76:79], s46 offen offset:1024 sc1
    v_mfma_f32_16x16x32_bf16 v[128:131], v[36:39], a[44:47], v[128:131]
    v_mfma_f32_16x16x32_bf16 v[128:131], v[32:35], a[36:39], v[128:131]
    ds_read_b128 v[32:35], v8 offset:1024
    ds_read_b128 v[36:39], v8 offset:10240
    v_mfma_f32_16x16x32_bf16 v[96:99], v[48:51], a[32:35], v[96:99]
    ds_read_b128 v[40:43], v8 offset:19456
    ds_read_b128 v[44:47], v8 offset:28672
    v_mfma_f32_16x16x32_bf16 v[96:99], v[52:55], a[40:43], v[96:99]
    buffer_load_dwordx4 a[140:143], v4, s[76:79], s46 offen offset:1024 sc1
    v_mfma_f32_16x16x32_bf16 v[96:99], v[56:59], a[48:51], v[96:99]
    v_mfma_f32_16x16x32_bf16 v[96:99], v[60:63], a[56:59], v[96:99]
    v_mfma_f32_16x16x32_bf16 v[132:135], v[60:63], a[60:63], v[132:135]
    v_mfma_f32_16x16x32_bf16 v[132:135], v[56:59], a[52:55], v[132:135]
    v_mfma_f32_16x16x32_bf16 v[132:135], v[52:55], a[44:47], v[132:135]
    buffer_load_dwordx4 a[144:147], v2, s[76:79], s46 offen offset:2048 sc1
    v_mfma_f32_16x16x32_bf16 v[132:135], v[48:51], a[36:39], v[132:135]
    s_waitcnt lgkmcnt(6)
    v_mfma_f32_16x16x32_bf16 v[64:67], v[16:19], a[64:67], v[64:67]
    ds_read_b128 v[48:51], v8 offset:2048
    v_mfma_f32_16x16x32_bf16 v[64:67], v[20:23], a[72:75], v[64:67]
    s_waitcnt lgkmcnt(5)
    v_mfma_f32_16x16x32_bf16 v[64:67], v[24:27], a[80:83], v[64:67]
    ds_read_b128 v[52:55], v8 offset:11264
    buffer_load_dwordx4 a[148:151], v4, s[76:79], s46 offen offset:2048 sc1
    v_mfma_f32_16x16x32_bf16 v[64:67], v[28:31], a[88:91], v[64:67]
    v_mfma_f32_16x16x32_bf16 v[100:103], v[28:31], a[92:95], v[100:103]
    ds_read_b128 v[56:59], v8 offset:20480
    v_mfma_f32_16x16x32_bf16 v[100:103], v[24:27], a[84:87], v[100:103]
    ds_read_b128 v[60:63], v8 offset:29696
    v_mfma_f32_16x16x32_bf16 v[100:103], v[20:23], a[76:79], v[100:103]
    buffer_load_dwordx4 a[152:155], v2, s[76:79], s46 offen offset:3072 sc1
    v_mfma_f32_16x16x32_bf16 v[100:103], v[16:19], a[68:71], v[100:103]
    s_waitcnt lgkmcnt(6)
    ds_read_b128 v[16:19], v8 offset:3072
    v_mfma_f32_16x16x32_bf16 v[68:71], v[32:35], a[64:67], v[68:71]
    v_mfma_f32_16x16x32_bf16 v[68:71], v[36:39], a[72:75], v[68:71]
    s_waitcnt lgkmcnt(5)
    ds_read_b128 v[20:23], v8 offset:12288
    v_mfma_f32_16x16x32_bf16 v[68:71], v[40:43], a[80:83], v[68:71]
    ds_read_b128 v[24:27], v8 offset:21504
    v_mfma_f32_16x16x32_bf16 v[68:71], v[44:47], a[88:91], v[68:71]
    buffer_load_dwordx4 a[156:159], v4, s[76:79], s46 offen offset:3072 sc1
    v_mfma_f32_16x16x32_bf16 v[104:107], v[44:47], a[92:95], v[104:107]
    s_add_u32 m0, s26, 110592
    ds_read_b128 v[28:31], v8 offset:30720
    v_mfma_f32_16x16x32_bf16 v[104:107], v[40:43], a[84:87], v[104:107]
    s_mov_b32 s27, 221184
    v_mfma_f32_16x16x32_bf16 v[104:107], v[36:39], a[76:79], v[104:107]
    v_mfma_f32_16x16x32_bf16 v[104:107], v[32:35], a[68:71], v[104:107]
    s_waitcnt lgkmcnt(6)
    ds_read_b128 v[32:35], v8 offset:4096
    ds_read_b128 v[36:39], v8 offset:13312
    v_mfma_f32_16x16x32_bf16 v[72:75], v[48:51], a[64:67], v[72:75]
    buffer_load_dwordx4 v3, s[8:11], s27 offen offset:0 sc1 lds
    v_mfma_f32_16x16x32_bf16 v[72:75], v[52:55], a[72:75], v[72:75]
    s_waitcnt lgkmcnt(6)
    ds_read_b128 v[40:43], v8 offset:22528
    v_mfma_f32_16x16x32_bf16 v[72:75], v[56:59], a[80:83], v[72:75]
    v_mfma_f32_16x16x32_bf16 v[72:75], v[60:63], a[88:91], v[72:75]
    ds_read_b128 v[44:47], v8 offset:31744
    buffer_load_dwordx4 v3, s[8:11], s27 offen offset:1024 sc1 lds
    v_mfma_f32_16x16x32_bf16 v[108:111], v[60:63], a[92:95], v[108:111]
    v_mfma_f32_16x16x32_bf16 v[108:111], v[56:59], a[84:87], v[108:111]
    v_mfma_f32_16x16x32_bf16 v[108:111], v[52:55], a[76:79], v[108:111]
    v_mfma_f32_16x16x32_bf16 v[108:111], v[48:51], a[68:71], v[108:111]
    s_waitcnt lgkmcnt(6)
    ds_read_b128 v[48:51], v8 offset:5120
    ds_read_b128 v[52:55], v8 offset:14336
    v_mfma_f32_16x16x32_bf16 v[76:79], v[16:19], a[64:67], v[76:79]
    ds_read_b128 v[56:59], v8 offset:23552
    buffer_load_dwordx4 v3, s[8:11], s27 offen offset:2048 sc1 lds
    v_mfma_f32_16x16x32_bf16 v[76:79], v[20:23], a[72:75], v[76:79]
    s_waitcnt lgkmcnt(7)
    ds_read_b128 v[60:63], v8 offset:32768
    v_mfma_f32_16x16x32_bf16 v[76:79], v[24:27], a[80:83], v[76:79]
    v_mfma_f32_16x16x32_bf16 v[76:79], v[28:31], a[88:91], v[76:79]
    v_mfma_f32_16x16x32_bf16 v[112:115], v[28:31], a[92:95], v[112:115]
    buffer_load_dwordx4 v3, s[8:11], s27 offen offset:3072 sc1 lds
    v_mfma_f32_16x16x32_bf16 v[112:115], v[24:27], a[84:87], v[112:115]
    v_mfma_f32_16x16x32_bf16 v[112:115], v[20:23], a[76:79], v[112:115]
    s_add_u32 m0, s26, 114688
    v_mfma_f32_16x16x32_bf16 v[112:115], v[16:19], a[68:71], v[112:115]
    s_waitcnt lgkmcnt(6)
    ds_read_b128 v[16:19], v8 offset:6144
    ds_read_b128 v[20:23], v8 offset:15360
    v_mfma_f32_16x16x32_bf16 v[80:83], v[32:35], a[64:67], v[80:83]
    ds_read_b128 v[24:27], v8 offset:24576
    ds_read_b128 v[28:31], v8 offset:33792
    v_mfma_f32_16x16x32_bf16 v[80:83], v[36:39], a[72:75], v[80:83]
    s_waitcnt lgkmcnt(8)
    v_mfma_f32_16x16x32_bf16 v[80:83], v[40:43], a[80:83], v[80:83]
    s_mov_b32 s27, 225280
    v_mfma_f32_16x16x32_bf16 v[80:83], v[44:47], a[88:91], v[80:83]
    buffer_load_dwordx4 v3, s[8:11], s27 offen offset:0 sc1 lds
    v_mfma_f32_16x16x32_bf16 v[116:119], v[44:47], a[92:95], v[116:119]
    v_mfma_f32_16x16x32_bf16 v[116:119], v[40:43], a[84:87], v[116:119]
    buffer_load_dwordx4 v3, s[8:11], s27 offen offset:1024 sc1 lds
    v_mfma_f32_16x16x32_bf16 v[116:119], v[36:39], a[76:79], v[116:119]
    v_mfma_f32_16x16x32_bf16 v[116:119], v[32:35], a[68:71], v[116:119]
    s_waitcnt lgkmcnt(6)
    ds_read_b128 v[32:35], v8 offset:7168
    ds_read_b128 v[36:39], v8 offset:16384
    v_mfma_f32_16x16x32_bf16 v[84:87], v[48:51], a[64:67], v[84:87]
    ds_read_b128 v[40:43], v8 offset:25600
    ds_read_b128 v[44:47], v8 offset:34816
    v_mfma_f32_16x16x32_bf16 v[84:87], v[52:55], a[72:75], v[84:87]
    s_waitcnt lgkmcnt(8)
    buffer_load_dwordx4 v3, s[8:11], s27 offen offset:2048 sc1 lds
    v_mfma_f32_16x16x32_bf16 v[84:87], v[56:59], a[80:83], v[84:87]
    v_mfma_f32_16x16x32_bf16 v[84:87], v[60:63], a[88:91], v[84:87]
    v_mfma_f32_16x16x32_bf16 v[120:123], v[60:63], a[92:95], v[120:123]
    v_mfma_f32_16x16x32_bf16 v[120:123], v[56:59], a[84:87], v[120:123]
    v_mfma_f32_16x16x32_bf16 v[120:123], v[52:55], a[76:79], v[120:123]
    buffer_load_dwordx4 v3, s[8:11], s27 offen offset:3072 sc1 lds
    v_mfma_f32_16x16x32_bf16 v[120:123], v[48:51], a[68:71], v[120:123]
    s_waitcnt lgkmcnt(6)
    ds_read_b128 v[48:51], v8 offset:8192
    ds_read_b128 v[52:55], v8 offset:17408
    v_mfma_f32_16x16x32_bf16 v[88:91], v[16:19], a[64:67], v[88:91]
    ds_read_b128 v[56:59], v8 offset:26624
    ds_read_b128 v[60:63], v8 offset:35840
    v_mfma_f32_16x16x32_bf16 v[88:91], v[20:23], a[72:75], v[88:91]
    s_waitcnt lgkmcnt(8)
    v_mfma_f32_16x16x32_bf16 v[88:91], v[24:27], a[80:83], v[88:91]
    s_add_u32 m0, s26, 118784
    v_mfma_f32_16x16x32_bf16 v[88:91], v[28:31], a[88:91], v[88:91]
    s_mov_b32 s27, 229376
    v_mfma_f32_16x16x32_bf16 v[124:127], v[28:31], a[92:95], v[124:127]
    buffer_load_dwordx4 v3, s[8:11], s27 offen offset:0 sc1 lds
    v_mfma_f32_16x16x32_bf16 v[124:127], v[24:27], a[84:87], v[124:127]
    v_mfma_f32_16x16x32_bf16 v[124:127], v[20:23], a[76:79], v[124:127]
    s_waitcnt vmcnt(17) lgkmcnt(0)
    v_mfma_f32_16x16x32_bf16 v[124:127], v[16:19], a[68:71], v[124:127]
    buffer_load_dwordx4 a[160:163], v2, s[76:79], s47 offen offset:0 sc1
    v_mfma_f32_16x16x32_bf16 v[92:95], v[32:35], a[64:67], v[92:95]
    s_barrier
    v_mfma_f32_16x16x32_bf16 v[92:95], v[36:39], a[72:75], v[92:95]
    ds_read_b128 v[16:19], v9 offset:0
    v_mfma_f32_16x16x32_bf16 v[92:95], v[40:43], a[80:83], v[92:95]
    ds_read_b128 v[20:23], v9 offset:9216
    v_mfma_f32_16x16x32_bf16 v[92:95], v[44:47], a[88:91], v[92:95]
    ds_read_b128 v[24:27], v9 offset:18432
    buffer_load_dwordx4 a[164:167], v4, s[76:79], s47 offen offset:0 sc1
    v_mfma_f32_16x16x32_bf16 v[128:131], v[44:47], a[92:95], v[128:131]
    ds_read_b128 v[28:31], v9 offset:27648
    v_mfma_f32_16x16x32_bf16 v[128:131], v[40:43], a[84:87], v[128:131]
    v_mfma_f32_16x16x32_bf16 v[128:131], v[36:39], a[76:79], v[128:131]
    v_mfma_f32_16x16x32_bf16 v[128:131], v[32:35], a[68:71], v[128:131]
    ds_read_b128 v[32:35], v9 offset:1024
    ds_read_b128 v[36:39], v9 offset:10240
    v_mfma_f32_16x16x32_bf16 v[96:99], v[48:51], a[64:67], v[96:99]
    ds_read_b128 v[40:43], v9 offset:19456
    ds_read_b128 v[44:47], v9 offset:28672
    v_mfma_f32_16x16x32_bf16 v[96:99], v[52:55], a[72:75], v[96:99]
    buffer_load_dwordx4 a[168:171], v2, s[76:79], s47 offen offset:1024 sc1
    v_mfma_f32_16x16x32_bf16 v[96:99], v[56:59], a[80:83], v[96:99]
    v_mfma_f32_16x16x32_bf16 v[96:99], v[60:63], a[88:91], v[96:99]
    v_mfma_f32_16x16x32_bf16 v[132:135], v[60:63], a[92:95], v[132:135]
    buffer_load_dwordx4 a[172:175], v4, s[76:79], s47 offen offset:1024 sc1
    v_mfma_f32_16x16x32_bf16 v[132:135], v[56:59], a[84:87], v[132:135]
    v_mfma_f32_16x16x32_bf16 v[132:135], v[52:55], a[76:79], v[132:135]
    v_mfma_f32_16x16x32_bf16 v[132:135], v[48:51], a[68:71], v[132:135]
    s_waitcnt lgkmcnt(6)
    v_mfma_f32_16x16x32_bf16 v[64:67], v[16:19], a[96:99], v[64:67]
    ds_read_b128 v[48:51], v9 offset:2048
    buffer_load_dwordx4 a[176:179], v2, s[76:79], s47 offen offset:2048 sc1
    v_mfma_f32_16x16x32_bf16 v[64:67], v[20:23], a[104:107], v[64:67]
    s_waitcnt lgkmcnt(5)
    v_mfma_f32_16x16x32_bf16 v[64:67], v[24:27], a[112:115], v[64:67]
    ds_read_b128 v[52:55], v9 offset:11264
    v_mfma_f32_16x16x32_bf16 v[64:67], v[28:31], a[120:123], v[64:67]
    v_mfma_f32_16x16x32_bf16 v[100:103], v[28:31], a[124:127], v[100:103]
    ds_read_b128 v[56:59], v9 offset:20480
    v_mfma_f32_16x16x32_bf16 v[100:103], v[24:27], a[116:119], v[100:103]
    ds_read_b128 v[60:63], v9 offset:29696
    buffer_load_dwordx4 a[180:183], v4, s[76:79], s47 offen offset:2048 sc1
    v_mfma_f32_16x16x32_bf16 v[100:103], v[20:23], a[108:111], v[100:103]
    v_mfma_f32_16x16x32_bf16 v[100:103], v[16:19], a[100:103], v[100:103]
    s_waitcnt lgkmcnt(6)
    ds_read_b128 v[16:19], v9 offset:3072
    v_mfma_f32_16x16x32_bf16 v[68:71], v[32:35], a[96:99], v[68:71]
    v_mfma_f32_16x16x32_bf16 v[68:71], v[36:39], a[104:107], v[68:71]
    s_waitcnt lgkmcnt(5)
    ds_read_b128 v[20:23], v9 offset:12288
    buffer_load_dwordx4 a[184:187], v2, s[76:79], s47 offen offset:3072 sc1
    v_mfma_f32_16x16x32_bf16 v[68:71], v[40:43], a[112:115], v[68:71]
    ds_read_b128 v[24:27], v9 offset:21504
    v_mfma_f32_16x16x32_bf16 v[68:71], v[44:47], a[120:123], v[68:71]
    v_mfma_f32_16x16x32_bf16 v[104:107], v[44:47], a[124:127], v[104:107]
    ds_read_b128 v[28:31], v9 offset:30720
    v_mfma_f32_16x16x32_bf16 v[104:107], v[40:43], a[116:119], v[104:107]
    buffer_load_dwordx4 a[188:191], v4, s[76:79], s47 offen offset:3072 sc1
    v_mfma_f32_16x16x32_bf16 v[104:107], v[36:39], a[108:111], v[104:107]
    v_mfma_f32_16x16x32_bf16 v[104:107], v[32:35], a[100:103], v[104:107]
    s_waitcnt lgkmcnt(6)
    ds_read_b128 v[32:35], v9 offset:4096
    ds_read_b128 v[36:39], v9 offset:13312
    v_mfma_f32_16x16x32_bf16 v[72:75], v[48:51], a[96:99], v[72:75]
    s_add_u32 m0, s26, 0
    v_mfma_f32_16x16x32_bf16 v[72:75], v[52:55], a[104:107], v[72:75]
    s_waitcnt lgkmcnt(6)
    ds_read_b128 v[40:43], v9 offset:22528
    v_mfma_f32_16x16x32_bf16 v[72:75], v[56:59], a[112:115], v[72:75]
    s_mov_b32 s27, 258048
    v_mfma_f32_16x16x32_bf16 v[72:75], v[60:63], a[120:123], v[72:75]
    ds_read_b128 v[44:47], v9 offset:31744
    buffer_load_dwordx4 v3, s[8:11], s27 offen offset:0 sc1 lds
    v_mfma_f32_16x16x32_bf16 v[108:111], v[60:63], a[124:127], v[108:111]
    v_mfma_f32_16x16x32_bf16 v[108:111], v[56:59], a[116:119], v[108:111]
    v_mfma_f32_16x16x32_bf16 v[108:111], v[52:55], a[108:111], v[108:111]
    buffer_load_dwordx4 v3, s[8:11], s27 offen offset:1024 sc1 lds
    v_mfma_f32_16x16x32_bf16 v[108:111], v[48:51], a[100:103], v[108:111]
    s_waitcnt lgkmcnt(6)
    ds_read_b128 v[48:51], v9 offset:5120
    ds_read_b128 v[52:55], v9 offset:14336
    v_mfma_f32_16x16x32_bf16 v[76:79], v[16:19], a[96:99], v[76:79]
    ds_read_b128 v[56:59], v9 offset:23552
    v_mfma_f32_16x16x32_bf16 v[76:79], v[20:23], a[104:107], v[76:79]
    s_waitcnt lgkmcnt(7)
    ds_read_b128 v[60:63], v9 offset:32768
    v_mfma_f32_16x16x32_bf16 v[76:79], v[24:27], a[112:115], v[76:79]
    v_mfma_f32_16x16x32_bf16 v[76:79], v[28:31], a[120:123], v[76:79]
    buffer_load_dwordx4 v3, s[8:11], s27 offen offset:2048 sc1 lds
    v_mfma_f32_16x16x32_bf16 v[112:115], v[28:31], a[124:127], v[112:115]
    v_mfma_f32_16x16x32_bf16 v[112:115], v[24:27], a[116:119], v[112:115]
    v_mfma_f32_16x16x32_bf16 v[112:115], v[20:23], a[108:111], v[112:115]
    v_mfma_f32_16x16x32_bf16 v[112:115], v[16:19], a[100:103], v[112:115]
    s_waitcnt lgkmcnt(6)
    ds_read_b128 v[16:19], v9 offset:6144
    ds_read_b128 v[20:23], v9 offset:15360
    v_mfma_f32_16x16x32_bf16 v[80:83], v[32:35], a[96:99], v[80:83]
    ds_read_b128 v[24:27], v9 offset:24576
    ds_read_b128 v[28:31], v9 offset:33792
    v_mfma_f32_16x16x32_bf16 v[80:83], v[36:39], a[104:107], v[80:83]
    s_waitcnt lgkmcnt(8)
    buffer_load_dwordx4 v3, s[8:11], s27 offen offset:3072 sc1 lds
    v_mfma_f32_16x16x32_bf16 v[80:83], v[40:43], a[112:115], v[80:83]
    s_add_u32 m0, s26, 4096
    v_mfma_f32_16x16x32_bf16 v[80:83], v[44:47], a[120:123], v[80:83]
    s_mov_b32 s27, 262144
    v_mfma_f32_16x16x32_bf16 v[116:119], v[44:47], a[124:127], v[116:119]
    buffer_load_dwordx4 v3, s[8:11], s27 offen offset:0 sc1 lds
    v_mfma_f32_16x16x32_bf16 v[116:119], v[40:43], a[116:119], v[116:119]
    v_mfma_f32_16x16x32_bf16 v[116:119], v[36:39], a[108:111], v[116:119]
    v_mfma_f32_16x16x32_bf16 v[116:119], v[32:35], a[100:103], v[116:119]
    s_waitcnt lgkmcnt(6)
    ds_read_b128 v[32:35], v9 offset:7168
    ds_read_b128 v[36:39], v9 offset:16384
    v_mfma_f32_16x16x32_bf16 v[84:87], v[48:51], a[96:99], v[84:87]
    ds_read_b128 v[40:43], v9 offset:25600
    ds_read_b128 v[44:47], v9 offset:34816
    v_mfma_f32_16x16x32_bf16 v[84:87], v[52:55], a[104:107], v[84:87]
    s_waitcnt lgkmcnt(8)
    buffer_load_dwordx4 v3, s[8:11], s27 offen offset:1024 sc1 lds
    v_mfma_f32_16x16x32_bf16 v[84:87], v[56:59], a[112:115], v[84:87]
    v_mfma_f32_16x16x32_bf16 v[84:87], v[60:63], a[120:123], v[84:87]
    v_mfma_f32_16x16x32_bf16 v[120:123], v[60:63], a[124:127], v[120:123]
    buffer_load_dwordx4 v3, s[8:11], s27 offen offset:2048 sc1 lds
    v_mfma_f32_16x16x32_bf16 v[120:123], v[56:59], a[116:119], v[120:123]
    v_mfma_f32_16x16x32_bf16 v[120:123], v[52:55], a[108:111], v[120:123]
    v_mfma_f32_16x16x32_bf16 v[120:123], v[48:51], a[100:103], v[120:123]
    s_waitcnt lgkmcnt(6)
    ds_read_b128 v[48:51], v9 offset:8192
    ds_read_b128 v[52:55], v9 offset:17408
    v_mfma_f32_16x16x32_bf16 v[88:91], v[16:19], a[96:99], v[88:91]
    ds_read_b128 v[56:59], v9 offset:26624
    ds_read_b128 v[60:63], v9 offset:35840
    v_mfma_f32_16x16x32_bf16 v[88:91], v[20:23], a[104:107], v[88:91]
    s_waitcnt lgkmcnt(8)
    buffer_load_dwordx4 v3, s[8:11], s27 offen offset:3072 sc1 lds
    v_mfma_f32_16x16x32_bf16 v[88:91], v[24:27], a[112:115], v[88:91]
    s_add_u32 m0, s26, 8192
    v_mfma_f32_16x16x32_bf16 v[88:91], v[28:31], a[120:123], v[88:91]
    s_mov_b32 s27, 266240
    v_mfma_f32_16x16x32_bf16 v[124:127], v[28:31], a[124:127], v[124:127]
    v_mfma_f32_16x16x32_bf16 v[124:127], v[24:27], a[116:119], v[124:127]
    buffer_load_dwordx4 v3, s[8:11], s27 offen offset:0 sc1 lds
    v_mfma_f32_16x16x32_bf16 v[124:127], v[20:23], a[108:111], v[124:127]
    s_waitcnt vmcnt(17) lgkmcnt(0)
    v_mfma_f32_16x16x32_bf16 v[124:127], v[16:19], a[100:103], v[124:127]
    v_mfma_f32_16x16x32_bf16 v[92:95], v[32:35], a[96:99], v[92:95]
    s_barrier
    v_mfma_f32_16x16x32_bf16 v[92:95], v[36:39], a[104:107], v[92:95]
    ds_read_b128 v[16:19], v10 offset:0
    buffer_load_dwordx4 a[192:195], v2, s[76:79], s48 offen offset:0 sc1
    v_mfma_f32_16x16x32_bf16 v[92:95], v[40:43], a[112:115], v[92:95]
    ds_read_b128 v[20:23], v10 offset:9216
    v_mfma_f32_16x16x32_bf16 v[92:95], v[44:47], a[120:123], v[92:95]
    ds_read_b128 v[24:27], v10 offset:18432
    v_mfma_f32_16x16x32_bf16 v[128:131], v[44:47], a[124:127], v[128:131]
    ds_read_b128 v[28:31], v10 offset:27648
    v_mfma_f32_16x16x32_bf16 v[128:131], v[40:43], a[116:119], v[128:131]
    v_mfma_f32_16x16x32_bf16 v[128:131], v[36:39], a[108:111], v[128:131]
    buffer_load_dwordx4 a[196:199], v4, s[76:79], s48 offen offset:0 sc1
    v_mfma_f32_16x16x32_bf16 v[128:131], v[32:35], a[100:103], v[128:131]
    ds_read_b128 v[32:35], v10 offset:1024
    ds_read_b128 v[36:39], v10 offset:10240
    v_mfma_f32_16x16x32_bf16 v[96:99], v[48:51], a[96:99], v[96:99]
    ds_read_b128 v[40:43], v10 offset:19456
    ds_read_b128 v[44:47], v10 offset:28672
    v_mfma_f32_16x16x32_bf16 v[96:99], v[52:55], a[104:107], v[96:99]
    v_mfma_f32_16x16x32_bf16 v[96:99], v[56:59], a[112:115], v[96:99]
    buffer_load_dwordx4 a[200:203], v2, s[76:79], s48 offen offset:1024 sc1
    v_mfma_f32_16x16x32_bf16 v[96:99], v[60:63], a[120:123], v[96:99]
    v_mfma_f32_16x16x32_bf16 v[132:135], v[60:63], a[124:127], v[132:135]
    v_mfma_f32_16x16x32_bf16 v[132:135], v[56:59], a[116:119], v[132:135]
    v_mfma_f32_16x16x32_bf16 v[132:135], v[52:55], a[108:111], v[132:135]
    v_mfma_f32_16x16x32_bf16 v[132:135], v[48:51], a[100:103], v[132:135]
    s_waitcnt lgkmcnt(6)
    buffer_load_dwordx4 a[204:207], v4, s[76:79], s48 offen offset:1024 sc1
    v_mfma_f32_16x16x32_bf16 v[64:67], v[16:19], a[128:131], v[64:67]
    ds_read_b128 v[48:51], v10 offset:2048
    v_mfma_f32_16x16x32_bf16 v[64:67], v[20:23], a[136:139], v[64:67]
    s_waitcnt lgkmcnt(5)
    v_mfma_f32_16x16x32_bf16 v[64:67], v[24:27], a[144:147], v[64:67]
    ds_read_b128 v[52:55], v10 offset:11264
    v_mfma_f32_16x16x32_bf16 v[64:67], v[28:31], a[152:155], v[64:67]
    buffer_load_dwordx4 a[208:211], v2, s[76:79], s48 offen offset:2048 sc1
    v_mfma_f32_16x16x32_bf16 v[100:103], v[28:31], a[156:159], v[100:103]
    ds_read_b128 v[56:59], v10 offset:20480
    v_mfma_f32_16x16x32_bf16 v[100:103], v[24:27], a[148:151], v[100:103]
    ds_read_b128 v[60:63], v10 offset:29696
    v_mfma_f32_16x16x32_bf16 v[100:103], v[20:23], a[140:143], v[100:103]
    v_mfma_f32_16x16x32_bf16 v[100:103], v[16:19], a[132:135], v[100:103]
    s_waitcnt lgkmcnt(6)
    ds_read_b128 v[16:19], v10 offset:3072
    buffer_load_dwordx4 a[212:215], v4, s[76:79], s48 offen offset:2048 sc1
    v_mfma_f32_16x16x32_bf16 v[68:71], v[32:35], a[128:131], v[68:71]
    v_mfma_f32_16x16x32_bf16 v[68:71], v[36:39], a[136:139], v[68:71]
    s_waitcnt lgkmcnt(5)
    ds_read_b128 v[20:23], v10 offset:12288
    v_mfma_f32_16x16x32_bf16 v[68:71], v[40:43], a[144:147], v[68:71]
    ds_read_b128 v[24:27], v10 offset:21504
    v_mfma_f32_16x16x32_bf16 v[68:71], v[44:47], a[152:155], v[68:71]
    v_mfma_f32_16x16x32_bf16 v[104:107], v[44:47], a[156:159], v[104:107]
    ds_read_b128 v[28:31], v10 offset:30720
    buffer_load_dwordx4 a[216:219], v2, s[76:79], s48 offen offset:3072 sc1
    v_mfma_f32_16x16x32_bf16 v[104:107], v[40:43], a[148:151], v[104:107]
    v_mfma_f32_16x16x32_bf16 v[104:107], v[36:39], a[140:143], v[104:107]
    v_mfma_f32_16x16x32_bf16 v[104:107], v[32:35], a[132:135], v[104:107]
    s_waitcnt lgkmcnt(6)
    ds_read_b128 v[32:35], v10 offset:4096
    ds_read_b128 v[36:39], v10 offset:13312
    v_mfma_f32_16x16x32_bf16 v[72:75], v[48:51], a[128:131], v[72:75]
    buffer_load_dwordx4 a[220:223], v4, s[76:79], s48 offen offset:3072 sc1
    v_mfma_f32_16x16x32_bf16 v[72:75], v[52:55], a[136:139], v[72:75]
    s_waitcnt lgkmcnt(6)
    ds_read_b128 v[40:43], v10 offset:22528
    v_mfma_f32_16x16x32_bf16 v[72:75], v[56:59], a[144:147], v[72:75]
    s_add_u32 m0, s26, 36864
    v_mfma_f32_16x16x32_bf16 v[72:75], v[60:63], a[152:155], v[72:75]
    s_mov_b32 s27, 294912
    ds_read_b128 v[44:47], v10 offset:31744
    v_mfma_f32_16x16x32_bf16 v[108:111], v[60:63], a[156:159], v[108:111]
    v_mfma_f32_16x16x32_bf16 v[108:111], v[56:59], a[148:151], v[108:111]
    buffer_load_dwordx4 v3, s[8:11], s27 offen offset:0 sc1 lds
    v_mfma_f32_16x16x32_bf16 v[108:111], v[52:55], a[140:143], v[108:111]
    v_mfma_f32_16x16x32_bf16 v[108:111], v[48:51], a[132:135], v[108:111]
    s_waitcnt lgkmcnt(6)
    ds_read_b128 v[48:51], v10 offset:5120
    ds_read_b128 v[52:55], v10 offset:14336
    v_mfma_f32_16x16x32_bf16 v[76:79], v[16:19], a[128:131], v[76:79]
    ds_read_b128 v[56:59], v10 offset:23552
    v_mfma_f32_16x16x32_bf16 v[76:79], v[20:23], a[136:139], v[76:79]
    s_waitcnt lgkmcnt(7)
    ds_read_b128 v[60:63], v10 offset:32768
    buffer_load_dwordx4 v3, s[8:11], s27 offen offset:1024 sc1 lds
    v_mfma_f32_16x16x32_bf16 v[76:79], v[24:27], a[144:147], v[76:79]
    v_mfma_f32_16x16x32_bf16 v[76:79], v[28:31], a[152:155], v[76:79]
    v_mfma_f32_16x16x32_bf16 v[112:115], v[28:31], a[156:159], v[112:115]
    v_mfma_f32_16x16x32_bf16 v[112:115], v[24:27], a[148:151], v[112:115]
    buffer_load_dwordx4 v3, s[8:11], s27 offen offset:2048 sc1 lds
    v_mfma_f32_16x16x32_bf16 v[112:115], v[20:23], a[140:143], v[112:115]
    v_mfma_f32_16x16x32_bf16 v[112:115], v[16:19], a[132:135], v[112:115]
    s_waitcnt lgkmcnt(6)
    ds_read_b128 v[16:19], v10 offset:6144
    ds_read_b128 v[20:23], v10 offset:15360
    v_mfma_f32_16x16x32_bf16 v[80:83], v[32:35], a[128:131], v[80:83]
    ds_read_b128 v[24:27], v10 offset:24576
    ds_read_b128 v[28:31], v10 offset:33792
    v_mfma_f32_16x16x32_bf16 v[80:83], v[36:39], a[136:139], v[80:83]
    s_waitcnt lgkmcnt(8)
    v_mfma_f32_16x16x32_bf16 v[80:83], v[40:43], a[144:147], v[80:83]
    buffer_load_dwordx4 v3, s[8:11], s27 offen offset:3072 sc1 lds
    v_mfma_f32_16x16x32_bf16 v[80:83], v[44:47], a[152:155], v[80:83]
    s_add_u32 m0, s26, 40960
    v_mfma_f32_16x16x32_bf16 v[116:119], v[44:47], a[156:159], v[116:119]
    s_mov_b32 s27, 299008
    v_mfma_f32_16x16x32_bf16 v[116:119], v[40:43], a[148:151], v[116:119]
    v_mfma_f32_16x16x32_bf16 v[116:119], v[36:39], a[140:143], v[116:119]
    buffer_load_dwordx4 v3, s[8:11], s27 offen offset:0 sc1 lds
    v_mfma_f32_16x16x32_bf16 v[116:119], v[32:35], a[132:135], v[116:119]
    s_waitcnt lgkmcnt(6)
    ds_read_b128 v[32:35], v10 offset:7168
    ds_read_b128 v[36:39], v10 offset:16384
    v_mfma_f32_16x16x32_bf16 v[84:87], v[48:51], a[128:131], v[84:87]
    ds_read_b128 v[40:43], v10 offset:25600
    ds_read_b128 v[44:47], v10 offset:34816
    v_mfma_f32_16x16x32_bf16 v[84:87], v[52:55], a[136:139], v[84:87]
    s_waitcnt lgkmcnt(8)
    v_mfma_f32_16x16x32_bf16 v[84:87], v[56:59], a[144:147], v[84:87]
    v_mfma_f32_16x16x32_bf16 v[84:87], v[60:63], a[152:155], v[84:87]
    buffer_load_dwordx4 v3, s[8:11], s27 offen offset:1024 sc1 lds
    v_mfma_f32_16x16x32_bf16 v[120:123], v[60:63], a[156:159], v[120:123]
    v_mfma_f32_16x16x32_bf16 v[120:123], v[56:59], a[148:151], v[120:123]
    v_mfma_f32_16x16x32_bf16 v[120:123], v[52:55], a[140:143], v[120:123]
    v_mfma_f32_16x16x32_bf16 v[120:123], v[48:51], a[132:135], v[120:123]
    s_waitcnt lgkmcnt(6)
    ds_read_b128 v[48:51], v10 offset:8192
    ds_read_b128 v[52:55], v10 offset:17408
    v_mfma_f32_16x16x32_bf16 v[88:91], v[16:19], a[128:131], v[88:91]
    ds_read_b128 v[56:59], v10 offset:26624
    ds_read_b128 v[60:63], v10 offset:35840
    v_mfma_f32_16x16x32_bf16 v[88:91], v[20:23], a[136:139], v[88:91]
    s_waitcnt lgkmcnt(8)
    buffer_load_dwordx4 v3, s[8:11], s27 offen offset:2048 sc1 lds
    v_mfma_f32_16x16x32_bf16 v[88:91], v[24:27], a[144:147], v[88:91]
    v_mfma_f32_16x16x32_bf16 v[88:91], v[28:31], a[152:155], v[88:91]
    buffer_load_dwordx4 v3, s[8:11], s27 offen offset:3072 sc1 lds
    v_mfma_f32_16x16x32_bf16 v[124:127], v[28:31], a[156:159], v[124:127]
    v_mfma_f32_16x16x32_bf16 v[124:127], v[24:27], a[148:151], v[124:127]
    s_add_u32 m0, s26, 45056
    v_mfma_f32_16x16x32_bf16 v[124:127], v[20:23], a[140:143], v[124:127]
    s_waitcnt vmcnt(16) lgkmcnt(0)
    v_mfma_f32_16x16x32_bf16 v[124:127], v[16:19], a[132:135], v[124:127]
    v_mfma_f32_16x16x32_bf16 v[92:95], v[32:35], a[128:131], v[92:95]
    s_barrier
    v_mfma_f32_16x16x32_bf16 v[92:95], v[36:39], a[136:139], v[92:95]
    ds_read_b128 v[16:19], v2 offset:0
    v_mfma_f32_16x16x32_bf16 v[92:95], v[40:43], a[144:147], v[92:95]
    s_mov_b32 s27, 303104
    ds_read_b128 v[20:23], v2 offset:9216
    v_mfma_f32_16x16x32_bf16 v[92:95], v[44:47], a[152:155], v[92:95]
    ds_read_b128 v[24:27], v2 offset:18432
    buffer_load_dwordx4 v3, s[8:11], s27 offen offset:0 sc1 lds
    v_mfma_f32_16x16x32_bf16 v[128:131], v[44:47], a[156:159], v[128:131]
    s_add_u32 m0, s29, 81920
    ds_read_b128 v[28:31], v2 offset:27648
    v_mfma_f32_16x16x32_bf16 v[128:131], v[40:43], a[148:151], v[128:131]
    buffer_load_dwordx4 v2, s[92:95], m0 offen offset:0 lds
    v_mfma_f32_16x16x32_bf16 v[128:131], v[36:39], a[140:143], v[128:131]
    v_mfma_f32_16x16x32_bf16 v[128:131], v[32:35], a[132:135], v[128:131]
    ds_read_b128 v[32:35], v2 offset:1024
    ds_read_b128 v[36:39], v2 offset:10240
    v_mfma_f32_16x16x32_bf16 v[96:99], v[48:51], a[128:131], v[96:99]
    ds_read_b128 v[40:43], v2 offset:19456
    ds_read_b128 v[44:47], v2 offset:28672
    v_mfma_f32_16x16x32_bf16 v[96:99], v[52:55], a[136:139], v[96:99]
    buffer_load_dwordx4 v2, s[92:95], m0 offen offset:1024 lds
    v_mfma_f32_16x16x32_bf16 v[96:99], v[56:59], a[144:147], v[96:99]
    v_mfma_f32_16x16x32_bf16 v[96:99], v[60:63], a[152:155], v[96:99]
    buffer_load_dwordx4 v2, s[92:95], m0 offen offset:2048 lds
    v_mfma_f32_16x16x32_bf16 v[132:135], v[60:63], a[156:159], v[132:135]
    v_mfma_f32_16x16x32_bf16 v[132:135], v[56:59], a[148:151], v[132:135]
    v_mfma_f32_16x16x32_bf16 v[132:135], v[52:55], a[140:143], v[132:135]
    v_mfma_f32_16x16x32_bf16 v[132:135], v[48:51], a[132:135], v[132:135]
    s_waitcnt lgkmcnt(6)
    buffer_load_dwordx4 v2, s[92:95], m0 offen offset:3072 lds
    v_mfma_f32_16x16x32_bf16 v[64:67], v[16:19], a[160:163], v[64:67]
    s_add_u32 m0, s29, 98304
    ds_read_b128 v[48:51], v2 offset:2048
    v_mfma_f32_16x16x32_bf16 v[64:67], v[20:23], a[168:171], v[64:67]
    s_waitcnt lgkmcnt(5)
    v_mfma_f32_16x16x32_bf16 v[64:67], v[24:27], a[176:179], v[64:67]
    ds_read_b128 v[52:55], v2 offset:11264
    buffer_load_dwordx4 v2, s[92:95], m0 offen offset:0 lds
    v_mfma_f32_16x16x32_bf16 v[64:67], v[28:31], a[184:187], v[64:67]
    v_mfma_f32_16x16x32_bf16 v[100:103], v[28:31], a[188:191], v[100:103]
    ds_read_b128 v[56:59], v2 offset:20480
    v_mfma_f32_16x16x32_bf16 v[100:103], v[24:27], a[180:183], v[100:103]
    ds_read_b128 v[60:63], v2 offset:29696
    v_mfma_f32_16x16x32_bf16 v[100:103], v[20:23], a[172:175], v[100:103]
    buffer_load_dwordx4 v2, s[92:95], m0 offen offset:1024 lds
    v_mfma_f32_16x16x32_bf16 v[100:103], v[16:19], a[164:167], v[100:103]
    s_waitcnt lgkmcnt(6)
    ds_read_b128 v[16:19], v2 offset:3072
    v_mfma_f32_16x16x32_bf16 v[68:71], v[32:35], a[160:163], v[68:71]
    v_mfma_f32_16x16x32_bf16 v[68:71], v[36:39], a[168:171], v[68:71]
    s_waitcnt lgkmcnt(5)
    ds_read_b128 v[20:23], v2 offset:12288
    buffer_load_dwordx4 v2, s[92:95], m0 offen offset:2048 lds
    v_mfma_f32_16x16x32_bf16 v[68:71], v[40:43], a[176:179], v[68:71]
    ds_read_b128 v[24:27], v2 offset:21504
    v_mfma_f32_16x16x32_bf16 v[68:71], v[44:47], a[184:187], v[68:71]
    v_mfma_f32_16x16x32_bf16 v[104:107], v[44:47], a[188:191], v[104:107]
    ds_read_b128 v[28:31], v2 offset:30720
    v_mfma_f32_16x16x32_bf16 v[104:107], v[40:43], a[180:183], v[104:107]
    buffer_load_dwordx4 v2, s[92:95], m0 offen offset:3072 lds
    v_mfma_f32_16x16x32_bf16 v[104:107], v[36:39], a[172:175], v[104:107]
    s_add_u32 m0, s29, 114688
    v_mfma_f32_16x16x32_bf16 v[104:107], v[32:35], a[164:167], v[104:107]
    s_waitcnt lgkmcnt(6)
    ds_read_b128 v[32:35], v2 offset:4096
    ds_read_b128 v[36:39], v2 offset:13312
    v_mfma_f32_16x16x32_bf16 v[72:75], v[48:51], a[160:163], v[72:75]
    buffer_load_dwordx4 v2, s[92:95], m0 offen offset:0 lds
    v_mfma_f32_16x16x32_bf16 v[72:75], v[52:55], a[168:171], v[72:75]
    s_waitcnt lgkmcnt(6)
    ds_read_b128 v[40:43], v2 offset:22528
    v_mfma_f32_16x16x32_bf16 v[72:75], v[56:59], a[176:179], v[72:75]
    v_mfma_f32_16x16x32_bf16 v[72:75], v[60:63], a[184:187], v[72:75]
    ds_read_b128 v[44:47], v2 offset:31744
    v_mfma_f32_16x16x32_bf16 v[108:111], v[60:63], a[188:191], v[108:111]
    buffer_load_dwordx4 v2, s[92:95], m0 offen offset:1024 lds
    v_mfma_f32_16x16x32_bf16 v[108:111], v[56:59], a[180:183], v[108:111]
    v_mfma_f32_16x16x32_bf16 v[108:111], v[52:55], a[172:175], v[108:111]
    v_mfma_f32_16x16x32_bf16 v[108:111], v[48:51], a[164:167], v[108:111]
    s_waitcnt lgkmcnt(6)
    ds_read_b128 v[48:51], v2 offset:5120
    ds_read_b128 v[52:55], v2 offset:14336
    v_mfma_f32_16x16x32_bf16 v[76:79], v[16:19], a[160:163], v[76:79]
    ds_read_b128 v[56:59], v2 offset:23552
    buffer_load_dwordx4 v2, s[92:95], m0 offen offset:2048 lds
    v_mfma_f32_16x16x32_bf16 v[76:79], v[20:23], a[168:171], v[76:79]
    s_waitcnt lgkmcnt(7)
    ds_read_b128 v[60:63], v2 offset:32768
    v_mfma_f32_16x16x32_bf16 v[76:79], v[24:27], a[176:179], v[76:79]
    v_mfma_f32_16x16x32_bf16 v[76:79], v[28:31], a[184:187], v[76:79]
    buffer_load_dwordx4 v2, s[92:95], m0 offen offset:3072 lds
    v_mfma_f32_16x16x32_bf16 v[112:115], v[28:31], a[188:191], v[112:115]
    s_add_u32 m0, s29, 0
    v_mfma_f32_16x16x32_bf16 v[112:115], v[24:27], a[180:183], v[112:115]
    v_mfma_f32_16x16x32_bf16 v[112:115], v[20:23], a[172:175], v[112:115]
    v_mfma_f32_16x16x32_bf16 v[112:115], v[16:19], a[164:167], v[112:115]
    s_waitcnt lgkmcnt(6)
    ds_read_b128 v[16:19], v2 offset:6144
    ds_read_b128 v[20:23], v2 offset:15360
    v_mfma_f32_16x16x32_bf16 v[80:83], v[32:35], a[160:163], v[80:83]
    ds_read_b128 v[24:27], v2 offset:24576
    ds_read_b128 v[28:31], v2 offset:33792
    v_mfma_f32_16x16x32_bf16 v[80:83], v[36:39], a[168:171], v[80:83]
    s_waitcnt lgkmcnt(8)
    v_mfma_f32_16x16x32_bf16 v[80:83], v[40:43], a[176:179], v[80:83]
    v_mfma_f32_16x16x32_bf16 v[80:83], v[44:47], a[184:187], v[80:83]
    v_mfma_f32_16x16x32_bf16 v[116:119], v[44:47], a[188:191], v[116:119]
    v_mfma_f32_16x16x32_bf16 v[116:119], v[40:43], a[180:183], v[116:119]
    v_mfma_f32_16x16x32_bf16 v[116:119], v[36:39], a[172:175], v[116:119]
    v_mfma_f32_16x16x32_bf16 v[116:119], v[32:35], a[164:167], v[116:119]
    s_waitcnt lgkmcnt(6)
    ds_read_b128 v[32:35], v2 offset:7168
    ds_read_b128 v[36:39], v2 offset:16384
    v_mfma_f32_16x16x32_bf16 v[84:87], v[48:51], a[160:163], v[84:87]
    ds_read_b128 v[40:43], v2 offset:25600
    ds_read_b128 v[44:47], v2 offset:34816
    v_mfma_f32_16x16x32_bf16 v[84:87], v[52:55], a[168:171], v[84:87]
    s_waitcnt lgkmcnt(8)
    v_mfma_f32_16x16x32_bf16 v[84:87], v[56:59], a[176:179], v[84:87]
    v_mfma_f32_16x16x32_bf16 v[84:87], v[60:63], a[184:187], v[84:87]
    v_mfma_f32_16x16x32_bf16 v[120:123], v[60:63], a[188:191], v[120:123]
    v_mfma_f32_16x16x32_bf16 v[120:123], v[56:59], a[180:183], v[120:123]
    v_mfma_f32_16x16x32_bf16 v[120:123], v[52:55], a[172:175], v[120:123]
    v_mfma_f32_16x16x32_bf16 v[120:123], v[48:51], a[164:167], v[120:123]
    s_waitcnt lgkmcnt(6)
    ds_read_b128 v[48:51], v2 offset:8192
    ds_read_b128 v[52:55], v2 offset:17408
    v_mfma_f32_16x16x32_bf16 v[88:91], v[16:19], a[160:163], v[88:91]
    ds_read_b128 v[56:59], v2 offset:26624
    ds_read_b128 v[60:63], v2 offset:35840
    v_mfma_f32_16x16x32_bf16 v[88:91], v[20:23], a[168:171], v[88:91]
    s_waitcnt lgkmcnt(8)
    v_mfma_f32_16x16x32_bf16 v[88:91], v[24:27], a[176:179], v[88:91]
    v_mfma_f32_16x16x32_bf16 v[88:91], v[28:31], a[184:187], v[88:91]
    v_mfma_f32_16x16x32_bf16 v[124:127], v[28:31], a[188:191], v[124:127]
    v_mfma_f32_16x16x32_bf16 v[124:127], v[24:27], a[180:183], v[124:127]
    v_mfma_f32_16x16x32_bf16 v[124:127], v[20:23], a[172:175], v[124:127]
    s_waitcnt vmcnt(12) lgkmcnt(0)
    v_mfma_f32_16x16x32_bf16 v[124:127], v[16:19], a[164:167], v[124:127]
    v_mfma_f32_16x16x32_bf16 v[92:95], v[32:35], a[160:163], v[92:95]
    s_barrier
    v_mfma_f32_16x16x32_bf16 v[92:95], v[36:39], a[168:171], v[92:95]
    ds_read_b128 v[16:19], v8 offset:0
    buffer_load_dwordx4 v2, s[92:95], m0 offen offset:0 lds
    v_mfma_f32_16x16x32_bf16 v[92:95], v[40:43], a[176:179], v[92:95]
    ds_read_b128 v[20:23], v8 offset:9216
    buffer_load_dwordx4 v2, s[92:95], m0 offen offset:1024 lds
    v_mfma_f32_16x16x32_bf16 v[92:95], v[44:47], a[184:187], v[92:95]
    ds_read_b128 v[24:27], v8 offset:18432
    v_mfma_f32_16x16x32_bf16 v[128:131], v[44:47], a[188:191], v[128:131]
    ds_read_b128 v[28:31], v8 offset:27648
    v_mfma_f32_16x16x32_bf16 v[128:131], v[40:43], a[180:183], v[128:131]
    buffer_load_dwordx4 v2, s[92:95], m0 offen offset:2048 lds
    v_mfma_f32_16x16x32_bf16 v[128:131], v[36:39], a[172:175], v[128:131]
    v_mfma_f32_16x16x32_bf16 v[128:131], v[32:35], a[164:167], v[128:131]
    ds_read_b128 v[32:35], v8 offset:1024
    ds_read_b128 v[36:39], v8 offset:10240
    v_mfma_f32_16x16x32_bf16 v[96:99], v[48:51], a[160:163], v[96:99]
    ds_read_b128 v[40:43], v8 offset:19456
    ds_read_b128 v[44:47], v8 offset:28672
    v_mfma_f32_16x16x32_bf16 v[96:99], v[52:55], a[168:171], v[96:99]
    buffer_load_dwordx4 v2, s[92:95], m0 offen offset:3072 lds
    v_mfma_f32_16x16x32_bf16 v[96:99], v[56:59], a[176:179], v[96:99]
    s_add_u32 m0, s29, 16384
    v_mfma_f32_16x16x32_bf16 v[96:99], v[60:63], a[184:187], v[96:99]
    v_mfma_f32_16x16x32_bf16 v[132:135], v[60:63], a[188:191], v[132:135]
    buffer_load_dwordx4 v2, s[92:95], m0 offen offset:0 lds
    v_mfma_f32_16x16x32_bf16 v[132:135], v[56:59], a[180:183], v[132:135]
    v_mfma_f32_16x16x32_bf16 v[132:135], v[52:55], a[172:175], v[132:135]
    v_mfma_f32_16x16x32_bf16 v[132:135], v[48:51], a[164:167], v[132:135]
    s_waitcnt lgkmcnt(6)
    v_mfma_f32_16x16x32_bf16 v[64:67], v[16:19], a[192:195], v[64:67]
    ds_read_b128 v[48:51], v8 offset:2048
    buffer_load_dwordx4 v2, s[92:95], m0 offen offset:1024 lds
    v_mfma_f32_16x16x32_bf16 v[64:67], v[20:23], a[200:203], v[64:67]
    s_waitcnt lgkmcnt(5)
    v_mfma_f32_16x16x32_bf16 v[64:67], v[24:27], a[208:211], v[64:67]
    ds_read_b128 v[52:55], v8 offset:11264
    v_mfma_f32_16x16x32_bf16 v[64:67], v[28:31], a[216:219], v[64:67]
    buffer_load_dwordx4 v2, s[92:95], m0 offen offset:2048 lds
    v_mfma_f32_16x16x32_bf16 v[100:103], v[28:31], a[220:223], v[100:103]
    ds_read_b128 v[56:59], v8 offset:20480
    v_mfma_f32_16x16x32_bf16 v[100:103], v[24:27], a[212:215], v[100:103]
    ds_read_b128 v[60:63], v8 offset:29696
    v_mfma_f32_16x16x32_bf16 v[100:103], v[20:23], a[204:207], v[100:103]
    v_mfma_f32_16x16x32_bf16 v[100:103], v[16:19], a[196:199], v[100:103]
    s_waitcnt lgkmcnt(6)
    ds_read_b128 v[16:19], v8 offset:3072
    buffer_load_dwordx4 v2, s[92:95], m0 offen offset:3072 lds
    v_mfma_f32_16x16x32_bf16 v[68:71], v[32:35], a[192:195], v[68:71]
    v_mfma_f32_16x16x32_bf16 v[68:71], v[36:39], a[200:203], v[68:71]
    s_waitcnt lgkmcnt(5)
    ds_read_b128 v[20:23], v8 offset:12288
    v_mfma_f32_16x16x32_bf16 v[68:71], v[40:43], a[208:211], v[68:71]
    ds_read_b128 v[24:27], v8 offset:21504
    v_mfma_f32_16x16x32_bf16 v[68:71], v[44:47], a[216:219], v[68:71]
    v_cvt_pk_bf16_f32 v212, v64, v65
    v_cvt_pk_bf16_f32 v213, v66, v67
    v_mfma_f32_16x16x32_bf16 v[104:107], v[44:47], a[220:223], v[104:107]
    ds_read_b128 v[28:31], v8 offset:30720
    v_cvt_pk_bf16_f32 v214, v100, v101
    v_mfma_f32_16x16x32_bf16 v[104:107], v[40:43], a[212:215], v[104:107]
    v_cvt_pk_bf16_f32 v215, v102, v103
    v_mfma_f32_16x16x32_bf16 v[104:107], v[36:39], a[204:207], v[104:107]
    v_mfma_f32_16x16x32_bf16 v[104:107], v[32:35], a[196:199], v[104:107]
    s_waitcnt lgkmcnt(6)
    ds_read_b128 v[32:35], v8 offset:4096
    ds_read_b128 v[36:39], v8 offset:13312
    v_mfma_f32_16x16x32_bf16 v[72:75], v[48:51], a[192:195], v[72:75]
    v_permlane32_swap_b32 v212, v214
    v_mfma_f32_16x16x32_bf16 v[72:75], v[52:55], a[200:203], v[72:75]
    s_waitcnt lgkmcnt(6)
    ds_read_b128 v[40:43], v8 offset:22528
    v_permlane32_swap_b32 v213, v215
    v_mfma_f32_16x16x32_bf16 v[72:75], v[56:59], a[208:211], v[72:75]
    buffer_store_dwordx4 v[212:215], v13, s[16:19], 0 offen offset:0 sc1
    v_mfma_f32_16x16x32_bf16 v[72:75], v[60:63], a[216:219], v[72:75]
    ds_read_b128 v[44:47], v8 offset:31744
    v_cvt_pk_bf16_f32 v216, v68, v69
    v_mfma_f32_16x16x32_bf16 v[108:111], v[60:63], a[220:223], v[108:111]
    v_cvt_pk_bf16_f32 v217, v70, v71
    v_cvt_pk_bf16_f32 v218, v104, v105
    v_mfma_f32_16x16x32_bf16 v[108:111], v[56:59], a[212:215], v[108:111]
    v_cvt_pk_bf16_f32 v219, v106, v107
    v_mfma_f32_16x16x32_bf16 v[108:111], v[52:55], a[204:207], v[108:111]
    v_mfma_f32_16x16x32_bf16 v[108:111], v[48:51], a[196:199], v[108:111]
    s_waitcnt lgkmcnt(6)
    ds_read_b128 v[48:51], v8 offset:5120
    ds_read_b128 v[52:55], v8 offset:14336
    v_mfma_f32_16x16x32_bf16 v[76:79], v[16:19], a[192:195], v[76:79]
    ds_read_b128 v[56:59], v8 offset:23552
    v_permlane32_swap_b32 v216, v218
    v_mfma_f32_16x16x32_bf16 v[76:79], v[20:23], a[200:203], v[76:79]
    s_waitcnt lgkmcnt(7)
    ds_read_b128 v[60:63], v8 offset:32768
    v_permlane32_swap_b32 v217, v219
    v_mfma_f32_16x16x32_bf16 v[76:79], v[24:27], a[208:211], v[76:79]
    buffer_store_dwordx4 v[216:219], v13, s[16:19], 0 offen offset:512 sc1
    v_mfma_f32_16x16x32_bf16 v[76:79], v[28:31], a[216:219], v[76:79]
    v_cvt_pk_bf16_f32 v220, v72, v73
    v_cvt_pk_bf16_f32 v221, v74, v75
    v_mfma_f32_16x16x32_bf16 v[112:115], v[28:31], a[220:223], v[112:115]
    v_cvt_pk_bf16_f32 v222, v108, v109
    v_cvt_pk_bf16_f32 v223, v110, v111
    v_mfma_f32_16x16x32_bf16 v[112:115], v[24:27], a[212:215], v[112:115]
    v_mfma_f32_16x16x32_bf16 v[112:115], v[20:23], a[204:207], v[112:115]
    v_permlane32_swap_b32 v220, v222
    v_mfma_f32_16x16x32_bf16 v[112:115], v[16:19], a[196:199], v[112:115]
    s_waitcnt lgkmcnt(6)
    ds_read_b128 v[16:19], v8 offset:6144
    ds_read_b128 v[20:23], v8 offset:15360
    v_mfma_f32_16x16x32_bf16 v[80:83], v[32:35], a[192:195], v[80:83]
    ds_read_b128 v[24:27], v8 offset:24576
    ds_read_b128 v[28:31], v8 offset:33792
    v_mfma_f32_16x16x32_bf16 v[80:83], v[36:39], a[200:203], v[80:83]
    s_waitcnt lgkmcnt(8)
    v_permlane32_swap_b32 v221, v223
    v_mfma_f32_16x16x32_bf16 v[80:83], v[40:43], a[208:211], v[80:83]
    buffer_store_dwordx4 v[220:223], v13, s[16:19], 0 offen offset:1024 sc1
    v_mfma_f32_16x16x32_bf16 v[80:83], v[44:47], a[216:219], v[80:83]
    v_cvt_pk_bf16_f32 v224, v76, v77
    v_cvt_pk_bf16_f32 v225, v78, v79
    v_mfma_f32_16x16x32_bf16 v[116:119], v[44:47], a[220:223], v[116:119]
    v_cvt_pk_bf16_f32 v226, v112, v113
    v_cvt_pk_bf16_f32 v227, v114, v115
    v_mfma_f32_16x16x32_bf16 v[116:119], v[40:43], a[212:215], v[116:119]
    v_mfma_f32_16x16x32_bf16 v[116:119], v[36:39], a[204:207], v[116:119]
    v_permlane32_swap_b32 v224, v226
    v_mfma_f32_16x16x32_bf16 v[116:119], v[32:35], a[196:199], v[116:119]
    s_waitcnt lgkmcnt(6)
    ds_read_b128 v[32:35], v8 offset:7168
    ds_read_b128 v[36:39], v8 offset:16384
    v_mfma_f32_16x16x32_bf16 v[84:87], v[48:51], a[192:195], v[84:87]
    ds_read_b128 v[40:43], v8 offset:25600
    ds_read_b128 v[44:47], v8 offset:34816
    v_mfma_f32_16x16x32_bf16 v[84:87], v[52:55], a[200:203], v[84:87]
    s_waitcnt lgkmcnt(8)
    v_permlane32_swap_b32 v225, v227
    v_mfma_f32_16x16x32_bf16 v[84:87], v[56:59], a[208:211], v[84:87]
    buffer_store_dwordx4 v[224:227], v13, s[16:19], 0 offen offset:1536 sc1
    v_mfma_f32_16x16x32_bf16 v[84:87], v[60:63], a[216:219], v[84:87]
    v_cvt_pk_bf16_f32 v228, v80, v81
    v_cvt_pk_bf16_f32 v229, v82, v83
    v_mfma_f32_16x16x32_bf16 v[120:123], v[60:63], a[220:223], v[120:123]
    v_cvt_pk_bf16_f32 v230, v116, v117
    v_cvt_pk_bf16_f32 v231, v118, v119
    v_mfma_f32_16x16x32_bf16 v[120:123], v[56:59], a[212:215], v[120:123]
    v_mfma_f32_16x16x32_bf16 v[120:123], v[52:55], a[204:207], v[120:123]
    v_permlane32_swap_b32 v228, v230
    v_mfma_f32_16x16x32_bf16 v[120:123], v[48:51], a[196:199], v[120:123]
    s_waitcnt lgkmcnt(6)
    ds_read_b128 v[48:51], v8 offset:8192
    ds_read_b128 v[52:55], v8 offset:17408
    v_mfma_f32_16x16x32_bf16 v[88:91], v[16:19], a[192:195], v[88:91]
    ds_read_b128 v[56:59], v8 offset:26624
    ds_read_b128 v[60:63], v8 offset:35840
    v_mfma_f32_16x16x32_bf16 v[88:91], v[20:23], a[200:203], v[88:91]
    s_waitcnt lgkmcnt(8)
    v_permlane32_swap_b32 v229, v231
    v_mfma_f32_16x16x32_bf16 v[88:91], v[24:27], a[208:211], v[88:91]
    buffer_store_dwordx4 v[228:231], v13, s[16:19], 0 offen offset:2048 sc1
    v_mfma_f32_16x16x32_bf16 v[88:91], v[28:31], a[216:219], v[88:91]
    v_cvt_pk_bf16_f32 v232, v84, v85
    v_cvt_pk_bf16_f32 v233, v86, v87
    v_mfma_f32_16x16x32_bf16 v[124:127], v[28:31], a[220:223], v[124:127]
    v_cvt_pk_bf16_f32 v234, v120, v121
    v_cvt_pk_bf16_f32 v235, v122, v123
    v_mfma_f32_16x16x32_bf16 v[124:127], v[24:27], a[212:215], v[124:127]
    v_mfma_f32_16x16x32_bf16 v[124:127], v[20:23], a[204:207], v[124:127]
    v_permlane32_swap_b32 v232, v234
    v_mfma_f32_16x16x32_bf16 v[124:127], v[16:19], a[196:199], v[124:127]
    s_waitcnt lgkmcnt(6)
    v_permlane32_swap_b32 v233, v235
    v_mfma_f32_16x16x32_bf16 v[92:95], v[32:35], a[192:195], v[92:95]
    buffer_store_dwordx4 v[232:235], v13, s[16:19], 0 offen offset:2560 sc1
    v_mfma_f32_16x16x32_bf16 v[92:95], v[36:39], a[200:203], v[92:95]
    s_waitcnt lgkmcnt(4)
    v_mfma_f32_16x16x32_bf16 v[92:95], v[40:43], a[208:211], v[92:95]
    v_mfma_f32_16x16x32_bf16 v[92:95], v[44:47], a[216:219], v[92:95]
    v_cvt_pk_bf16_f32 v236, v88, v89
    v_cvt_pk_bf16_f32 v237, v90, v91
    v_mfma_f32_16x16x32_bf16 v[128:131], v[44:47], a[220:223], v[128:131]
    v_cvt_pk_bf16_f32 v238, v124, v125
    v_cvt_pk_bf16_f32 v239, v126, v127
    v_mfma_f32_16x16x32_bf16 v[128:131], v[40:43], a[212:215], v[128:131]
    v_mfma_f32_16x16x32_bf16 v[128:131], v[36:39], a[204:207], v[128:131]
    v_permlane32_swap_b32 v236, v238
    v_mfma_f32_16x16x32_bf16 v[128:131], v[32:35], a[196:199], v[128:131]
    s_waitcnt lgkmcnt(2)
    v_permlane32_swap_b32 v237, v239
    v_mfma_f32_16x16x32_bf16 v[96:99], v[48:51], a[192:195], v[96:99]
    buffer_store_dwordx4 v[236:239], v13, s[16:19], 0 offen offset:3072 sc1
    v_mfma_f32_16x16x32_bf16 v[96:99], v[52:55], a[200:203], v[96:99]
    s_waitcnt lgkmcnt(0)
    v_mfma_f32_16x16x32_bf16 v[96:99], v[56:59], a[208:211], v[96:99]
    v_mfma_f32_16x16x32_bf16 v[96:99], v[60:63], a[216:219], v[96:99]
    v_cvt_pk_bf16_f32 v240, v92, v93
    v_cvt_pk_bf16_f32 v241, v94, v95
    v_mfma_f32_16x16x32_bf16 v[132:135], v[60:63], a[220:223], v[132:135]
    v_cvt_pk_bf16_f32 v242, v128, v129
    v_cvt_pk_bf16_f32 v243, v130, v131
    v_mfma_f32_16x16x32_bf16 v[132:135], v[56:59], a[212:215], v[132:135]
    v_mfma_f32_16x16x32_bf16 v[132:135], v[52:55], a[204:207], v[132:135]
    v_mfma_f32_16x16x32_bf16 v[132:135], v[48:51], a[196:199], v[132:135]
    v_cvt_pk_bf16_f32 v244, v96, v97
    v_cvt_pk_bf16_f32 v245, v98, v99
    s_nop 5
    v_cvt_pk_bf16_f32 v246, v132, v133
    v_cvt_pk_bf16_f32 v247, v134, v135
    v_permlane32_swap_b32 v240, v242
    v_permlane32_swap_b32 v241, v243
    buffer_store_dwordx4 v[240:243], v13, s[16:19], 0 offen offset:3584 sc1
    v_permlane32_swap_b32 v244, v246
    v_permlane32_swap_b32 v245, v247
    buffer_store_dwordx4 v[244:247], v13, s[16:19], s41 offen offset:0 sc1
    s_lshl_b32 s25, s38, 1
    s_add_u32 s25, s25, s22
    s_add_u32 s25, s25, 896
    s_lshl_b32 s25, s25, 7
    v_mul_u32_u24 v10, 128, v1
    v_mov_b32 v11, 1
    s_waitcnt vmcnt(0)
    s_mov_b64 exec, 1
    buffer_atomic_add v11, v10, s[96:99], s25 offen
    s_mov_b64 exec, -1
    s_lshl_b32 s34, s21, 2
    s_add_u32 s34, s34, s20
    s_mov_b32 s35, s22
    s_barrier
    s_lshr_b32 s24, s3, 1
    s_lshl_b32 s25, s34, 1
    s_add_u32 s24, s24, s25
    s_mul_i32 s25, s24, 18432
    s_mul_i32 s26, s35, 4608
    s_add_u32 s25, s25, s26
    s_add_u32 s26, s25, 2740224
    s_add_u32 s52, s58, s26
    s_addc_u32 s53, s59, 0
    s_mov_b32 s54, 4608
    s_mov_b32 s55, 0x20000
    s_and_b32 s27, s3, 1
    s_lshl_b32 s28, s27, 10
    v_add_u32 v24, s28, v2
    s_mov_b32 s56, 0x00003f80
    s_mov_b32 s57, 0x3f800000
    s_mov_b32 s40, 0x3f803f80
    s_lshl_b32 s29, s24, 10
    s_lshl_b32 s26, s35, 8
    s_add_u32 s29, s29, s26
    s_lshl_b32 s26, s27, 3
    s_add_u32 s29, s29, s26
    buffer_load_dwordx4 v[128:131], v24, s[52:55], 0 offen offset:0 sc1
    buffer_load_dwordx4 v[132:135], v24, s[52:55], 0 offen offset:2048 sc1
    buffer_load_dwordx4 v[136:139], v24, s[52:55], s41 offen offset:0 sc1
    s_add_u32 s26, s25, 28299264
    s_add_u32 s8, s58, s26
    s_addc_u32 s9, s59, 0
    s_mov_b32 s10, 7082496
    s_mov_b32 s11, 0x20000
    v_mov_b32 v25, 1073741824
    v_cmp_gt_u32 vcc, 512, v24
    s_nop 1
    v_cndmask_b32 v25, v25, v24, vcc
    s_mov_b32 s30, 0
    s_mov_b32 s36, 4096
    s_mov_b32 s31, 2359296
    s_mov_b32 s37, 2363392
    s_mov_b32 s32, 4718592
    s_mov_b32 s38, 4722688
    s_mov_b32 s33, 7077888
    s_mov_b32 s39, 7081984
    s_add_u32 s26, s25, 37748736
    s_add_u32 s12, s58, s26
    s_addc_u32 s13, s59, 0
    s_mov_b32 s14, 4608
    s_mov_b32 s15, 0x20000
    s_add_u32 s16, s58, 40108032
    s_addc_u32 s17, s59, 0
    s_mov_b32 s18, 131072
    s_mov_b32 s19, 0x20000
    v_mov_b32 v10, 0
    v_mov_b32 v11, 0
    v_mov_b32 v12, 0
    v_mov_b32 v13, 0
    s_lshl_b32 s26, s34, 2
    s_add_u32 s26, s26, s35
    s_add_u32 s26, s26, 896
    s_lshl_b32 s26, s26, 7
    v_mov_b32 v14, 0
    s_mov_b64 exec, 1
    s_mov_b32 s61, 200000
POLL_mk_24:
    v_mov_b32 v15, 0
    buffer_atomic_add v15, v14, s[96:99], s26 offen sc0
    s_waitcnt vmcnt(0)
    v_cmp_gt_u32 vcc, 4, v15
    s_nop 0
    s_cbranch_vccz PDONE_mk_25
    s_sub_u32 s61, s61, 1
    s_cmp_lg_u32 s61, 0
    s_cbranch_scc1 POLL_mk_24
PDONE_mk_25:
    s_mov_b64 exec, -1
    buffer_load_dwordx4 v[32:35], v24, s[8:11], s30 offen offset:0 sc1
    buffer_load_dwordx4 v[36:39], v24, s[8:11], s31 offen offset:0 sc1
    buffer_load_dwordx4 v[40:43], v24, s[8:11], s32 offen offset:0 sc1
    buffer_load_dwordx4 v[44:47], v24, s[8:11], s33 offen offset:0 sc1
    buffer_load_dwordx4 v[48:51], v24, s[8:11], s30 offen offset:2048 sc1
    buffer_load_dwordx4 v[52:55], v24, s[8:11], s31 offen offset:2048 sc1
    buffer_load_dwordx4 v[56:59], v24, s[8:11], s32 offen offset:2048 sc1
    buffer_load_dwordx4 v[60:63], v24, s[8:11], s33 offen offset:2048 sc1
    buffer_load_dwordx4 v[64:67], v25, s[8:11], s36 offen sc1
    buffer_load_dwordx4 v[68:71], v25, s[8:11], s37 offen sc1
    buffer_load_dwordx4 v[72:75], v25, s[8:11], s38 offen sc1
    buffer_load_dwordx4 v[76:79], v25, s[8:11], s39 offen sc1
    v_lshlrev_b32 v80, 16, v128
    v_and_b32 v81, 0xffff0000, v128
    v_lshlrev_b32 v82, 16, v129
    v_and_b32 v83, 0xffff0000, v129
    v_lshlrev_b32 v84, 16, v130
    v_and_b32 v85, 0xffff0000, v130
    v_lshlrev_b32 v86, 16, v131
    v_and_b32 v87, 0xffff0000, v131
    s_waitcnt vmcnt(11)
    v_dot2c_f32_bf16 v80, s56, v32
    v_dot2c_f32_bf16 v81, s57, v32
    v_dot2c_f32_bf16 v82, s56, v33
    v_dot2c_f32_bf16 v83, s57, v33
    v_dot2c_f32_bf16 v84, s56, v34
    v_dot2c_f32_bf16 v85, s57, v34
    v_dot2c_f32_bf16 v86, s56, v35
    v_dot2c_f32_bf16 v87, s57, v35
    s_waitcnt vmcnt(10)
    v_dot2c_f32_bf16 v80, s56, v36
    v_dot2c_f32_bf16 v81, s57, v36
    v_dot2c_f32_bf16 v82, s56, v37
    v_dot2c_f32_bf16 v83, s57, v37
    v_dot2c_f32_bf16 v84, s56, v38
    v_dot2c_f32_bf16 v85, s57, v38
    v_dot2c_f32_bf16 v86, s56, v39
    v_dot2c_f32_bf16 v87, s57, v39
    s_waitcnt vmcnt(9)
    v_dot2c_f32_bf16 v80, s56, v40
    v_dot2c_f32_bf16 v81, s57, v40
    v_dot2c_f32_bf16 v82, s56, v41
    v_dot2c_f32_bf16 v83, s57, v41
    v_dot2c_f32_bf16 v84, s56, v42
    v_dot2c_f32_bf16 v85, s57, v42
    v_dot2c_f32_bf16 v86, s56, v43
    v_dot2c_f32_bf16 v87, s57, v43
    s_waitcnt vmcnt(8)
    v_dot2c_f32_bf16 v80, s56, v44
    v_dot2c_f32_bf16 v81, s57, v44
    v_dot2c_f32_bf16 v82, s56, v45
    v_dot2c_f32_bf16 v83, s57, v45
    v_dot2c_f32_bf16 v84, s56, v46
    v_dot2c_f32_bf16 v85, s57, v46
    v_dot2c_f32_bf16 v86, s56, v47
    v_dot2c_f32_bf16 v87, s57, v47
    v_cvt_pk_bf16_f32 v88, v80, v81
    v_cvt_pk_bf16_f32 v89, v82, v83
    v_cvt_pk_bf16_f32 v90, v84, v85
    v_cvt_pk_bf16_f32 v91, v86, v87
    v_lshlrev_b32 v92, 16, v132
    v_and_b32 v93, 0xffff0000, v132
    v_lshlrev_b32 v94, 16, v133
    v_and_b32 v95, 0xffff0000, v133
    v_lshlrev_b32 v96, 16, v134
    v_and_b32 v97, 0xffff0000, v134
    v_lshlrev_b32 v98, 16, v135
    v_and_b32 v99, 0xffff0000, v135
    s_waitcnt vmcnt(7)
    v_dot2c_f32_bf16 v92, s56, v48
    v_dot2c_f32_bf16 v93, s57, v48
    v_dot2c_f32_bf16 v94, s56, v49
    v_dot2c_f32_bf16 v95, s57, v49
    v_dot2c_f32_bf16 v96, s56, v50
    v_dot2c_f32_bf16 v97, s57, v50
    v_dot2c_f32_bf16 v98, s56, v51
    v_dot2c_f32_bf16 v99, s57, v51
    s_waitcnt vmcnt(6)
    v_dot2c_f32_bf16 v92, s56, v52
    v_dot2c_f32_bf16 v93, s57, v52
    v_dot2c_f32_bf16 v94, s56, v53
    v_dot2c_f32_bf16 v95, s57, v53
    v_dot2c_f32_bf16 v96, s56, v54
    v_dot2c_f32_bf16 v97, s57, v54
    v_dot2c_f32_bf16 v98, s56, v55
    v_dot2c_f32_bf16 v99, s57, v55
    s_waitcnt vmcnt(5)
    v_dot2c_f32_bf16 v92, s56, v56
    v_dot2c_f32_bf16 v93, s57, v56
    v_dot2c_f32_bf16 v94, s56, v57
    v_dot2c_f32_bf16 v95, s57, v57
    v_dot2c_f32_bf16 v96, s56, v58
    v_dot2c_f32_bf16 v97, s57, v58
    v_dot2c_f32_bf16 v98, s56, v59
    v_dot2c_f32_bf16 v99, s57, v59
    s_waitcnt vmcnt(4)
    v_dot2c_f32_bf16 v92, s56, v60
    v_dot2c_f32_bf16 v93, s57, v60
    v_dot2c_f32_bf16 v94, s56, v61
    v_dot2c_f32_bf16 v95, s57, v61
    v_dot2c_f32_bf16 v96, s56, v62
    v_dot2c_f32_bf16 v97, s57, v62
    v_dot2c_f32_bf16 v98, s56, v63
    v_dot2c_f32_bf16 v99, s57, v63
    v_cvt_pk_bf16_f32 v100, v92, v93
    v_cvt_pk_bf16_f32 v101, v94, v95
    v_cvt_pk_bf16_f32 v102, v96, v97
    v_cvt_pk_bf16_f32 v103, v98, v99
    v_lshlrev_b32 v104, 16, v136
    v_and_b32 v105, 0xffff0000, v136
    v_lshlrev_b32 v106, 16, v137
    v_and_b32 v107, 0xffff0000, v137
    v_lshlrev_b32 v108, 16, v138
    v_and_b32 v109, 0xffff0000, v138
    v_lshlrev_b32 v110, 16, v139
    v_and_b32 v111, 0xffff0000, v139
    s_waitcnt vmcnt(3)
    v_dot2c_f32_bf16 v104, s56, v64
    v_dot2c_f32_bf16 v105, s57, v64
    v_dot2c_f32_bf16 v106, s56, v65
    v_dot2c_f32_bf16 v107, s57, v65
    v_dot2c_f32_bf16 v108, s56, v66
    v_dot2c_f32_bf16 v109, s57, v66
    v_dot2c_f32_bf16 v110, s56, v67
    v_dot2c_f32_bf16 v111, s57, v67
    s_waitcnt vmcnt(2)
    v_dot2c_f32_bf16 v104, s56, v68
    v_dot2c_f32_bf16 v105, s57, v68
    v_dot2c_f32_bf16 v106, s56, v69
    v_dot2c_f32_bf16 v107, s57, v69
    v_dot2c_f32_bf16 v108, s56, v70
    v_dot2c_f32_bf16 v109, s57, v70
    v_dot2c_f32_bf16 v110, s56, v71
    v_dot2c_f32_bf16 v111, s57, v71
    s_waitcnt vmcnt(1)
    v_dot2c_f32_bf16 v104, s56, v72
    v_dot2c_f32_bf16 v105, s57, v72
    v_dot2c_f32_bf16 v106, s56, v73
    v_dot2c_f32_bf16 v107, s57, v73
    v_dot2c_f32_bf16 v108, s56, v74
    v_dot2c_f32_bf16 v109, s57, v74
    v_dot2c_f32_bf16 v110, s56, v75
    v_dot2c_f32_bf16 v111, s57, v75
    s_waitcnt vmcnt(0)
    v_dot2c_f32_bf16 v104, s56, v76
    v_dot2c_f32_bf16 v105, s57, v76
    v_dot2c_f32_bf16 v106, s56, v77
    v_dot2c_f32_bf16 v107, s57, v77
    v_dot2c_f32_bf16 v108, s56, v78
    v_dot2c_f32_bf16 v109, s57, v78
    v_dot2c_f32_bf16 v110, s56, v79
    v_dot2c_f32_bf16 v111, s57, v79
    v_cvt_pk_bf16_f32 v112, v104, v105
    v_cvt_pk_bf16_f32 v113, v106, v107
    v_cvt_pk_bf16_f32 v114, v108, v109
    v_cvt_pk_bf16_f32 v115, v110, v111
    s_cmp_eq_u32 s60, 1
    s_cbranch_scc0 SK_mk_26
    s_mov_b32 s12, s62
    s_mov_b32 s13, s63
    s_mov_b32 s14, 2359296
    s_mov_b32 s15, 0x20000
    s_mul_i32 s26, s24, 18432
    s_mul_i32 s28, s35, 288
    s_add_u32 s26, s26, s28
    s_lshl_b32 s28, s27, 6
    s_add_u32 s26, s26, s28
    v_and_b32 v8, 15, v1
    v_mul_u32_u24 v8, 1152, v8
    v_lshrrev_b32 v9, 4, v1
    v_lshl_add_u32 v8, v9, 4, v8
    v_mov_b32 v9, 1073741824
    v_cmp_gt_u32 vcc, 512, v24
    s_nop 1
    v_cndmask_b32 v9, v9, v8, vcc
    buffer_store_dwordx4 v[88:91], v8, s[12:15], s26 offen offset:0
    buffer_store_dwordx4 v[100:103], v8, s[12:15], s26 offen offset:128
    buffer_store_dwordx4 v[112:115], v9, s[12:15], s26 offen offset:256
    s_endpgm
SK_mk_26:
    buffer_store_dwordx4 v[88:91], v24, s[12:15], 0 offen offset:0 sc1
    v_dot2c_f32_bf16 v10, s40, v88
    v_dot2c_f32_bf16 v12, v88, v88
    v_dot2c_f32_bf16 v11, s40, v89
    v_dot2c_f32_bf16 v13, v89, v89
    v_dot2c_f32_bf16 v10, s40, v90
    v_dot2c_f32_bf16 v12, v90, v90
    v_dot2c_f32_bf16 v11, s40, v91
    v_dot2c_f32_bf16 v13, v91, v91
    buffer_store_dwordx4 v[100:103], v24, s[12:15], 0 offen offset:2048 sc1
    v_dot2c_f32_bf16 v10, s40, v100
    v_dot2c_f32_bf16 v12, v100, v100
    v_dot2c_f32_bf16 v11, s40, v101
    v_dot2c_f32_bf16 v13, v101, v101
    v_dot2c_f32_bf16 v10, s40, v102
    v_dot2c_f32_bf16 v12, v102, v102
    v_dot2c_f32_bf16 v11, s40, v103
    v_dot2c_f32_bf16 v13, v103, v103
    buffer_store_dwordx4 v[112:115], v24, s[12:15], s41 offen offset:0 sc1
    v_dot2c_f32_bf16 v10, s40, v112
    v_dot2c_f32_bf16 v12, v112, v112
    v_dot2c_f32_bf16 v11, s40, v113
    v_dot2c_f32_bf16 v13, v113, v113
    v_dot2c_f32_bf16 v10, s40, v114
    v_dot2c_f32_bf16 v12, v114, v114
    v_dot2c_f32_bf16 v11, s40, v115
    v_dot2c_f32_bf16 v13, v115, v115
    s_nop 1
    v_add_f32 v10, v10, v11
    v_add_f32 v11, v12, v13
    v_mov_b32 v14, v10
    s_nop 1
    v_permlane16_swap_b32 v10, v14
    v_add_f32 v10, v10, v14
    v_mov_b32 v14, v10
    s_nop 1
    v_permlane32_swap_b32 v10, v14
    v_add_f32 v10, v10, v14
    v_mov_b32 v14, v11
    s_nop 1
    v_permlane16_swap_b32 v11, v14
    v_add_f32 v11, v11, v14
    v_mov_b32 v14, v11
    s_nop 1
    v_permlane32_swap_b32 v11, v14
    v_add_f32 v11, v11, v14
    v_mov_b32 v14, 1073741824
    v_cmp_gt_u32 vcc, 16, v1
    s_nop 1
    v_cndmask_b32 v14, v14, v2, vcc
    buffer_store_dwordx2 v[10:11], v14, s[16:19], s29 offen sc1
    s_lshl_b32 s26, s34, 2
    s_add_u32 s26, s26, 1152
    s_lshl_b32 s26, s26, 7
    s_add_u32 s26, s26, 37748736
    v_mul_u32_u24 v10, 128, v1
    v_mov_b32 v11, 1
    s_waitcnt vmcnt(0)
    s_mov_b64 exec, 15
    buffer_atomic_add v11, v10, s[96:99], s26 offen
    s_mov_b64 exec, -1
    s_add_u32 s58, s58, 37748736
    s_addc_u32 s59, s59, 0
    s_sub_u32 s60, s60, 1
    s_cmp_lg_u32 s60, 0
    s_cbranch_scc1 LP_mk_3
    s_endpgm
mk_code_end:
.section .rodata,"a"
.p2align 6
.amdhsa_kernel k0_kernel
  .amdhsa_next_free_vgpr 64
  .amdhsa_next_free_sgpr 53
  .amdhsa_accum_offset 64
  .amdhsa_group_segment_fixed_size 0
  .amdhsa_kernarg_size 80
  .amdhsa_user_sgpr_count 2
  .amdhsa_user_sgpr_kernarg_segment_ptr 1
  .amdhsa_system_sgpr_workgroup_id_x 1
.end_amdhsa_kernel
.p2align 6
.amdhsa_kernel mk_kernel
  .amdhsa_next_free_vgpr 512
  .amdhsa_next_free_sgpr 102
  .amdhsa_accum_offset 256
  .amdhsa_group_segment_fixed_size 0
  .amdhsa_kernarg_size 80
  .amdhsa_user_sgpr_count 2
  .amdhsa_user_sgpr_kernarg_segment_ptr 1
  .amdhsa_system_sgpr_workgroup_id_x 1
.end_amdhsa_kernel
```
